```python
import torch

def _softmax(x, axis=-1):
    return torch.softmax(x, dim=axis)
def _gelu(x):
    return torch.nn.functional.gelu(x, approximate="tanh")
def _silu(x):
    return torch.nn.functional.silu(x)
def _sigmoid(x):
    return torch.sigmoid(x)
def _layernorm(x, axis=-1, eps=1e-5):
    m = x.mean(dim=axis, keepdim=True)
    v = x.var(dim=axis, keepdim=True, unbiased=False)
    return (x - m) / torch.sqrt(v + eps)
def _scatter_add(tgt, idx, src, axis=0):
    return tgt.clone().index_add_(axis, idx, src)
def _segment_sum(src, seg, n):
    out = torch.zeros((n,) + src.shape[1:], dtype=src.dtype)
    return out.index_add_(0, seg, src)
def _pad(x, pw):
    flat = tuple(v for pair in reversed(pw) for v in pair)
    return torch.nn.functional.pad(x, flat)

kernel_name = 'standalone__mha_softmax__near_ridge'

def setup_inputs():

    _w = (lambda a: (lambda t: t.to(torch.bfloat16) if t.is_floating_point() else t)(torch.as_tensor(a)))
    B, H, Sq, Sk, D = 8, 32, 512, 512, 128
    return {
        "q": _w((lambda *s: torch.randn(*s, dtype=torch.bfloat16) * 0.8)(B, H, Sq, D)),
        "k": _w((lambda *s: torch.randn(*s, dtype=torch.bfloat16) * 0.8)(B, H, Sk, D)),
        "v": _w((lambda *s: torch.randn(*s, dtype=torch.bfloat16) * 0.05)(B, H, Sk, D)),
    }

def reference(q, k, v):
    scale = q.shape[-1] ** -0.5
    scores = torch.einsum("bhqd,bhkd->bhqk", q, k) * scale
    p = _softmax(scores, axis=-1)
    return torch.einsum("bhqk,bhkd->bhqd", p, v)
```

```asm
; @launch grid=(256,1,1) block=(256,1,1) lds=163840
.amdgcn_target "amdgcn-amd-amdhsa--gfx950"
.text
.globl standalone__mha_softmax__near_ridge_kernel
.p2align 8
.type standalone__mha_softmax__near_ridge_kernel,@function
standalone__mha_softmax__near_ridge_kernel:
    s_cmp_ge_u32 s2, 256
    s_cbranch_scc1 L_end
    s_load_dwordx2 s[4:5], s[0:1], 0
    s_load_dwordx2 s[8:9], s[0:1], 8
    s_load_dwordx2 s[12:13], s[0:1], 16
    s_load_dwordx2 s[16:17], s[0:1], 24
    s_mov_b32 s6, 33554432
    s_mov_b32 s7, 0x00020000
    s_mov_b32 s10, 33554432
    s_mov_b32 s11, 0x00020000
    s_mov_b32 s14, 33554432
    s_mov_b32 s15, 0x00020000
    s_mov_b32 s18, 33554432
    s_mov_b32 s19, 0x00020000
    s_getpc_b64 s[52:53]
L_pc:
    s_add_u32 s52, s52, L_pad0-L_pc
    s_addc_u32 s53, s53, 0
    s_lshr_b32 s54, s2, 3
    s_lshl_b32 s54, s54, 5
    v_lshrrev_b32 v28, 3, v0
    v_and_b32 v28, 24, v28
    v_and_or_b32 v28, v0, 7, v28
    v_add_u32 v28, s54, v28
    v_and_b32 v28, 511, v28
    v_min_u32 v28, 322, v28
    v_lshlrev_b32 v28, 7, v28
    global_load_dword v255, v28, s[52:53]
    v_lshrrev_b32 v28, 6, v0
    v_and_b32 v29, 63, v0
    v_readfirstlane_b32 s20, v28
    s_and_b32 s48, s2, 7
    s_lshr_b32 s49, s2, 4
    s_lshl_b32 s49, s49, 3
    s_or_b32 s48, s48, s49
    s_lshl_b32 s22, s48, 17
    s_add_u32 s23, s22, 16777216
    s_bfe_u32 s49, s2, 0x10003
    s_lshl_b32 s49, s49, 16
    s_lshl_b32 s50, s20, 14
    s_add_u32 s49, s49, s50
    s_add_u32 s24, s22, s49
    s_add_u32 s25, s23, s49
    s_lshl_b32 s21, s20, 10
    v_and_b32 v30, 15, v29
    v_lshrrev_b32 v31, 4, v29
    v_and_b32 v33, 1, v31
    v_lshrrev_b32 v34, 1, v31
    v_lshl_or_b32 v32, v33, 1, v34
    v_lshlrev_b32 v33, 8, v30
    v_lshl_or_b32 v1, v32, 4, v33
    v_lshrrev_b32 v33, 3, v29
    v_and_b32 v35, 6, v33
    v_and_b32 v34, 1, v28
    v_or_b32 v35, v35, v34
    v_and_b32 v34, 7, v29
    v_xor_b32 v35, v35, v34
    v_lshl_add_u32 v33, v28, 3, v33
    v_lshlrev_b32 v33, 8, v33
    v_lshl_or_b32 v0, v35, 4, v33
    s_lshl_b32 s3, s20, 11
    v_lshrrev_b32 v33, 3, v29
    v_and_b32 v35, 6, v33
    v_and_b32 v34, 7, v29
    v_xor_b32 v35, v35, v34
    v_lshlrev_b32 v33, 8, v33
    v_lshl_or_b32 v244, v35, 4, v33
    v_xor_b32 v245, 16, v244
    v_add_u32 v245, 2048, v245
    s_waitcnt lgkmcnt(0)
    s_add_u32 s48, s24, 0
    s_add_u32 m0, s3, 32768
    s_nop 0
    buffer_load_dwordx4 v244, s[4:7], s48 offen nt lds
    s_add_u32 m0, s3, 40832
    s_nop 0
    buffer_load_dwordx4 v244, s[4:7], s48 offen offset:128 nt lds
    s_add_u32 m0, s3, 33792
    s_nop 0
    buffer_load_dwordx4 v245, s[4:7], s48 offen nt lds
    s_add_u32 m0, s3, 41856
    s_nop 0
    buffer_load_dwordx4 v245, s[4:7], s48 offen offset:128 nt lds
    s_add_u32 s26, s22, 0
    s_add_u32 s27, s22, 8192
    s_add_u32 m0, s21, 0
    s_nop 0
    buffer_load_dwordx4 v0, s[8:11], s26 offen nt lds
    s_add_u32 m0, s21, 8064
    s_nop 0
    buffer_load_dwordx4 v0, s[8:11], s26 offen offset:128 nt lds
    s_add_u32 m0, s21, 4096
    s_nop 0
    buffer_load_dwordx4 v0, s[8:11], s27 offen nt lds
    s_add_u32 m0, s21, 12160
    s_nop 0
    buffer_load_dwordx4 v0, s[8:11], s27 offen offset:128 nt lds
    s_add_u32 s48, s24, 4096
    s_add_u32 m0, s3, 98304
    s_nop 0
    buffer_load_dwordx4 v244, s[4:7], s48 offen nt lds
    s_add_u32 m0, s3, 106368
    s_nop 0
    buffer_load_dwordx4 v244, s[4:7], s48 offen offset:128 nt lds
    s_add_u32 m0, s3, 99328
    s_nop 0
    buffer_load_dwordx4 v245, s[4:7], s48 offen nt lds
    s_add_u32 m0, s3, 107392
    s_nop 0
    buffer_load_dwordx4 v245, s[4:7], s48 offen offset:128 nt lds
    v_and_b32 v35, 6, v30
    v_lshrrev_b32 v33, 3, v30
    v_or_b32 v35, v35, v33
    v_xor_b32 v35, v35, v32
    v_lshlrev_b32 v33, 7, v30
    v_lshl_or_b32 v2, v35, 4, v33
    v_xor_b32 v3, 64, v2
    v_lshl_add_u32 v248, v28, 11, v2
    v_add_u32 v250, 65536, v248
    v_lshl_add_u32 v249, v28, 11, v3
    v_add_u32 v251, 65536, v249
    v_lshrrev_b32 v30, 2, v29
    v_and_b32 v35, 6, v30
    v_lshrrev_b32 v33, 3, v30
    v_or_b32 v35, v35, v33
    v_bfe_u32 v33, v29, 1, 1
    v_xor_b32 v35, v35, v33
    v_lshlrev_b32 v33, 7, v30
    v_lshl_or_b32 v33, v35, 4, v33
    v_and_b32 v34, 1, v29
    v_lshl_or_b32 v33, v34, 3, v33
    v_add_u32 v4, 65536, v33
    v_xor_b32 v5, 32, v4
    v_xor_b32 v6, 64, v4
    v_xor_b32 v7, 96, v4
    v_and_b32 v33, 15, v29
    v_mul_u32_u24 v33, 272, v33
    v_lshl_add_u32 v33, v31, 3, v33
    v_lshlrev_b32 v34, 13, v28
    v_add_u32 v34, 131072, v34
    v_add_u32 v252, v33, v34
    v_lshlrev_b32 v254, 4, v29
    v_lshl_add_u32 v33, v31, 4, v254
    v_add_u32 v253, v33, v34
    s_mov_b32 s28, 0x3e0293ee
    s_mov_b32 s29, 0x3e0293ee
    s_mov_b32 s30, 0x4f800000
    s_mov_b32 s31, 0xffff0000
    v_mov_b32 v33, 0x3f803f80
    v_and_b32 v34, 3, v29
    v_cmp_eq_u32 s[48:49], 0, v34
    s_nop 1
    v_cndmask_b32 v33, 0, v33, s[48:49]
    v_accvgpr_write_b32 a192, v33
    v_accvgpr_write_b32 a193, v33
    v_accvgpr_write_b32 a194, v33
    v_accvgpr_write_b32 a195, v33
    v_bfe_u32 v33, v29, 2, 2
    v_and_b32 v34, 3, v29
    v_xor_b32 v33, v33, v31
    v_lshl_or_b32 v33, v33, 2, v34
    v_accvgpr_write_b32 a212, 0
    v_accvgpr_write_b32 a213, 0
    v_accvgpr_write_b32 a216, 0
    v_accvgpr_write_b32 a217, 0
    v_accvgpr_write_b32 a220, 0
    v_accvgpr_write_b32 a221, 0
    v_mov_b32 v35, 0
    v_cmp_eq_u32 s[48:49], 0, v33
    v_mov_b32 v34, 0x3e02
    s_nop 0
    v_cndmask_b32 v35, v35, v34, s[48:49]
    v_cmp_eq_u32 s[48:49], 1, v33
    v_mov_b32 v34, 0x3e020000
    s_nop 0
    v_cndmask_b32 v35, v35, v34, s[48:49]
    v_accvgpr_write_b32 a214, v35
    v_mov_b32 v35, 0
    v_cmp_eq_u32 s[48:49], 0, v33
    v_mov_b32 v34, 0x3a14
    s_nop 0
    v_cndmask_b32 v35, v35, v34, s[48:49]
    v_cmp_eq_u32 s[48:49], 1, v33
    v_mov_b32 v34, 0x3a140000
    s_nop 0
    v_cndmask_b32 v35, v35, v34, s[48:49]
    v_accvgpr_write_b32 a218, v35
    v_mov_b32 v35, 0
    v_cmp_eq_u32 s[48:49], 2, v33
    v_mov_b32 v34, 0x3e02
    s_nop 0
    v_cndmask_b32 v35, v35, v34, s[48:49]
    v_cmp_eq_u32 s[48:49], 3, v33
    v_mov_b32 v34, 0x3e020000
    s_nop 0
    v_cndmask_b32 v35, v35, v34, s[48:49]
    v_accvgpr_write_b32 a215, v35
    v_mov_b32 v35, 0
    v_cmp_eq_u32 s[48:49], 2, v33
    v_mov_b32 v34, 0x3a14
    s_nop 0
    v_cndmask_b32 v35, v35, v34, s[48:49]
    v_cmp_eq_u32 s[48:49], 3, v33
    v_mov_b32 v34, 0x3a140000
    s_nop 0
    v_cndmask_b32 v35, v35, v34, s[48:49]
    v_accvgpr_write_b32 a219, v35
    s_mov_b64 vcc, -1
    s_cmp_eq_u32 s20, 0
    s_cbranch_scc1 L_pad0
    s_cmp_eq_u32 s20, 1
    s_cbranch_scc1 L_pad1
    s_cmp_eq_u32 s20, 2
    s_cbranch_scc1 L_pad2
    s_cmp_eq_u32 s20, 3
    s_cbranch_scc1 L_pad3
L_touched0:
    s_mov_b64 vcc, 0
    s_mov_b64 vcc, -1
    s_cmp_eq_u32 s20, 0
    s_cbranch_scc1 L_pad4
    s_cmp_eq_u32 s20, 1
    s_cbranch_scc1 L_pad5
    s_cmp_eq_u32 s20, 2
    s_cbranch_scc1 L_pad6
    s_cmp_eq_u32 s20, 3
    s_cbranch_scc1 L_pad7
L_touched1:
    s_mov_b64 vcc, 0
    s_waitcnt vmcnt(8)
    ds_read_b128 v[124:127], v248 offset:32768
    ds_read_b128 v[128:131], v249 offset:32768
    ds_read_b128 v[132:135], v248 offset:40960
    ds_read_b128 v[136:139], v249 offset:40960
    s_add_u32 s26, s22, 0
    s_add_u32 s27, s22, 8192
    s_add_u32 m0, s21, 65536
    s_nop 0
    buffer_load_dwordx4 v0, s[12:15], s26 offen nt lds
    s_waitcnt lgkmcnt(3)
    v_lshlrev_b32 v140, 16, v124
    v_lshlrev_b32 v142, 16, v125
    v_lshlrev_b32 v144, 16, v126
    v_lshlrev_b32 v146, 16, v127
    v_and_b32 v141, s31, v124
    v_and_b32 v143, s31, v125
    v_and_b32 v145, s31, v126
    v_and_b32 v147, s31, v127
    v_pk_mul_f32 v[140:141], v[140:141], s[28:29]
    v_pk_mul_f32 v[142:143], v[142:143], s[28:29]
    v_pk_mul_f32 v[144:145], v[144:145], s[28:29]
    v_pk_mul_f32 v[146:147], v[146:147], s[28:29]
    v_cvt_pk_bf16_f32 v60, v140, v141
    v_cvt_pk_bf16_f32 v61, v142, v143
    v_cvt_pk_bf16_f32 v62, v144, v145
    v_cvt_pk_bf16_f32 v63, v146, v147
    s_add_u32 m0, s21, 73600
    s_nop 0
    buffer_load_dwordx4 v0, s[12:15], s26 offen offset:128 nt lds
    s_waitcnt lgkmcnt(2)
    v_lshlrev_b32 v140, 16, v128
    v_lshlrev_b32 v142, 16, v129
    v_lshlrev_b32 v144, 16, v130
    v_lshlrev_b32 v146, 16, v131
    v_and_b32 v141, s31, v128
    v_and_b32 v143, s31, v129
    v_and_b32 v145, s31, v130
    v_and_b32 v147, s31, v131
    v_pk_mul_f32 v[140:141], v[140:141], s[28:29]
    v_pk_mul_f32 v[142:143], v[142:143], s[28:29]
    v_pk_mul_f32 v[144:145], v[144:145], s[28:29]
    v_pk_mul_f32 v[146:147], v[146:147], s[28:29]
    v_cvt_pk_bf16_f32 v64, v140, v141
    v_cvt_pk_bf16_f32 v65, v142, v143
    v_cvt_pk_bf16_f32 v66, v144, v145
    v_cvt_pk_bf16_f32 v67, v146, v147
    s_add_u32 m0, s21, 69632
    s_nop 0
    buffer_load_dwordx4 v0, s[12:15], s27 offen nt lds
    s_waitcnt lgkmcnt(1)
    v_lshlrev_b32 v140, 16, v132
    v_lshlrev_b32 v142, 16, v133
    v_lshlrev_b32 v144, 16, v134
    v_lshlrev_b32 v146, 16, v135
    v_and_b32 v141, s31, v132
    v_and_b32 v143, s31, v133
    v_and_b32 v145, s31, v134
    v_and_b32 v147, s31, v135
    v_pk_mul_f32 v[140:141], v[140:141], s[28:29]
    v_pk_mul_f32 v[142:143], v[142:143], s[28:29]
    v_pk_mul_f32 v[144:145], v[144:145], s[28:29]
    v_pk_mul_f32 v[146:147], v[146:147], s[28:29]
    v_cvt_pk_bf16_f32 v68, v140, v141
    v_cvt_pk_bf16_f32 v69, v142, v143
    v_cvt_pk_bf16_f32 v70, v144, v145
    v_cvt_pk_bf16_f32 v71, v146, v147
    s_add_u32 m0, s21, 77696
    s_nop 0
    buffer_load_dwordx4 v0, s[12:15], s27 offen offset:128 nt lds
    s_waitcnt lgkmcnt(0)
    v_lshlrev_b32 v140, 16, v136
    v_lshlrev_b32 v142, 16, v137
    v_lshlrev_b32 v144, 16, v138
    v_lshlrev_b32 v146, 16, v139
    v_and_b32 v141, s31, v136
    v_and_b32 v143, s31, v137
    v_and_b32 v145, s31, v138
    v_and_b32 v147, s31, v139
    v_pk_mul_f32 v[140:141], v[140:141], s[28:29]
    v_pk_mul_f32 v[142:143], v[142:143], s[28:29]
    v_pk_mul_f32 v[144:145], v[144:145], s[28:29]
    v_pk_mul_f32 v[146:147], v[146:147], s[28:29]
    v_cvt_pk_bf16_f32 v72, v140, v141
    v_cvt_pk_bf16_f32 v73, v142, v143
    v_cvt_pk_bf16_f32 v74, v144, v145
    v_cvt_pk_bf16_f32 v75, v146, v147
    s_nop 1
    s_mov_b64 vcc, -1
    s_cmp_eq_u32 s20, 0
    s_cbranch_scc1 L_pad8
    s_cmp_eq_u32 s20, 1
    s_cbranch_scc1 L_pad9
    s_cmp_eq_u32 s20, 2
    s_cbranch_scc1 L_touched2
    s_cmp_eq_u32 s20, 3
    s_cbranch_scc1 L_touched2
L_touched2:
    s_mov_b64 vcc, 0
    s_waitcnt vmcnt(8)
    s_barrier
    ds_read_b128 a[0:3], v2 offset:0
    ds_read_b128 a[4:7], v3 offset:0
    ds_read_b128 a[8:11], v2 offset:8192
    ds_read_b128 a[12:15], v3 offset:8192
    ds_read_b128 a[16:19], v2 offset:2048
    ds_read_b128 a[20:23], v3 offset:2048
    ds_read_b128 a[24:27], v2 offset:10240
    ds_read_b128 a[28:31], v3 offset:10240
    ds_read_b128 a[32:35], v2 offset:4096
    ds_read_b128 a[36:39], v3 offset:4096
    ds_read_b128 a[40:43], v2 offset:12288
    ds_read_b128 a[44:47], v3 offset:12288
    ds_read_b128 a[48:51], v2 offset:6144
    ds_read_b128 a[52:55], v3 offset:6144
    ds_read_b128 a[56:59], v2 offset:14336
    ds_read_b128 a[60:63], v3 offset:14336
    s_add_u32 s48, s24, 8192
    s_add_u32 m0, s3, 49152
    s_nop 0
    buffer_load_dwordx4 v244, s[4:7], s48 offen nt lds
    s_add_u32 m0, s3, 57216
    s_nop 0
    buffer_load_dwordx4 v244, s[4:7], s48 offen offset:128 nt lds
    s_add_u32 m0, s3, 50176
    s_nop 0
    buffer_load_dwordx4 v245, s[4:7], s48 offen nt lds
    s_add_u32 m0, s3, 58240
    s_nop 0
    buffer_load_dwordx4 v245, s[4:7], s48 offen offset:128 nt lds
    s_waitcnt lgkmcnt(15)
    v_mfma_f32_16x16x32_bf16 v[124:127], a[0:3], v[60:63], 0
    s_waitcnt lgkmcnt(14)
    v_mfma_f32_16x16x32_bf16 v[124:127], a[4:7], v[64:67], v[124:127]
    s_waitcnt lgkmcnt(13)
    v_mfma_f32_16x16x32_bf16 v[124:127], a[8:11], v[68:71], v[124:127]
    s_waitcnt lgkmcnt(12)
    v_mfma_f32_16x16x32_bf16 v[124:127], a[12:15], v[72:75], v[124:127]
    s_nop 7
    v_max3_f32 v124, v124, v125, v126
    v_max_f32 v124, v124, v127
    v_mov_b32 v125, v124
    s_nop 1
    v_permlane32_swap_b32 v125, v124
    v_max_f32 v124, v125, v124
    v_mov_b32 v125, v124
    s_nop 1
    v_permlane16_swap_b32 v125, v124
    v_min_f32 v12, -v125, -v124
    v_min_f32 v13, -v125, -v124
    v_min_f32 v14, -v125, -v124
    v_min_f32 v15, -v125, -v124
    s_nop 0
    s_nop 0
    v_mfma_f32_16x16x32_bf16 v[28:31], a[0:3], v[60:63], v[12:15]
    v_mfma_f32_16x16x32_bf16 v[28:31], a[4:7], v[64:67], v[28:31]
    v_mfma_f32_16x16x32_bf16 v[28:31], a[8:11], v[68:71], v[28:31]
    v_mfma_f32_16x16x32_bf16 v[28:31], a[12:15], v[72:75], v[28:31]
    s_waitcnt lgkmcnt(8)
    v_mfma_f32_16x16x32_bf16 v[32:35], a[28:31], v[72:75], v[12:15]
    v_mfma_f32_16x16x32_bf16 v[32:35], a[24:27], v[68:71], v[32:35]
    v_mfma_f32_16x16x32_bf16 v[32:35], a[20:23], v[64:67], v[32:35]
    v_mfma_f32_16x16x32_bf16 v[32:35], a[16:19], v[60:63], v[32:35]
    s_waitcnt lgkmcnt(7)
    s_nop 1
    v_exp_f32 v28, v28
    v_mfma_f32_16x16x32_bf16 v[36:39], a[32:35], v[60:63], v[12:15]
    s_waitcnt lgkmcnt(6)
    v_exp_f32 v29, v29
    v_mfma_f32_16x16x32_bf16 v[36:39], a[36:39], v[64:67], v[36:39]
    s_waitcnt lgkmcnt(5)
    v_exp_f32 v30, v30
    v_mfma_f32_16x16x32_bf16 v[36:39], a[40:43], v[68:71], v[36:39]
    s_waitcnt lgkmcnt(4)
    v_exp_f32 v31, v31
    v_mfma_f32_16x16x32_bf16 v[36:39], a[44:47], v[72:75], v[36:39]
    s_waitcnt lgkmcnt(0)
    v_exp_f32 v32, v32
    v_mfma_f32_16x16x32_bf16 v[40:43], a[60:63], v[72:75], v[12:15]
    v_exp_f32 v33, v33
    v_mfma_f32_16x16x32_bf16 v[40:43], a[56:59], v[68:71], v[40:43]
    v_exp_f32 v34, v34
    v_mfma_f32_16x16x32_bf16 v[40:43], a[52:55], v[64:67], v[40:43]
    v_exp_f32 v35, v35
    v_mfma_f32_16x16x32_bf16 v[40:43], a[48:51], v[60:63], v[40:43]
    v_exp_f32 v36, v36
    s_waitcnt vmcnt(8)
    ds_read_b128 v[156:159], v250 offset:32768
    ds_read_b128 v[160:163], v251 offset:32768
    ds_read_b128 v[164:167], v250 offset:40960
    ds_read_b128 v[168:171], v251 offset:40960
    s_add_u32 s48, s24, 12288
    s_add_u32 m0, s3, 114688
    s_nop 0
    buffer_load_dwordx4 v244, s[4:7], s48 offen nt lds
    s_waitcnt lgkmcnt(3)
    v_lshlrev_b32 v172, 16, v156
    v_lshlrev_b32 v174, 16, v157
    v_lshlrev_b32 v176, 16, v158
    v_lshlrev_b32 v178, 16, v159
    v_and_b32 v173, s31, v156
    v_and_b32 v175, s31, v157
    v_and_b32 v177, s31, v158
    v_and_b32 v179, s31, v159
    v_pk_mul_f32 v[172:173], v[172:173], s[28:29]
    v_pk_mul_f32 v[174:175], v[174:175], s[28:29]
    v_pk_mul_f32 v[176:177], v[176:177], s[28:29]
    v_pk_mul_f32 v[178:179], v[178:179], s[28:29]
    v_cvt_pk_bf16_f32 v76, v172, v173
    v_cvt_pk_bf16_f32 v77, v174, v175
    v_cvt_pk_bf16_f32 v78, v176, v177
    v_cvt_pk_bf16_f32 v79, v178, v179
    s_add_u32 m0, s3, 122752
    s_nop 0
    buffer_load_dwordx4 v244, s[4:7], s48 offen offset:128 nt lds
    s_waitcnt lgkmcnt(2)
    v_lshlrev_b32 v172, 16, v160
    v_lshlrev_b32 v174, 16, v161
    v_lshlrev_b32 v176, 16, v162
    v_lshlrev_b32 v178, 16, v163
    v_and_b32 v173, s31, v160
    v_and_b32 v175, s31, v161
    v_and_b32 v177, s31, v162
    v_and_b32 v179, s31, v163
    v_pk_mul_f32 v[172:173], v[172:173], s[28:29]
    v_pk_mul_f32 v[174:175], v[174:175], s[28:29]
    v_pk_mul_f32 v[176:177], v[176:177], s[28:29]
    v_pk_mul_f32 v[178:179], v[178:179], s[28:29]
    v_cvt_pk_bf16_f32 v80, v172, v173
    v_cvt_pk_bf16_f32 v81, v174, v175
    v_cvt_pk_bf16_f32 v82, v176, v177
    v_cvt_pk_bf16_f32 v83, v178, v179
    s_add_u32 m0, s3, 115712
    s_nop 0
    buffer_load_dwordx4 v245, s[4:7], s48 offen nt lds
    s_waitcnt lgkmcnt(1)
    v_lshlrev_b32 v172, 16, v164
    v_lshlrev_b32 v174, 16, v165
    v_lshlrev_b32 v176, 16, v166
    v_lshlrev_b32 v178, 16, v167
    v_and_b32 v173, s31, v164
    v_and_b32 v175, s31, v165
    v_and_b32 v177, s31, v166
    v_and_b32 v179, s31, v167
    v_pk_mul_f32 v[172:173], v[172:173], s[28:29]
    v_pk_mul_f32 v[174:175], v[174:175], s[28:29]
    v_pk_mul_f32 v[176:177], v[176:177], s[28:29]
    v_pk_mul_f32 v[178:179], v[178:179], s[28:29]
    v_cvt_pk_bf16_f32 v84, v172, v173
    v_cvt_pk_bf16_f32 v85, v174, v175
    v_cvt_pk_bf16_f32 v86, v176, v177
    v_cvt_pk_bf16_f32 v87, v178, v179
    s_add_u32 m0, s3, 123776
    s_nop 0
    buffer_load_dwordx4 v245, s[4:7], s48 offen offset:128 nt lds
    s_waitcnt lgkmcnt(0)
    v_lshlrev_b32 v172, 16, v168
    v_lshlrev_b32 v174, 16, v169
    v_lshlrev_b32 v176, 16, v170
    v_lshlrev_b32 v178, 16, v171
    v_and_b32 v173, s31, v168
    v_and_b32 v175, s31, v169
    v_and_b32 v177, s31, v170
    v_and_b32 v179, s31, v171
    v_pk_mul_f32 v[172:173], v[172:173], s[28:29]
    v_pk_mul_f32 v[174:175], v[174:175], s[28:29]
    v_pk_mul_f32 v[176:177], v[176:177], s[28:29]
    v_pk_mul_f32 v[178:179], v[178:179], s[28:29]
    v_cvt_pk_bf16_f32 v88, v172, v173
    v_cvt_pk_bf16_f32 v89, v174, v175
    v_cvt_pk_bf16_f32 v90, v176, v177
    v_cvt_pk_bf16_f32 v91, v178, v179
    s_nop 1
    v_mfma_f32_16x16x32_bf16 v[156:159], a[0:3], v[76:79], 0
    v_exp_f32 v37, v37
    v_mfma_f32_16x16x32_bf16 v[156:159], a[4:7], v[80:83], v[156:159]
    v_exp_f32 v38, v38
    v_mfma_f32_16x16x32_bf16 v[156:159], a[8:11], v[84:87], v[156:159]
    v_exp_f32 v39, v39
    v_mfma_f32_16x16x32_bf16 v[156:159], a[12:15], v[88:91], v[156:159]
    v_cvt_pk_bf16_f32 v44, v28, v29
    v_cvt_pk_bf16_f32 v45, v30, v31
    v_cvt_pk_bf16_f32 v46, v32, v33
    v_cvt_pk_bf16_f32 v47, v34, v35
    v_cvt_pk_bf16_f32 v48, v36, v37
    v_cvt_pk_bf16_f32 v49, v38, v39
    v_exp_f32 v40, v40
    v_exp_f32 v41, v41
    v_exp_f32 v42, v42
    v_exp_f32 v43, v43
    s_branch L_pad0
    .p2align 12
L_pad0:
    s_cbranch_vccnz L_touched0
    v_max3_f32 v156, v156, v157, v158
    v_max_f32 v156, v156, v159
    v_mov_b32 v157, v156
    s_nop 1
    v_permlane32_swap_b32 v157, v156
    v_max_f32 v156, v157, v156
    v_mov_b32 v157, v156
    s_nop 1
    v_permlane16_swap_b32 v157, v156
    v_min_f32 v16, -v157, -v156
    v_min_f32 v17, -v157, -v156
    v_min_f32 v18, -v157, -v156
    v_min_f32 v19, -v157, -v156
    s_waitcnt vmcnt(8)
    s_barrier
    v_mfma_f32_16x16x32_bf16 v[28:31], a[0:3], v[76:79], v[16:19]
    s_add_u32 s26, s22, 16384
    ds_read_b64_tr_b16 a[64:65], v4 offset:0
    ds_read_b64_tr_b16 a[66:67], v4 offset:2048
    v_mfma_f32_16x16x32_bf16 v[28:31], a[4:7], v[80:83], v[28:31]
    s_add_u32 s27, s22, 24576
    ds_read_b64_tr_b16 a[68:69], v4 offset:4096
    ds_read_b64_tr_b16 a[70:71], v4 offset:6144
    v_mfma_f32_16x16x32_bf16 v[28:31], a[8:11], v[84:87], v[28:31]
    s_add_u32 m0, s21, 16384
    ds_read_b64_tr_b16 a[72:73], v5 offset:0
    ds_read_b64_tr_b16 a[74:75], v5 offset:2048
    v_mfma_f32_16x16x32_bf16 v[28:31], a[12:15], v[88:91], v[28:31]
    ds_read_b64_tr_b16 a[76:77], v5 offset:4096
    ds_read_b64_tr_b16 a[78:79], v5 offset:6144
    v_mfma_f32_16x16x32_bf16 v[32:35], a[28:31], v[88:91], v[16:19]
    buffer_load_dwordx4 v0, s[8:11], s26 offen nt lds
    ds_read_b64_tr_b16 a[80:81], v6 offset:0
    ds_read_b64_tr_b16 a[82:83], v6 offset:2048
    v_mfma_f32_16x16x32_bf16 v[32:35], a[24:27], v[84:87], v[32:35]
    s_add_u32 m0, s21, 24448
    ds_read_b64_tr_b16 a[84:85], v6 offset:4096
    ds_read_b64_tr_b16 a[86:87], v6 offset:6144
    v_mfma_f32_16x16x32_bf16 v[32:35], a[20:23], v[80:83], v[32:35]
    ds_read_b64_tr_b16 a[88:89], v7 offset:0
    ds_read_b64_tr_b16 a[90:91], v7 offset:2048
    v_mfma_f32_16x16x32_bf16 v[32:35], a[16:19], v[76:79], v[32:35]
    buffer_load_dwordx4 v0, s[8:11], s26 offen offset:128 nt lds
    ds_read_b64_tr_b16 a[92:93], v7 offset:4096
    ds_read_b64_tr_b16 a[94:95], v7 offset:6144
    v_mfma_f32_16x16x32_bf16 v[36:39], a[32:35], v[76:79], v[16:19]
    s_add_u32 m0, s21, 20480
    ds_read_b64_tr_b16 a[96:97], v4 offset:8192
    ds_read_b64_tr_b16 a[98:99], v4 offset:10240
    v_mfma_f32_16x16x32_bf16 v[36:39], a[36:39], v[80:83], v[36:39]
    ds_read_b64_tr_b16 a[100:101], v4 offset:12288
    ds_read_b64_tr_b16 a[102:103], v4 offset:14336
    v_mfma_f32_16x16x32_bf16 v[36:39], a[40:43], v[84:87], v[36:39]
    buffer_load_dwordx4 v0, s[8:11], s27 offen nt lds
    ds_read_b64_tr_b16 a[104:105], v5 offset:8192
    ds_read_b64_tr_b16 a[106:107], v5 offset:10240
    v_mfma_f32_16x16x32_bf16 v[36:39], a[44:47], v[88:91], v[36:39]
    s_add_u32 m0, s21, 28544
    ds_read_b64_tr_b16 a[108:109], v5 offset:12288
    ds_read_b64_tr_b16 a[110:111], v5 offset:14336
    v_cvt_pk_bf16_f32 v50, v40, v41
    v_cvt_pk_bf16_f32 v51, v42, v43
    v_mfma_f32_16x16x32_bf16 v[40:43], a[60:63], v[88:91], v[16:19]
    ds_read_b64_tr_b16 a[112:113], v6 offset:8192
    ds_read_b64_tr_b16 a[114:115], v6 offset:10240
    v_mfma_f32_16x16x32_bf16 v[40:43], a[56:59], v[84:87], v[40:43]
    buffer_load_dwordx4 v0, s[8:11], s27 offen offset:128 nt lds
    ds_read_b64_tr_b16 a[116:117], v6 offset:12288
    ds_read_b64_tr_b16 a[118:119], v6 offset:14336
    v_mfma_f32_16x16x32_bf16 v[40:43], a[52:55], v[80:83], v[40:43]
    ds_read_b64_tr_b16 a[120:121], v7 offset:8192
    ds_read_b64_tr_b16 a[122:123], v7 offset:10240
    v_mfma_f32_16x16x32_bf16 v[40:43], a[48:51], v[76:79], v[40:43]
    ds_read_b64_tr_b16 a[124:125], v7 offset:12288
    ds_read_b64_tr_b16 a[126:127], v7 offset:14336
    v_mfma_f32_16x16x32_bf16 a[196:199], a[192:195], v[44:47], 0
    v_exp_f32 v28, v28
    v_mfma_f32_16x16x32_bf16 a[196:199], a[192:195], v[48:51], a[196:199]
    s_waitcnt lgkmcnt(15)
    v_exp_f32 v29, v29
    v_mfma_f32_16x16x32_bf16 v[124:127], a[68:71], v[48:51], 0
    v_exp_f32 v30, v30
    v_mfma_f32_16x16x32_bf16 v[124:127], a[64:67], v[44:47], v[124:127]
    v_exp_f32 v31, v31
    v_mfma_f32_16x16x32_bf16 v[128:131], a[72:75], v[44:47], 0
    v_cvt_pk_bf16_f32 v52, v28, v29
    v_cvt_pk_bf16_f32 v53, v30, v31
    v_mfma_f32_16x16x32_bf16 v[128:131], a[76:79], v[48:51], v[128:131]
    v_exp_f32 v32, v32
    v_mfma_f32_16x16x32_bf16 v[132:135], a[84:87], v[48:51], 0
    v_exp_f32 v33, v33
    v_mfma_f32_16x16x32_bf16 v[132:135], a[80:83], v[44:47], v[132:135]
    v_exp_f32 v34, v34
    v_mfma_f32_16x16x32_bf16 v[136:139], a[88:91], v[44:47], 0
    v_exp_f32 v35, v35
    v_mfma_f32_16x16x32_bf16 v[136:139], a[92:95], v[48:51], v[136:139]
    s_waitcnt lgkmcnt(0)
    v_cvt_pk_bf16_f32 v54, v32, v33
    v_cvt_pk_bf16_f32 v55, v34, v35
    v_mfma_f32_16x16x32_bf16 v[140:143], a[100:103], v[48:51], 0
    v_exp_f32 v36, v36
    v_mfma_f32_16x16x32_bf16 v[140:143], a[96:99], v[44:47], v[140:143]
    v_exp_f32 v37, v37
    v_mfma_f32_16x16x32_bf16 v[144:147], a[104:107], v[44:47], 0
    v_exp_f32 v38, v38
    v_mfma_f32_16x16x32_bf16 v[144:147], a[108:111], v[48:51], v[144:147]
    v_exp_f32 v39, v39
    v_mfma_f32_16x16x32_bf16 v[148:151], a[116:119], v[48:51], 0
    v_cvt_pk_bf16_f32 v56, v36, v37
    v_cvt_pk_bf16_f32 v57, v38, v39
    v_mfma_f32_16x16x32_bf16 v[148:151], a[112:115], v[44:47], v[148:151]
    v_exp_f32 v40, v40
    v_mfma_f32_16x16x32_bf16 v[152:155], a[120:123], v[44:47], 0
    v_exp_f32 v41, v41
    v_mfma_f32_16x16x32_bf16 v[152:155], a[124:127], v[48:51], v[152:155]
    v_exp_f32 v42, v42
    s_waitcnt vmcnt(8)
    ds_read_b128 v[188:191], v248 offset:49152
    ds_read_b128 v[192:195], v249 offset:49152
    ds_read_b128 v[196:199], v248 offset:57344
    ds_read_b128 v[200:203], v249 offset:57344
    s_add_u32 s26, s22, 16384
    s_add_u32 s27, s22, 24576
    s_add_u32 m0, s21, 81920
    s_nop 0
    buffer_load_dwordx4 v0, s[12:15], s26 offen nt lds
    s_waitcnt lgkmcnt(3)
    v_lshlrev_b32 v204, 16, v188
    v_lshlrev_b32 v206, 16, v189
    v_lshlrev_b32 v208, 16, v190
    v_lshlrev_b32 v210, 16, v191
    v_and_b32 v205, s31, v188
    v_and_b32 v207, s31, v189
    v_and_b32 v209, s31, v190
    v_and_b32 v211, s31, v191
    v_pk_mul_f32 v[204:205], v[204:205], s[28:29]
    v_pk_mul_f32 v[206:207], v[206:207], s[28:29]
    v_pk_mul_f32 v[208:209], v[208:209], s[28:29]
    v_pk_mul_f32 v[210:211], v[210:211], s[28:29]
    v_cvt_pk_bf16_f32 v92, v204, v205
    v_cvt_pk_bf16_f32 v93, v206, v207
    v_cvt_pk_bf16_f32 v94, v208, v209
    v_cvt_pk_bf16_f32 v95, v210, v211
    s_add_u32 m0, s21, 89984
    s_nop 0
    buffer_load_dwordx4 v0, s[12:15], s26 offen offset:128 nt lds
    s_waitcnt lgkmcnt(2)
    v_lshlrev_b32 v204, 16, v192
    v_lshlrev_b32 v206, 16, v193
    v_lshlrev_b32 v208, 16, v194
    v_lshlrev_b32 v210, 16, v195
    v_and_b32 v205, s31, v192
    v_and_b32 v207, s31, v193
    v_and_b32 v209, s31, v194
    v_and_b32 v211, s31, v195
    v_pk_mul_f32 v[204:205], v[204:205], s[28:29]
    v_pk_mul_f32 v[206:207], v[206:207], s[28:29]
    v_pk_mul_f32 v[208:209], v[208:209], s[28:29]
    v_pk_mul_f32 v[210:211], v[210:211], s[28:29]
    v_cvt_pk_bf16_f32 v96, v204, v205
    v_cvt_pk_bf16_f32 v97, v206, v207
    v_cvt_pk_bf16_f32 v98, v208, v209
    v_cvt_pk_bf16_f32 v99, v210, v211
    s_add_u32 m0, s21, 86016
    s_nop 0
    buffer_load_dwordx4 v0, s[12:15], s27 offen nt lds
    s_waitcnt lgkmcnt(1)
    v_lshlrev_b32 v204, 16, v196
    v_lshlrev_b32 v206, 16, v197
    v_lshlrev_b32 v208, 16, v198
    v_lshlrev_b32 v210, 16, v199
    v_and_b32 v205, s31, v196
    v_and_b32 v207, s31, v197
    v_and_b32 v209, s31, v198
    v_and_b32 v211, s31, v199
    v_pk_mul_f32 v[204:205], v[204:205], s[28:29]
    v_pk_mul_f32 v[206:207], v[206:207], s[28:29]
    v_pk_mul_f32 v[208:209], v[208:209], s[28:29]
    v_pk_mul_f32 v[210:211], v[210:211], s[28:29]
    v_cvt_pk_bf16_f32 v100, v204, v205
    v_cvt_pk_bf16_f32 v101, v206, v207
    v_cvt_pk_bf16_f32 v102, v208, v209
    v_cvt_pk_bf16_f32 v103, v210, v211
    s_add_u32 m0, s21, 94080
    s_nop 0
    buffer_load_dwordx4 v0, s[12:15], s27 offen offset:128 nt lds
    s_waitcnt lgkmcnt(0)
    v_lshlrev_b32 v204, 16, v200
    v_lshlrev_b32 v206, 16, v201
    v_lshlrev_b32 v208, 16, v202
    v_lshlrev_b32 v210, 16, v203
    v_and_b32 v205, s31, v200
    v_and_b32 v207, s31, v201
    v_and_b32 v209, s31, v202
    v_and_b32 v211, s31, v203
    v_pk_mul_f32 v[204:205], v[204:205], s[28:29]
    v_pk_mul_f32 v[206:207], v[206:207], s[28:29]
    v_pk_mul_f32 v[208:209], v[208:209], s[28:29]
    v_pk_mul_f32 v[210:211], v[210:211], s[28:29]
    v_cvt_pk_bf16_f32 v104, v204, v205
    v_cvt_pk_bf16_f32 v105, v206, v207
    v_cvt_pk_bf16_f32 v106, v208, v209
    v_cvt_pk_bf16_f32 v107, v210, v211
    s_nop 1
    v_mfma_f32_16x16x32_bf16 v[188:191], a[0:3], v[92:95], 0
    v_exp_f32 v43, v43
    v_mfma_f32_16x16x32_bf16 v[188:191], a[4:7], v[96:99], v[188:191]
    v_cvt_pk_bf16_f32 v58, v40, v41
    v_cvt_pk_bf16_f32 v59, v42, v43
    v_mfma_f32_16x16x32_bf16 v[188:191], a[8:11], v[100:103], v[188:191]
    v_mfma_f32_16x16x32_bf16 v[188:191], a[12:15], v[104:107], v[188:191]
    s_nop 7
    v_max3_f32 v188, v188, v189, v190
    v_max_f32 v188, v188, v191
    v_mov_b32 v189, v188
    s_nop 1
    v_permlane32_swap_b32 v189, v188
    v_max_f32 v188, v189, v188
    v_mov_b32 v189, v188
    s_nop 1
    v_permlane16_swap_b32 v189, v188
    v_min_f32 v20, -v189, -v188
    v_min_f32 v21, -v189, -v188
    v_min_f32 v22, -v189, -v188
    v_min_f32 v23, -v189, -v188
    s_nop 1
    v_mfma_f32_16x16x32_bf16 v[28:31], a[0:3], v[92:95], v[20:23]
    v_mfma_f32_16x16x32_bf16 v[28:31], a[4:7], v[96:99], v[28:31]
    v_mfma_f32_16x16x32_bf16 v[28:31], a[8:11], v[100:103], v[28:31]
    v_mfma_f32_16x16x32_bf16 v[28:31], a[12:15], v[104:107], v[28:31]
    v_mfma_f32_16x16x32_bf16 v[32:35], a[28:31], v[104:107], v[20:23]
    v_mfma_f32_16x16x32_bf16 v[32:35], a[24:27], v[100:103], v[32:35]
    v_mfma_f32_16x16x32_bf16 v[32:35], a[20:23], v[96:99], v[32:35]
    v_mfma_f32_16x16x32_bf16 v[32:35], a[16:19], v[92:95], v[32:35]
    s_nop 3
    v_exp_f32 v28, v28
    v_mfma_f32_16x16x32_bf16 v[36:39], a[32:35], v[92:95], v[20:23]
    v_exp_f32 v29, v29
    v_mfma_f32_16x16x32_bf16 v[36:39], a[36:39], v[96:99], v[36:39]
    v_exp_f32 v30, v30
    v_mfma_f32_16x16x32_bf16 v[36:39], a[40:43], v[100:103], v[36:39]
    v_exp_f32 v31, v31
    v_mfma_f32_16x16x32_bf16 v[36:39], a[44:47], v[104:107], v[36:39]
    v_cvt_pk_bf16_f32 v44, v28, v29
    v_cvt_pk_bf16_f32 v45, v30, v31
    v_mfma_f32_16x16x32_bf16 v[40:43], a[60:63], v[104:107], v[20:23]
    v_exp_f32 v32, v32
    v_mfma_f32_16x16x32_bf16 v[40:43], a[56:59], v[100:103], v[40:43]
    v_exp_f32 v33, v33
    v_mfma_f32_16x16x32_bf16 v[40:43], a[52:55], v[96:99], v[40:43]
    v_exp_f32 v34, v34
    v_mfma_f32_16x16x32_bf16 v[40:43], a[48:51], v[92:95], v[40:43]
    v_exp_f32 v35, v35
    v_mfma_f32_16x16x32_bf16 a[200:203], a[192:195], v[52:55], 0
    v_cvt_pk_bf16_f32 v46, v32, v33
    v_cvt_pk_bf16_f32 v47, v34, v35
    v_mfma_f32_16x16x32_bf16 a[200:203], a[192:195], v[56:59], a[200:203]
    v_exp_f32 v36, v36
    v_mfma_f32_16x16x32_bf16 v[156:159], a[68:71], v[56:59], 0
    v_exp_f32 v37, v37
    v_mfma_f32_16x16x32_bf16 v[156:159], a[64:67], v[52:55], v[156:159]
    v_exp_f32 v38, v38
    v_mfma_f32_16x16x32_bf16 v[160:163], a[72:75], v[52:55], 0
    v_exp_f32 v39, v39
    v_mfma_f32_16x16x32_bf16 v[160:163], a[76:79], v[56:59], v[160:163]
    v_cvt_pk_bf16_f32 v48, v36, v37
    v_cvt_pk_bf16_f32 v49, v38, v39
    v_mfma_f32_16x16x32_bf16 v[164:167], a[84:87], v[56:59], 0
    v_exp_f32 v40, v40
    v_mfma_f32_16x16x32_bf16 v[164:167], a[80:83], v[52:55], v[164:167]
    v_exp_f32 v41, v41
    v_mfma_f32_16x16x32_bf16 v[168:171], a[88:91], v[52:55], 0
    v_exp_f32 v42, v42
    v_mfma_f32_16x16x32_bf16 v[168:171], a[92:95], v[56:59], v[168:171]
    v_exp_f32 v43, v43
    v_mfma_f32_16x16x32_bf16 v[172:175], a[100:103], v[56:59], 0
    v_cvt_pk_bf16_f32 v50, v40, v41
    v_cvt_pk_bf16_f32 v51, v42, v43
    v_mfma_f32_16x16x32_bf16 v[172:175], a[96:99], v[52:55], v[172:175]
    v_mfma_f32_16x16x32_bf16 v[176:179], a[104:107], v[52:55], 0
    v_mfma_f32_16x16x32_bf16 v[176:179], a[108:111], v[56:59], v[176:179]
    v_mfma_f32_16x16x32_bf16 v[180:183], a[116:119], v[56:59], 0
    v_mfma_f32_16x16x32_bf16 v[180:183], a[112:115], v[52:55], v[180:183]
    v_mfma_f32_16x16x32_bf16 v[184:187], a[120:123], v[52:55], 0
    s_add_u32 s26, s22, 32768
    v_mfma_f32_16x16x32_bf16 v[184:187], a[124:127], v[56:59], v[184:187]
    s_add_u32 s27, s22, 40960
    s_waitcnt vmcnt(8)
    ds_read_b128 v[220:223], v250 offset:49152
    ds_read_b128 v[224:227], v251 offset:49152
    ds_read_b128 v[228:231], v250 offset:57344
    ds_read_b128 v[232:235], v251 offset:57344
    s_waitcnt lgkmcnt(3)
    v_lshlrev_b32 v236, 16, v220
    v_lshlrev_b32 v238, 16, v221
    v_lshlrev_b32 v240, 16, v222
    v_lshlrev_b32 v242, 16, v223
    v_and_b32 v237, s31, v220
    v_and_b32 v239, s31, v221
    v_and_b32 v241, s31, v222
    v_and_b32 v243, s31, v223
    v_pk_mul_f32 v[236:237], v[236:237], s[28:29]
    v_pk_mul_f32 v[238:239], v[238:239], s[28:29]
    v_pk_mul_f32 v[240:241], v[240:241], s[28:29]
    v_pk_mul_f32 v[242:243], v[242:243], s[28:29]
    v_cvt_pk_bf16_f32 v108, v236, v237
    v_cvt_pk_bf16_f32 v109, v238, v239
    v_cvt_pk_bf16_f32 v110, v240, v241
    v_cvt_pk_bf16_f32 v111, v242, v243
    s_waitcnt lgkmcnt(2)
    v_lshlrev_b32 v236, 16, v224
    v_lshlrev_b32 v238, 16, v225
    v_lshlrev_b32 v240, 16, v226
    v_lshlrev_b32 v242, 16, v227
    v_and_b32 v237, s31, v224
    v_and_b32 v239, s31, v225
    v_and_b32 v241, s31, v226
    v_and_b32 v243, s31, v227
    v_pk_mul_f32 v[236:237], v[236:237], s[28:29]
    v_pk_mul_f32 v[238:239], v[238:239], s[28:29]
    v_pk_mul_f32 v[240:241], v[240:241], s[28:29]
    v_pk_mul_f32 v[242:243], v[242:243], s[28:29]
    v_cvt_pk_bf16_f32 v112, v236, v237
    v_cvt_pk_bf16_f32 v113, v238, v239
    v_cvt_pk_bf16_f32 v114, v240, v241
    v_cvt_pk_bf16_f32 v115, v242, v243
    s_waitcnt lgkmcnt(1)
    v_lshlrev_b32 v236, 16, v228
    v_lshlrev_b32 v238, 16, v229
    v_lshlrev_b32 v240, 16, v230
    v_lshlrev_b32 v242, 16, v231
    v_and_b32 v237, s31, v228
    v_and_b32 v239, s31, v229
    v_and_b32 v241, s31, v230
    v_and_b32 v243, s31, v231
    v_pk_mul_f32 v[236:237], v[236:237], s[28:29]
    v_pk_mul_f32 v[238:239], v[238:239], s[28:29]
    v_pk_mul_f32 v[240:241], v[240:241], s[28:29]
    v_pk_mul_f32 v[242:243], v[242:243], s[28:29]
    v_cvt_pk_bf16_f32 v116, v236, v237
    v_cvt_pk_bf16_f32 v117, v238, v239
    v_cvt_pk_bf16_f32 v118, v240, v241
    v_cvt_pk_bf16_f32 v119, v242, v243
    s_waitcnt lgkmcnt(0)
    v_lshlrev_b32 v236, 16, v232
    v_lshlrev_b32 v238, 16, v233
    v_lshlrev_b32 v240, 16, v234
    v_lshlrev_b32 v242, 16, v235
    v_and_b32 v237, s31, v232
    v_and_b32 v239, s31, v233
    v_and_b32 v241, s31, v234
    v_and_b32 v243, s31, v235
    v_pk_mul_f32 v[236:237], v[236:237], s[28:29]
    v_pk_mul_f32 v[238:239], v[238:239], s[28:29]
    v_pk_mul_f32 v[240:241], v[240:241], s[28:29]
    v_pk_mul_f32 v[242:243], v[242:243], s[28:29]
    v_cvt_pk_bf16_f32 v120, v236, v237
    v_cvt_pk_bf16_f32 v121, v238, v239
    v_cvt_pk_bf16_f32 v122, v240, v241
    v_cvt_pk_bf16_f32 v123, v242, v243
    s_nop 1
    v_mfma_f32_16x16x32_bf16 v[220:223], a[0:3], v[108:111], 0
    s_add_u32 m0, s21, 32768
    v_mfma_f32_16x16x32_bf16 v[220:223], a[4:7], v[112:115], v[220:223]
    v_mfma_f32_16x16x32_bf16 v[220:223], a[8:11], v[116:119], v[220:223]
    v_mfma_f32_16x16x32_bf16 v[220:223], a[12:15], v[120:123], v[220:223]
    s_nop 7
    v_max3_f32 v220, v220, v221, v222
    v_max_f32 v220, v220, v223
    v_mov_b32 v221, v220
    s_nop 1
    v_permlane32_swap_b32 v221, v220
    v_max_f32 v220, v221, v220
    v_mov_b32 v221, v220
    s_nop 1
    v_permlane16_swap_b32 v221, v220
    v_min_f32 v24, -v221, -v220
    v_min_f32 v25, -v221, -v220
    v_min_f32 v26, -v221, -v220
    v_min_f32 v27, -v221, -v220
    s_nop 1
    v_mfma_f32_16x16x32_bf16 v[28:31], a[0:3], v[108:111], v[24:27]
    s_waitcnt vmcnt(4)
    s_barrier
    v_mfma_f32_16x16x32_bf16 v[28:31], a[4:7], v[112:115], v[28:31]
    ds_read_b128 a[0:3], v2 offset:16384
    v_mfma_f32_16x16x32_bf16 v[28:31], a[8:11], v[116:119], v[28:31]
    ds_read_b128 a[4:7], v3 offset:16384
    v_mfma_f32_16x16x32_bf16 v[28:31], a[12:15], v[120:123], v[28:31]
    buffer_load_dwordx4 v0, s[8:11], s26 offen nt lds
    v_mfma_f32_16x16x32_bf16 v[32:35], a[28:31], v[120:123], v[24:27]
    s_add_u32 m0, s21, 40832
    ds_read_b128 a[8:11], v2 offset:24576
    v_mfma_f32_16x16x32_bf16 v[32:35], a[24:27], v[116:119], v[32:35]
    ds_read_b128 a[12:15], v3 offset:24576
    v_mfma_f32_16x16x32_bf16 v[32:35], a[20:23], v[112:115], v[32:35]
    ds_read_b128 a[28:31], v3 offset:26624
    v_mfma_f32_16x16x32_bf16 v[32:35], a[16:19], v[108:111], v[32:35]
    v_exp_f32 v28, v28
    v_mfma_f32_16x16x32_bf16 v[36:39], a[32:35], v[108:111], v[24:27]
    v_exp_f32 v29, v29
    v_mfma_f32_16x16x32_bf16 v[36:39], a[36:39], v[112:115], v[36:39]
    v_exp_f32 v30, v30
    v_mfma_f32_16x16x32_bf16 v[36:39], a[40:43], v[116:119], v[36:39]
    v_exp_f32 v31, v31
    v_mfma_f32_16x16x32_bf16 v[36:39], a[44:47], v[120:123], v[36:39]
    buffer_load_dwordx4 v0, s[8:11], s26 offen offset:128 nt lds
    v_mfma_f32_16x16x32_bf16 v[40:43], a[60:63], v[120:123], v[24:27]
    ds_read_b128 a[24:27], v2 offset:26624
    v_cvt_pk_bf16_f32 v52, v28, v29
    v_mfma_f32_16x16x32_bf16 v[40:43], a[56:59], v[116:119], v[40:43]
    s_add_u32 m0, s21, 36864
    ds_read_b128 a[20:23], v3 offset:18432
    v_cvt_pk_bf16_f32 v53, v30, v31
    v_mfma_f32_16x16x32_bf16 v[40:43], a[52:55], v[112:115], v[40:43]
    v_exp_f32 v32, v32
    v_mfma_f32_16x16x32_bf16 v[40:43], a[48:51], v[108:111], v[40:43]
    v_exp_f32 v33, v33
    v_mfma_f32_16x16x32_bf16 a[204:207], a[192:195], v[44:47], 0
    v_exp_f32 v34, v34
    v_mfma_f32_16x16x32_bf16 a[204:207], a[192:195], v[48:51], a[204:207]
    v_exp_f32 v35, v35
    v_mfma_f32_16x16x32_bf16 v[188:191], a[68:71], v[48:51], 0
    ds_read_b128 a[16:19], v2 offset:18432
    v_cvt_pk_bf16_f32 v54, v32, v33
    v_mfma_f32_16x16x32_bf16 v[188:191], a[64:67], v[44:47], v[188:191]
    ds_read_b128 a[32:35], v2 offset:20480
    v_cvt_pk_bf16_f32 v55, v34, v35
    v_mfma_f32_16x16x32_bf16 v[192:195], a[72:75], v[44:47], 0
    buffer_load_dwordx4 v0, s[8:11], s27 offen nt lds
    v_mfma_f32_16x16x32_bf16 v[192:195], a[76:79], v[48:51], v[192:195]
    s_add_u32 m0, s21, 44928
    v_exp_f32 v36, v36
    v_mfma_f32_16x16x32_bf16 v[196:199], a[84:87], v[48:51], 0
    v_exp_f32 v37, v37
    v_mfma_f32_16x16x32_bf16 v[196:199], a[80:83], v[44:47], v[196:199]
    v_exp_f32 v38, v38
    v_mfma_f32_16x16x32_bf16 v[200:203], a[88:91], v[44:47], 0
    v_exp_f32 v39, v39
    v_mfma_f32_16x16x32_bf16 v[200:203], a[92:95], v[48:51], v[200:203]
    ds_read_b128 a[36:39], v3 offset:20480
    v_cvt_pk_bf16_f32 v56, v36, v37
    v_mfma_f32_16x16x32_bf16 v[204:207], a[100:103], v[48:51], 0
    ds_read_b128 a[40:43], v2 offset:28672
    v_cvt_pk_bf16_f32 v57, v38, v39
    v_mfma_f32_16x16x32_bf16 v[204:207], a[96:99], v[44:47], v[204:207]
    v_exp_f32 v40, v40
    v_mfma_f32_16x16x32_bf16 v[208:211], a[104:107], v[44:47], 0
    buffer_load_dwordx4 v0, s[8:11], s27 offen offset:128 nt lds
    v_mfma_f32_16x16x32_bf16 v[208:211], a[108:111], v[48:51], v[208:211]
    v_exp_f32 v41, v41
    v_mfma_f32_16x16x32_bf16 v[212:215], a[116:119], v[48:51], 0
    s_add_u32 m0, s21, 98304
    v_exp_f32 v42, v42
    v_mfma_f32_16x16x32_bf16 v[212:215], a[112:115], v[44:47], v[212:215]
    v_exp_f32 v43, v43
    v_mfma_f32_16x16x32_bf16 v[216:219], a[120:123], v[44:47], 0
    ds_read_b128 a[44:47], v3 offset:28672
    v_cvt_pk_bf16_f32 v58, v40, v41
    v_mfma_f32_16x16x32_bf16 v[216:219], a[124:127], v[48:51], v[216:219]
    s_waitcnt lgkmcnt(3)
    ds_read_b128 a[60:63], v3 offset:30720
    v_cvt_pk_bf16_f32 v59, v42, v43
    v_mfma_f32_16x16x32_bf16 v[28:31], a[0:3], v[60:63], v[12:15]
    ds_read_b128 a[56:59], v2 offset:30720
    v_mfma_f32_16x16x32_bf16 v[28:31], a[4:7], v[64:67], v[28:31]
    ds_read_b128 a[52:55], v3 offset:22528
    v_mfma_f32_16x16x32_bf16 v[28:31], a[8:11], v[68:71], v[28:31]
    ds_read_b128 a[48:51], v2 offset:22528
    v_mfma_f32_16x16x32_bf16 v[28:31], a[12:15], v[72:75], v[28:31]
    buffer_load_dwordx4 v0, s[12:15], s26 offen nt lds
    v_mfma_f32_16x16x32_bf16 v[32:35], a[28:31], v[72:75], v[12:15]
    s_add_u32 m0, s21, 106368
    v_mfma_f32_16x16x32_bf16 v[32:35], a[24:27], v[68:71], v[32:35]
    v_mfma_f32_16x16x32_bf16 v[32:35], a[20:23], v[64:67], v[32:35]
    v_mfma_f32_16x16x32_bf16 v[32:35], a[16:19], v[60:63], v[32:35]
    s_nop 1
    v_exp_f32 v28, v28
    v_mfma_f32_16x16x32_bf16 v[36:39], a[32:35], v[60:63], v[12:15]
    s_waitcnt lgkmcnt(4)
    v_exp_f32 v29, v29
    v_mfma_f32_16x16x32_bf16 v[36:39], a[36:39], v[64:67], v[36:39]
    v_exp_f32 v30, v30
    v_mfma_f32_16x16x32_bf16 v[36:39], a[40:43], v[68:71], v[36:39]
    v_exp_f32 v31, v31
    v_mfma_f32_16x16x32_bf16 v[36:39], a[44:47], v[72:75], v[36:39]
    s_waitcnt lgkmcnt(1)
    buffer_load_dwordx4 v0, s[12:15], s26 offen offset:128 nt lds
    v_mfma_f32_16x16x32_bf16 v[40:43], a[60:63], v[72:75], v[12:15]
    v_exp_f32 v32, v32
    v_mfma_f32_16x16x32_bf16 v[40:43], a[56:59], v[68:71], v[40:43]
    s_add_u32 m0, s21, 102400
    v_exp_f32 v33, v33
    v_mfma_f32_16x16x32_bf16 v[40:43], a[52:55], v[64:67], v[40:43]
    s_waitcnt lgkmcnt(0)
    v_exp_f32 v34, v34
    v_mfma_f32_16x16x32_bf16 v[40:43], a[48:51], v[60:63], v[40:43]
    v_exp_f32 v35, v35
    v_mfma_f32_16x16x32_bf16 a[208:211], a[192:195], v[52:55], 0
    v_exp_f32 v36, v36
    v_mfma_f32_16x16x32_bf16 a[208:211], a[192:195], v[56:59], a[208:211]
    s_waitcnt vmcnt(6)
    s_barrier
    v_mfma_f32_16x16x32_bf16 v[220:223], a[68:71], v[56:59], 0
    ds_read_b64_tr_b16 a[68:69], v4 offset:20480
    v_cvt_pk_bf16_f32 v44, v28, v29
    v_mfma_f32_16x16x32_bf16 v[220:223], a[64:67], v[52:55], v[220:223]
    ds_read_b64_tr_b16 a[70:71], v4 offset:22528
    v_cvt_pk_bf16_f32 v45, v30, v31
    v_mfma_f32_16x16x32_bf16 v[224:227], a[72:75], v[52:55], 0
    buffer_load_dwordx4 v0, s[12:15], s27 offen nt lds
    v_mfma_f32_16x16x32_bf16 v[224:227], a[76:79], v[56:59], v[224:227]
    s_add_u32 m0, s21, 110464
    ds_read_b64_tr_b16 a[64:65], v4 offset:16384
    v_cvt_pk_bf16_f32 v46, v32, v33
    v_mfma_f32_16x16x32_bf16 v[228:231], a[84:87], v[56:59], 0
    ds_read_b64_tr_b16 a[66:67], v4 offset:18432
    v_cvt_pk_bf16_f32 v47, v34, v35
    v_mfma_f32_16x16x32_bf16 v[228:231], a[80:83], v[52:55], v[228:231]
    v_exp_f32 v37, v37
    v_mfma_f32_16x16x32_bf16 v[232:235], a[88:91], v[52:55], 0
    v_exp_f32 v38, v38
    v_mfma_f32_16x16x32_bf16 v[232:235], a[92:95], v[56:59], v[232:235]
    v_exp_f32 v39, v39
    v_mfma_f32_16x16x32_bf16 v[236:239], a[100:103], v[56:59], 0
    ds_read_b64_tr_b16 a[72:73], v5 offset:16384
    v_cvt_pk_bf16_f32 v48, v36, v37
    v_mfma_f32_16x16x32_bf16 v[236:239], a[96:99], v[52:55], v[236:239]
    ds_read_b64_tr_b16 a[74:75], v5 offset:18432
    v_cvt_pk_bf16_f32 v49, v38, v39
    v_mfma_f32_16x16x32_bf16 v[240:243], a[104:107], v[52:55], 0
    buffer_load_dwordx4 v0, s[12:15], s27 offen offset:128 nt lds
    v_mfma_f32_16x16x32_bf16 v[240:243], a[108:111], v[56:59], v[240:243]
    s_add_u32 s26, s22, 49152
    v_exp_f32 v40, v40
    v_mfma_f32_16x16x32_bf16 v[244:247], a[116:119], v[56:59], 0
    s_add_u32 s27, s22, 57344
    v_exp_f32 v41, v41
    v_mfma_f32_16x16x32_bf16 v[244:247], a[112:115], v[52:55], v[244:247]
    s_add_u32 m0, s21, 49152
    v_exp_f32 v42, v42
    v_mfma_f32_16x16x32_bf16 v[248:251], a[120:123], v[52:55], 0
    ds_read_b64_tr_b16 a[76:77], v5 offset:20480
    v_cvt_pk_bf16_f32 v50, v40, v41
    v_mfma_f32_16x16x32_bf16 v[248:251], a[124:127], v[56:59], v[248:251]
    ds_read_b64_tr_b16 a[78:79], v5 offset:22528
    v_exp_f32 v43, v43
    v_mfma_f32_16x16x32_bf16 v[28:31], a[0:3], v[76:79], v[16:19]
    ds_read_b64_tr_b16 a[84:85], v6 offset:20480
    v_cvt_pk_bf16_f32 v51, v42, v43
    v_mfma_f32_16x16x32_bf16 v[28:31], a[4:7], v[80:83], v[28:31]
    ds_read_b64_tr_b16 a[86:87], v6 offset:22528
    v_mfma_f32_16x16x32_bf16 v[28:31], a[8:11], v[84:87], v[28:31]
    ds_read_b64_tr_b16 a[80:81], v6 offset:16384
    v_mfma_f32_16x16x32_bf16 v[28:31], a[12:15], v[88:91], v[28:31]
    ds_read_b64_tr_b16 a[82:83], v6 offset:18432
    buffer_load_dwordx4 v0, s[8:11], s26 offen nt lds
    v_mfma_f32_16x16x32_bf16 v[32:35], a[28:31], v[88:91], v[16:19]
    ds_read_b64_tr_b16 a[88:89], v7 offset:16384
    v_mfma_f32_16x16x32_bf16 v[32:35], a[24:27], v[84:87], v[32:35]
    ds_read_b64_tr_b16 a[90:91], v7 offset:18432
    v_mfma_f32_16x16x32_bf16 v[32:35], a[20:23], v[80:83], v[32:35]
    ds_read_b64_tr_b16 a[92:93], v7 offset:20480
    v_mfma_f32_16x16x32_bf16 v[32:35], a[16:19], v[76:79], v[32:35]
    ds_read_b64_tr_b16 a[94:95], v7 offset:22528
    v_mfma_f32_16x16x32_bf16 v[36:39], a[32:35], v[76:79], v[16:19]
    s_add_u32 m0, s21, 57216
    ds_read_b64_tr_b16 a[100:101], v4 offset:28672
    v_mfma_f32_16x16x32_bf16 v[36:39], a[36:39], v[80:83], v[36:39]
    ds_read_b64_tr_b16 a[102:103], v4 offset:30720
    v_mfma_f32_16x16x32_bf16 v[36:39], a[40:43], v[84:87], v[36:39]
    ds_read_b64_tr_b16 a[96:97], v4 offset:24576
    v_mfma_f32_16x16x32_bf16 v[36:39], a[44:47], v[88:91], v[36:39]
    ds_read_b64_tr_b16 a[98:99], v4 offset:26624
    v_mfma_f32_16x16x32_bf16 v[40:43], a[60:63], v[88:91], v[16:19]
    ds_read_b64_tr_b16 a[104:105], v5 offset:24576
    v_mfma_f32_16x16x32_bf16 v[40:43], a[56:59], v[84:87], v[40:43]
    ds_read_b64_tr_b16 a[106:107], v5 offset:26624
    v_mfma_f32_16x16x32_bf16 v[40:43], a[52:55], v[80:83], v[40:43]
    ds_read_b64_tr_b16 a[108:109], v5 offset:28672
    v_mfma_f32_16x16x32_bf16 v[40:43], a[48:51], v[76:79], v[40:43]
    ds_read_b64_tr_b16 a[110:111], v5 offset:30720
    buffer_load_dwordx4 v0, s[8:11], s26 offen offset:128 nt lds
    v_mfma_f32_16x16x32_bf16 a[196:199], a[192:195], v[44:47], a[196:199]
    ds_read_b64_tr_b16 a[116:117], v6 offset:28672
    v_mfma_f32_16x16x32_bf16 a[196:199], a[192:195], v[48:51], a[196:199]
    s_waitcnt lgkmcnt(9)
    ds_read_b64_tr_b16 a[118:119], v6 offset:30720
    v_mfma_f32_16x16x32_bf16 v[124:127], a[68:71], v[48:51], v[124:127]
    ds_read_b64_tr_b16 a[112:113], v6 offset:24576
    v_mfma_f32_16x16x32_bf16 v[124:127], a[64:67], v[44:47], v[124:127]
    ds_read_b64_tr_b16 a[114:115], v6 offset:26624
    v_mfma_f32_16x16x32_bf16 v[128:131], a[72:75], v[44:47], v[128:131]
    ds_read_b64_tr_b16 a[120:121], v7 offset:24576
    v_mfma_f32_16x16x32_bf16 v[128:131], a[76:79], v[48:51], v[128:131]
    s_add_u32 m0, s21, 53248
    ds_read_b64_tr_b16 a[122:123], v7 offset:26624
    v_mfma_f32_16x16x32_bf16 v[132:135], a[84:87], v[48:51], v[132:135]
    ds_read_b64_tr_b16 a[124:125], v7 offset:28672
    v_mfma_f32_16x16x32_bf16 v[132:135], a[80:83], v[44:47], v[132:135]
    ds_read_b64_tr_b16 a[126:127], v7 offset:30720
    v_mfma_f32_16x16x32_bf16 v[136:139], a[88:91], v[44:47], v[136:139]
    v_exp_f32 v28, v28
    v_mfma_f32_16x16x32_bf16 v[136:139], a[92:95], v[48:51], v[136:139]
    s_waitcnt lgkmcnt(8)
    v_exp_f32 v29, v29
    v_mfma_f32_16x16x32_bf16 v[140:143], a[100:103], v[48:51], v[140:143]
L_pad1:
    s_cbranch_vccnz L_touched0
    v_exp_f32 v30, v30
    v_mfma_f32_16x16x32_bf16 v[140:143], a[96:99], v[44:47], v[140:143]
    v_exp_f32 v31, v31
    v_mfma_f32_16x16x32_bf16 v[144:147], a[104:107], v[44:47], v[144:147]
    buffer_load_dwordx4 v0, s[8:11], s27 offen nt lds
    v_mfma_f32_16x16x32_bf16 v[144:147], a[108:111], v[48:51], v[144:147]
    s_waitcnt lgkmcnt(4)
    v_cvt_pk_bf16_f32 v52, v28, v29
    v_cvt_pk_bf16_f32 v53, v30, v31
    v_mfma_f32_16x16x32_bf16 v[148:151], a[116:119], v[48:51], v[148:151]
    v_exp_f32 v32, v32
    v_mfma_f32_16x16x32_bf16 v[148:151], a[112:115], v[44:47], v[148:151]
    s_waitcnt lgkmcnt(2)
    v_exp_f32 v33, v33
    v_mfma_f32_16x16x32_bf16 v[152:155], a[120:123], v[44:47], v[152:155]
    s_waitcnt lgkmcnt(0)
    v_exp_f32 v34, v34
    v_mfma_f32_16x16x32_bf16 v[152:155], a[124:127], v[48:51], v[152:155]
    v_exp_f32 v35, v35
    v_mfma_f32_16x16x32_bf16 v[28:31], a[0:3], v[92:95], v[20:23]
    s_add_u32 m0, s21, 61312
    v_cvt_pk_bf16_f32 v54, v32, v33
    v_cvt_pk_bf16_f32 v55, v34, v35
    v_mfma_f32_16x16x32_bf16 v[28:31], a[4:7], v[96:99], v[28:31]
    v_exp_f32 v36, v36
    v_mfma_f32_16x16x32_bf16 v[28:31], a[8:11], v[100:103], v[28:31]
    v_exp_f32 v37, v37
    v_mfma_f32_16x16x32_bf16 v[28:31], a[12:15], v[104:107], v[28:31]
    v_exp_f32 v38, v38
    v_mfma_f32_16x16x32_bf16 v[32:35], a[28:31], v[104:107], v[20:23]
    v_exp_f32 v39, v39
    v_mfma_f32_16x16x32_bf16 v[32:35], a[24:27], v[100:103], v[32:35]
    v_cvt_pk_bf16_f32 v56, v36, v37
    v_cvt_pk_bf16_f32 v57, v38, v39
    v_mfma_f32_16x16x32_bf16 v[32:35], a[20:23], v[96:99], v[32:35]
    v_exp_f32 v40, v40
    v_mfma_f32_16x16x32_bf16 v[32:35], a[16:19], v[92:95], v[32:35]
    buffer_load_dwordx4 v0, s[8:11], s27 offen offset:128 nt lds
    v_mfma_f32_16x16x32_bf16 v[36:39], a[32:35], v[92:95], v[20:23]
    v_exp_f32 v41, v41
    v_mfma_f32_16x16x32_bf16 v[36:39], a[36:39], v[96:99], v[36:39]
    v_exp_f32 v42, v42
    v_mfma_f32_16x16x32_bf16 v[36:39], a[40:43], v[100:103], v[36:39]
    v_exp_f32 v43, v43
    v_mfma_f32_16x16x32_bf16 v[36:39], a[44:47], v[104:107], v[36:39]
    v_cvt_pk_bf16_f32 v58, v40, v41
    v_cvt_pk_bf16_f32 v59, v42, v43
    v_mfma_f32_16x16x32_bf16 v[40:43], a[60:63], v[104:107], v[20:23]
    v_exp_f32 v28, v28
    v_mfma_f32_16x16x32_bf16 v[40:43], a[56:59], v[100:103], v[40:43]
    s_add_u32 m0, s21, 114688
    v_exp_f32 v29, v29
    v_mfma_f32_16x16x32_bf16 v[40:43], a[52:55], v[96:99], v[40:43]
    v_exp_f32 v30, v30
    v_mfma_f32_16x16x32_bf16 v[40:43], a[48:51], v[92:95], v[40:43]
    v_exp_f32 v31, v31
    v_mfma_f32_16x16x32_bf16 a[200:203], a[192:195], v[52:55], a[200:203]
    v_cvt_pk_bf16_f32 v44, v28, v29
    v_cvt_pk_bf16_f32 v45, v30, v31
    v_mfma_f32_16x16x32_bf16 a[200:203], a[192:195], v[56:59], a[200:203]
    v_exp_f32 v32, v32
    v_mfma_f32_16x16x32_bf16 v[156:159], a[68:71], v[56:59], v[156:159]
    v_exp_f32 v33, v33
    v_mfma_f32_16x16x32_bf16 v[156:159], a[64:67], v[52:55], v[156:159]
    v_exp_f32 v34, v34
    v_mfma_f32_16x16x32_bf16 v[160:163], a[72:75], v[52:55], v[160:163]
    buffer_load_dwordx4 v0, s[12:15], s26 offen nt lds
    v_mfma_f32_16x16x32_bf16 v[160:163], a[76:79], v[56:59], v[160:163]
    v_exp_f32 v35, v35
    v_mfma_f32_16x16x32_bf16 v[164:167], a[84:87], v[56:59], v[164:167]
    v_cvt_pk_bf16_f32 v46, v32, v33
    v_cvt_pk_bf16_f32 v47, v34, v35
    v_mfma_f32_16x16x32_bf16 v[164:167], a[80:83], v[52:55], v[164:167]
    v_exp_f32 v36, v36
    v_mfma_f32_16x16x32_bf16 v[168:171], a[88:91], v[52:55], v[168:171]
    v_exp_f32 v37, v37
    v_mfma_f32_16x16x32_bf16 v[168:171], a[92:95], v[56:59], v[168:171]
    s_add_u32 m0, s21, 122752
    v_exp_f32 v38, v38
    v_mfma_f32_16x16x32_bf16 v[172:175], a[100:103], v[56:59], v[172:175]
    v_exp_f32 v39, v39
    v_mfma_f32_16x16x32_bf16 v[172:175], a[96:99], v[52:55], v[172:175]
    v_cvt_pk_bf16_f32 v48, v36, v37
    v_cvt_pk_bf16_f32 v49, v38, v39
    v_mfma_f32_16x16x32_bf16 v[176:179], a[104:107], v[52:55], v[176:179]
    v_exp_f32 v40, v40
    v_mfma_f32_16x16x32_bf16 v[176:179], a[108:111], v[56:59], v[176:179]
    v_exp_f32 v41, v41
    v_mfma_f32_16x16x32_bf16 v[180:183], a[116:119], v[56:59], v[180:183]
    v_exp_f32 v42, v42
    v_mfma_f32_16x16x32_bf16 v[180:183], a[112:115], v[52:55], v[180:183]
    v_exp_f32 v43, v43
    v_mfma_f32_16x16x32_bf16 v[184:187], a[120:123], v[52:55], v[184:187]
    buffer_load_dwordx4 v0, s[12:15], s26 offen offset:128 nt lds
    v_mfma_f32_16x16x32_bf16 v[184:187], a[124:127], v[56:59], v[184:187]
    s_waitcnt vmcnt(10)
    s_barrier
    v_mfma_f32_16x16x32_bf16 v[28:31], a[0:3], v[108:111], v[24:27]
    ds_read_b128 a[0:3], v2 offset:32768
    v_cvt_pk_bf16_f32 v50, v40, v41
    v_mfma_f32_16x16x32_bf16 v[28:31], a[4:7], v[112:115], v[28:31]
    ds_read_b128 a[4:7], v3 offset:32768
    v_cvt_pk_bf16_f32 v51, v42, v43
    v_mfma_f32_16x16x32_bf16 v[28:31], a[8:11], v[116:119], v[28:31]
    ds_read_b128 a[8:11], v2 offset:40960
    v_mfma_f32_16x16x32_bf16 v[28:31], a[12:15], v[120:123], v[28:31]
    ds_read_b128 a[12:15], v3 offset:40960
    v_mfma_f32_16x16x32_bf16 v[32:35], a[28:31], v[120:123], v[24:27]
    s_add_u32 m0, s21, 118784
    ds_read_b128 a[28:31], v3 offset:43008
    v_mfma_f32_16x16x32_bf16 v[32:35], a[24:27], v[116:119], v[32:35]
    ds_read_b128 a[24:27], v2 offset:43008
    v_mfma_f32_16x16x32_bf16 v[32:35], a[20:23], v[112:115], v[32:35]
    ds_read_b128 a[20:23], v3 offset:34816
    v_mfma_f32_16x16x32_bf16 v[32:35], a[16:19], v[108:111], v[32:35]
    v_exp_f32 v28, v28
    v_mfma_f32_16x16x32_bf16 v[36:39], a[32:35], v[108:111], v[24:27]
    v_exp_f32 v29, v29
    v_mfma_f32_16x16x32_bf16 v[36:39], a[36:39], v[112:115], v[36:39]
    v_exp_f32 v30, v30
    v_mfma_f32_16x16x32_bf16 v[36:39], a[40:43], v[116:119], v[36:39]
    v_exp_f32 v31, v31
    v_mfma_f32_16x16x32_bf16 v[36:39], a[44:47], v[120:123], v[36:39]
    buffer_load_dwordx4 v0, s[12:15], s27 offen nt lds
    v_mfma_f32_16x16x32_bf16 v[40:43], a[60:63], v[120:123], v[24:27]
    ds_read_b128 a[16:19], v2 offset:34816
    v_cvt_pk_bf16_f32 v52, v28, v29
    v_mfma_f32_16x16x32_bf16 v[40:43], a[56:59], v[116:119], v[40:43]
    ds_read_b128 a[32:35], v2 offset:36864
    v_cvt_pk_bf16_f32 v53, v30, v31
    v_mfma_f32_16x16x32_bf16 v[40:43], a[52:55], v[112:115], v[40:43]
    v_exp_f32 v32, v32
    v_mfma_f32_16x16x32_bf16 v[40:43], a[48:51], v[108:111], v[40:43]
    v_exp_f32 v33, v33
    v_mfma_f32_16x16x32_bf16 a[204:207], a[192:195], v[44:47], a[204:207]
    v_exp_f32 v34, v34
    v_mfma_f32_16x16x32_bf16 a[204:207], a[192:195], v[48:51], a[204:207]
    s_add_u32 m0, s21, 126848
    v_exp_f32 v35, v35
    v_mfma_f32_16x16x32_bf16 v[188:191], a[68:71], v[48:51], v[188:191]
    ds_read_b128 a[36:39], v3 offset:36864
    v_cvt_pk_bf16_f32 v54, v32, v33
    v_mfma_f32_16x16x32_bf16 v[188:191], a[64:67], v[44:47], v[188:191]
    ds_read_b128 a[40:43], v2 offset:45056
    v_cvt_pk_bf16_f32 v55, v34, v35
    v_mfma_f32_16x16x32_bf16 v[192:195], a[72:75], v[44:47], v[192:195]
    v_exp_f32 v36, v36
    v_mfma_f32_16x16x32_bf16 v[192:195], a[76:79], v[48:51], v[192:195]
    v_exp_f32 v37, v37
    v_mfma_f32_16x16x32_bf16 v[196:199], a[84:87], v[48:51], v[196:199]
    v_exp_f32 v38, v38
    v_mfma_f32_16x16x32_bf16 v[196:199], a[80:83], v[44:47], v[196:199]
    v_exp_f32 v39, v39
    v_mfma_f32_16x16x32_bf16 v[200:203], a[88:91], v[44:47], v[200:203]
    buffer_load_dwordx4 v0, s[12:15], s27 offen offset:128 nt lds
    v_mfma_f32_16x16x32_bf16 v[200:203], a[92:95], v[48:51], v[200:203]
    ds_read_b128 a[44:47], v3 offset:45056
    v_cvt_pk_bf16_f32 v56, v36, v37
    v_mfma_f32_16x16x32_bf16 v[204:207], a[100:103], v[48:51], v[204:207]
    ds_read_b128 a[60:63], v3 offset:47104
    v_cvt_pk_bf16_f32 v57, v38, v39
    v_mfma_f32_16x16x32_bf16 v[204:207], a[96:99], v[44:47], v[204:207]
    v_exp_f32 v40, v40
    v_mfma_f32_16x16x32_bf16 v[208:211], a[104:107], v[44:47], v[208:211]
    s_add_u32 s26, s22, 65536
    v_exp_f32 v41, v41
    v_mfma_f32_16x16x32_bf16 v[208:211], a[108:111], v[48:51], v[208:211]
    s_add_u32 s27, s22, 73728
    v_exp_f32 v42, v42
    v_mfma_f32_16x16x32_bf16 v[212:215], a[116:119], v[48:51], v[212:215]
    s_add_u32 m0, s21, 0
    v_exp_f32 v43, v43
    v_mfma_f32_16x16x32_bf16 v[212:215], a[112:115], v[44:47], v[212:215]
    ds_read_b128 a[56:59], v2 offset:47104
    v_cvt_pk_bf16_f32 v58, v40, v41
    v_mfma_f32_16x16x32_bf16 v[216:219], a[120:123], v[44:47], v[216:219]
    ds_read_b128 a[52:55], v3 offset:38912
    v_cvt_pk_bf16_f32 v59, v42, v43
    v_mfma_f32_16x16x32_bf16 v[216:219], a[124:127], v[48:51], v[216:219]
    s_waitcnt lgkmcnt(4)
    ds_read_b128 a[48:51], v2 offset:38912
    v_mfma_f32_16x16x32_bf16 v[28:31], a[0:3], v[60:63], v[12:15]
    v_mfma_f32_16x16x32_bf16 v[28:31], a[4:7], v[64:67], v[28:31]
    v_mfma_f32_16x16x32_bf16 v[28:31], a[8:11], v[68:71], v[28:31]
    v_mfma_f32_16x16x32_bf16 v[28:31], a[12:15], v[72:75], v[28:31]
    buffer_load_dwordx4 v0, s[8:11], s26 offen nt lds
    v_mfma_f32_16x16x32_bf16 v[32:35], a[28:31], v[72:75], v[12:15]
    v_mfma_f32_16x16x32_bf16 v[32:35], a[24:27], v[68:71], v[32:35]
    v_mfma_f32_16x16x32_bf16 v[32:35], a[20:23], v[64:67], v[32:35]
    v_mfma_f32_16x16x32_bf16 v[32:35], a[16:19], v[60:63], v[32:35]
    s_nop 2
    v_exp_f32 v28, v28
    v_mfma_f32_16x16x32_bf16 v[36:39], a[32:35], v[60:63], v[12:15]
    v_exp_f32 v29, v29
    v_mfma_f32_16x16x32_bf16 v[36:39], a[36:39], v[64:67], v[36:39]
    v_exp_f32 v30, v30
    v_mfma_f32_16x16x32_bf16 v[36:39], a[40:43], v[68:71], v[36:39]
    s_waitcnt lgkmcnt(0)
    v_exp_f32 v31, v31
    v_mfma_f32_16x16x32_bf16 v[36:39], a[44:47], v[72:75], v[36:39]
    s_add_u32 m0, s21, 8064
    v_exp_f32 v32, v32
    v_mfma_f32_16x16x32_bf16 v[40:43], a[60:63], v[72:75], v[12:15]
    v_exp_f32 v33, v33
    v_mfma_f32_16x16x32_bf16 v[40:43], a[56:59], v[68:71], v[40:43]
    v_exp_f32 v34, v34
    v_mfma_f32_16x16x32_bf16 v[40:43], a[52:55], v[64:67], v[40:43]
    v_exp_f32 v35, v35
    v_mfma_f32_16x16x32_bf16 v[40:43], a[48:51], v[60:63], v[40:43]
    v_exp_f32 v36, v36
    v_mfma_f32_16x16x32_bf16 a[208:211], a[192:195], v[52:55], a[208:211]
    v_exp_f32 v37, v37
    v_mfma_f32_16x16x32_bf16 a[208:211], a[192:195], v[56:59], a[208:211]
    s_waitcnt vmcnt(9)
    s_barrier
    buffer_load_dwordx4 v0, s[8:11], s26 offen offset:128 nt lds
    v_mfma_f32_16x16x32_bf16 v[220:223], a[68:71], v[56:59], v[220:223]
    ds_read_b64_tr_b16 a[68:69], v4 offset:36864
    v_cvt_pk_bf16_f32 v44, v28, v29
    v_mfma_f32_16x16x32_bf16 v[220:223], a[64:67], v[52:55], v[220:223]
    ds_read_b64_tr_b16 a[70:71], v4 offset:38912
    v_cvt_pk_bf16_f32 v45, v30, v31
    v_mfma_f32_16x16x32_bf16 v[224:227], a[72:75], v[52:55], v[224:227]
    ds_read_b64_tr_b16 a[64:65], v4 offset:32768
    v_cvt_pk_bf16_f32 v46, v32, v33
    v_mfma_f32_16x16x32_bf16 v[224:227], a[76:79], v[56:59], v[224:227]
    ds_read_b64_tr_b16 a[66:67], v4 offset:34816
    v_cvt_pk_bf16_f32 v47, v34, v35
    v_mfma_f32_16x16x32_bf16 v[228:231], a[84:87], v[56:59], v[228:231]
    v_exp_f32 v38, v38
    v_mfma_f32_16x16x32_bf16 v[228:231], a[80:83], v[52:55], v[228:231]
    v_exp_f32 v39, v39
    v_mfma_f32_16x16x32_bf16 v[232:235], a[88:91], v[52:55], v[232:235]
    ds_read_b64_tr_b16 a[72:73], v5 offset:32768
    v_cvt_pk_bf16_f32 v48, v36, v37
    v_mfma_f32_16x16x32_bf16 v[232:235], a[92:95], v[56:59], v[232:235]
    s_add_u32 m0, s21, 4096
    ds_read_b64_tr_b16 a[74:75], v5 offset:34816
    v_cvt_pk_bf16_f32 v49, v38, v39
    v_mfma_f32_16x16x32_bf16 v[236:239], a[100:103], v[56:59], v[236:239]
    v_exp_f32 v40, v40
    v_mfma_f32_16x16x32_bf16 v[236:239], a[96:99], v[52:55], v[236:239]
    v_exp_f32 v41, v41
    v_mfma_f32_16x16x32_bf16 v[240:243], a[104:107], v[52:55], v[240:243]
    v_exp_f32 v42, v42
    v_mfma_f32_16x16x32_bf16 v[240:243], a[108:111], v[56:59], v[240:243]
    v_exp_f32 v43, v43
    v_mfma_f32_16x16x32_bf16 v[244:247], a[116:119], v[56:59], v[244:247]
    ds_read_b64_tr_b16 a[76:77], v5 offset:36864
    v_cvt_pk_bf16_f32 v50, v40, v41
    v_mfma_f32_16x16x32_bf16 v[244:247], a[112:115], v[52:55], v[244:247]
    ds_read_b64_tr_b16 a[78:79], v5 offset:38912
    v_cvt_pk_bf16_f32 v51, v42, v43
    v_mfma_f32_16x16x32_bf16 v[248:251], a[120:123], v[52:55], v[248:251]
    buffer_load_dwordx4 v0, s[8:11], s27 offen nt lds
    v_mfma_f32_16x16x32_bf16 v[248:251], a[124:127], v[56:59], v[248:251]
    ds_read_b64_tr_b16 a[84:85], v6 offset:36864
    v_mfma_f32_16x16x32_bf16 v[28:31], a[0:3], v[76:79], v[16:19]
    ds_read_b64_tr_b16 a[86:87], v6 offset:38912
    v_mfma_f32_16x16x32_bf16 v[28:31], a[4:7], v[80:83], v[28:31]
    ds_read_b64_tr_b16 a[80:81], v6 offset:32768
    v_mfma_f32_16x16x32_bf16 v[28:31], a[8:11], v[84:87], v[28:31]
    ds_read_b64_tr_b16 a[82:83], v6 offset:34816
    v_mfma_f32_16x16x32_bf16 v[28:31], a[12:15], v[88:91], v[28:31]
    ds_read_b64_tr_b16 a[88:89], v7 offset:32768
    v_mfma_f32_16x16x32_bf16 v[32:35], a[28:31], v[88:91], v[16:19]
    ds_read_b64_tr_b16 a[90:91], v7 offset:34816
    v_mfma_f32_16x16x32_bf16 v[32:35], a[24:27], v[84:87], v[32:35]
    s_add_u32 m0, s21, 12160
    ds_read_b64_tr_b16 a[92:93], v7 offset:36864
    v_mfma_f32_16x16x32_bf16 v[32:35], a[20:23], v[80:83], v[32:35]
    ds_read_b64_tr_b16 a[94:95], v7 offset:38912
    v_mfma_f32_16x16x32_bf16 v[32:35], a[16:19], v[76:79], v[32:35]
    ds_read_b64_tr_b16 a[100:101], v4 offset:45056
    v_mfma_f32_16x16x32_bf16 v[36:39], a[32:35], v[76:79], v[16:19]
    ds_read_b64_tr_b16 a[102:103], v4 offset:47104
    v_mfma_f32_16x16x32_bf16 v[36:39], a[36:39], v[80:83], v[36:39]
    ds_read_b64_tr_b16 a[96:97], v4 offset:40960
    v_mfma_f32_16x16x32_bf16 v[36:39], a[40:43], v[84:87], v[36:39]
    ds_read_b64_tr_b16 a[98:99], v4 offset:43008
    v_mfma_f32_16x16x32_bf16 v[36:39], a[44:47], v[88:91], v[36:39]
    ds_read_b64_tr_b16 a[104:105], v5 offset:40960
    v_mfma_f32_16x16x32_bf16 v[40:43], a[60:63], v[88:91], v[16:19]
    buffer_load_dwordx4 v0, s[8:11], s27 offen offset:128 nt lds
    v_mfma_f32_16x16x32_bf16 v[40:43], a[56:59], v[84:87], v[40:43]
    ds_read_b64_tr_b16 a[106:107], v5 offset:43008
    v_mfma_f32_16x16x32_bf16 v[40:43], a[52:55], v[80:83], v[40:43]
    ds_read_b64_tr_b16 a[108:109], v5 offset:45056
    v_mfma_f32_16x16x32_bf16 v[40:43], a[48:51], v[76:79], v[40:43]
    ds_read_b64_tr_b16 a[110:111], v5 offset:47104
    v_mfma_f32_16x16x32_bf16 a[196:199], a[192:195], v[44:47], a[196:199]
    ds_read_b64_tr_b16 a[116:117], v6 offset:45056
    v_mfma_f32_16x16x32_bf16 a[196:199], a[192:195], v[48:51], a[196:199]
    s_waitcnt lgkmcnt(8)
    ds_read_b64_tr_b16 a[118:119], v6 offset:47104
    v_mfma_f32_16x16x32_bf16 v[124:127], a[68:71], v[48:51], v[124:127]
    ds_read_b64_tr_b16 a[112:113], v6 offset:40960
    v_mfma_f32_16x16x32_bf16 v[124:127], a[64:67], v[44:47], v[124:127]
    ds_read_b64_tr_b16 a[114:115], v6 offset:43008
    v_mfma_f32_16x16x32_bf16 v[128:131], a[72:75], v[44:47], v[128:131]
    s_add_u32 m0, s21, 65536
    ds_read_b64_tr_b16 a[120:121], v7 offset:40960
    v_mfma_f32_16x16x32_bf16 v[128:131], a[76:79], v[48:51], v[128:131]
    ds_read_b64_tr_b16 a[122:123], v7 offset:43008
    v_mfma_f32_16x16x32_bf16 v[132:135], a[84:87], v[48:51], v[132:135]
    ds_read_b64_tr_b16 a[124:125], v7 offset:45056
    v_mfma_f32_16x16x32_bf16 v[132:135], a[80:83], v[44:47], v[132:135]
    ds_read_b64_tr_b16 a[126:127], v7 offset:47104
    v_exp_f32 v28, v28
    v_mfma_f32_16x16x32_bf16 v[136:139], a[88:91], v[44:47], v[136:139]
    v_exp_f32 v29, v29
    v_mfma_f32_16x16x32_bf16 v[136:139], a[92:95], v[48:51], v[136:139]
    s_waitcnt lgkmcnt(8)
    v_exp_f32 v30, v30
    v_mfma_f32_16x16x32_bf16 v[140:143], a[100:103], v[48:51], v[140:143]
    v_exp_f32 v31, v31
    v_mfma_f32_16x16x32_bf16 v[140:143], a[96:99], v[44:47], v[140:143]
    buffer_load_dwordx4 v0, s[12:15], s26 offen nt lds
    v_mfma_f32_16x16x32_bf16 v[144:147], a[104:107], v[44:47], v[144:147]
    v_exp_f32 v32, v32
    v_mfma_f32_16x16x32_bf16 v[144:147], a[108:111], v[48:51], v[144:147]
    s_waitcnt lgkmcnt(4)
    v_cvt_pk_bf16_f32 v52, v28, v29
    v_cvt_pk_bf16_f32 v53, v30, v31
    v_mfma_f32_16x16x32_bf16 v[148:151], a[116:119], v[48:51], v[148:151]
    v_exp_f32 v33, v33
    v_mfma_f32_16x16x32_bf16 v[148:151], a[112:115], v[44:47], v[148:151]
    s_waitcnt lgkmcnt(2)
    v_exp_f32 v34, v34
    v_mfma_f32_16x16x32_bf16 v[152:155], a[120:123], v[44:47], v[152:155]
    s_waitcnt lgkmcnt(0)
    v_exp_f32 v35, v35
    v_mfma_f32_16x16x32_bf16 v[152:155], a[124:127], v[48:51], v[152:155]
    v_cvt_pk_bf16_f32 v54, v32, v33
    v_cvt_pk_bf16_f32 v55, v34, v35
    v_mfma_f32_16x16x32_bf16 v[28:31], a[0:3], v[92:95], v[20:23]
    s_waitcnt vmcnt(5)
    s_barrier
    v_mfma_f32_16x16x32_bf16 v[28:31], a[4:7], v[96:99], v[28:31]
    s_add_u32 m0, s21, 73600
    v_exp_f32 v36, v36
    v_mfma_f32_16x16x32_bf16 v[28:31], a[8:11], v[100:103], v[28:31]
    v_exp_f32 v37, v37
    v_mfma_f32_16x16x32_bf16 v[28:31], a[12:15], v[104:107], v[28:31]
    v_exp_f32 v38, v38
    v_mfma_f32_16x16x32_bf16 v[32:35], a[28:31], v[104:107], v[20:23]
    v_exp_f32 v39, v39
    v_mfma_f32_16x16x32_bf16 v[32:35], a[24:27], v[100:103], v[32:35]
    v_exp_f32 v40, v40
    v_mfma_f32_16x16x32_bf16 v[32:35], a[20:23], v[96:99], v[32:35]
    v_cvt_pk_bf16_f32 v56, v36, v37
    v_cvt_pk_bf16_f32 v57, v38, v39
    v_mfma_f32_16x16x32_bf16 v[32:35], a[16:19], v[92:95], v[32:35]
    buffer_load_dwordx4 v0, s[12:15], s26 offen offset:128 nt lds
    v_mfma_f32_16x16x32_bf16 v[36:39], a[32:35], v[92:95], v[20:23]
    v_exp_f32 v41, v41
    v_mfma_f32_16x16x32_bf16 v[36:39], a[36:39], v[96:99], v[36:39]
    v_exp_f32 v42, v42
    v_mfma_f32_16x16x32_bf16 v[36:39], a[40:43], v[100:103], v[36:39]
    v_exp_f32 v43, v43
    v_mfma_f32_16x16x32_bf16 v[36:39], a[44:47], v[104:107], v[36:39]
    v_cvt_pk_bf16_f32 v58, v40, v41
    v_cvt_pk_bf16_f32 v59, v42, v43
    v_mfma_f32_16x16x32_bf16 v[40:43], a[60:63], v[104:107], v[20:23]
    v_exp_f32 v28, v28
    v_mfma_f32_16x16x32_bf16 v[40:43], a[56:59], v[100:103], v[40:43]
    v_exp_f32 v29, v29
    v_mfma_f32_16x16x32_bf16 v[40:43], a[52:55], v[96:99], v[40:43]
    v_exp_f32 v30, v30
    v_mfma_f32_16x16x32_bf16 v[40:43], a[48:51], v[92:95], v[40:43]
    s_add_u32 m0, s21, 69632
    v_exp_f32 v31, v31
    v_mfma_f32_16x16x32_bf16 a[200:203], a[192:195], v[52:55], a[200:203]
    v_cvt_pk_bf16_f32 v44, v28, v29
    v_cvt_pk_bf16_f32 v45, v30, v31
    v_mfma_f32_16x16x32_bf16 a[200:203], a[192:195], v[56:59], a[200:203]
    v_exp_f32 v32, v32
    v_mfma_f32_16x16x32_bf16 v[156:159], a[68:71], v[56:59], v[156:159]
    v_exp_f32 v33, v33
    v_mfma_f32_16x16x32_bf16 v[156:159], a[64:67], v[52:55], v[156:159]
    v_exp_f32 v34, v34
    v_mfma_f32_16x16x32_bf16 v[160:163], a[72:75], v[52:55], v[160:163]
    v_exp_f32 v35, v35
    v_mfma_f32_16x16x32_bf16 v[160:163], a[76:79], v[56:59], v[160:163]
    v_cvt_pk_bf16_f32 v46, v32, v33
    v_cvt_pk_bf16_f32 v47, v34, v35
    v_mfma_f32_16x16x32_bf16 v[164:167], a[84:87], v[56:59], v[164:167]
    buffer_load_dwordx4 v0, s[12:15], s27 offen nt lds
    v_mfma_f32_16x16x32_bf16 v[164:167], a[80:83], v[52:55], v[164:167]
    v_exp_f32 v36, v36
    v_mfma_f32_16x16x32_bf16 v[168:171], a[88:91], v[52:55], v[168:171]
    v_exp_f32 v37, v37
    v_mfma_f32_16x16x32_bf16 v[168:171], a[92:95], v[56:59], v[168:171]
    v_exp_f32 v38, v38
    v_mfma_f32_16x16x32_bf16 v[172:175], a[100:103], v[56:59], v[172:175]
    v_exp_f32 v39, v39
    v_mfma_f32_16x16x32_bf16 v[172:175], a[96:99], v[52:55], v[172:175]
    v_cvt_pk_bf16_f32 v48, v36, v37
    v_cvt_pk_bf16_f32 v49, v38, v39
    v_mfma_f32_16x16x32_bf16 v[176:179], a[104:107], v[52:55], v[176:179]
    v_exp_f32 v40, v40
    v_mfma_f32_16x16x32_bf16 v[176:179], a[108:111], v[56:59], v[176:179]
    s_add_u32 m0, s21, 77696
    v_exp_f32 v41, v41
    v_mfma_f32_16x16x32_bf16 v[180:183], a[116:119], v[56:59], v[180:183]
    v_exp_f32 v42, v42
    v_mfma_f32_16x16x32_bf16 v[180:183], a[112:115], v[52:55], v[180:183]
    v_exp_f32 v43, v43
    v_mfma_f32_16x16x32_bf16 v[184:187], a[120:123], v[52:55], v[184:187]
    v_cvt_pk_bf16_f32 v50, v40, v41
    v_cvt_pk_bf16_f32 v51, v42, v43
    v_mfma_f32_16x16x32_bf16 v[184:187], a[124:127], v[56:59], v[184:187]
    v_mfma_f32_16x16x32_bf16 v[28:31], a[0:3], v[108:111], v[24:27]
    ds_read_b128 a[0:3], v2 offset:49152
    v_mfma_f32_16x16x32_bf16 v[28:31], a[4:7], v[112:115], v[28:31]
    ds_read_b128 a[4:7], v3 offset:49152
    v_mfma_f32_16x16x32_bf16 v[28:31], a[8:11], v[116:119], v[28:31]
    buffer_load_dwordx4 v0, s[12:15], s27 offen offset:128 nt lds
    v_mfma_f32_16x16x32_bf16 v[28:31], a[12:15], v[120:123], v[28:31]
    ds_read_b128 a[8:11], v2 offset:57344
    v_mfma_f32_16x16x32_bf16 v[32:35], a[28:31], v[120:123], v[24:27]
    ds_read_b128 a[12:15], v3 offset:57344
    v_mfma_f32_16x16x32_bf16 v[32:35], a[24:27], v[116:119], v[32:35]
    ds_read_b128 a[28:31], v3 offset:59392
    v_mfma_f32_16x16x32_bf16 v[32:35], a[20:23], v[112:115], v[32:35]
    ds_read_b128 a[24:27], v2 offset:59392
    v_mfma_f32_16x16x32_bf16 v[32:35], a[16:19], v[108:111], v[32:35]
    v_exp_f32 v28, v28
    v_mfma_f32_16x16x32_bf16 v[36:39], a[32:35], v[108:111], v[24:27]
    s_add_u32 s26, s22, 81920
    v_exp_f32 v29, v29
    v_mfma_f32_16x16x32_bf16 v[36:39], a[36:39], v[112:115], v[36:39]
    s_add_u32 s27, s22, 90112
    v_exp_f32 v30, v30
    v_mfma_f32_16x16x32_bf16 v[36:39], a[40:43], v[116:119], v[36:39]
    s_add_u32 m0, s21, 16384
    v_exp_f32 v31, v31
    v_mfma_f32_16x16x32_bf16 v[36:39], a[44:47], v[120:123], v[36:39]
    ds_read_b128 a[20:23], v3 offset:51200
    v_cvt_pk_bf16_f32 v52, v28, v29
    v_mfma_f32_16x16x32_bf16 v[40:43], a[60:63], v[120:123], v[24:27]
    ds_read_b128 a[16:19], v2 offset:51200
    v_cvt_pk_bf16_f32 v53, v30, v31
    v_mfma_f32_16x16x32_bf16 v[40:43], a[56:59], v[116:119], v[40:43]
    v_exp_f32 v32, v32
    v_mfma_f32_16x16x32_bf16 v[40:43], a[52:55], v[112:115], v[40:43]
    v_exp_f32 v33, v33
    v_mfma_f32_16x16x32_bf16 v[40:43], a[48:51], v[108:111], v[40:43]
    v_exp_f32 v34, v34
    v_mfma_f32_16x16x32_bf16 a[204:207], a[192:195], v[44:47], a[204:207]
    v_exp_f32 v35, v35
    v_mfma_f32_16x16x32_bf16 a[204:207], a[192:195], v[48:51], a[204:207]
    buffer_load_dwordx4 v0, s[8:11], s26 offen nt lds
    v_mfma_f32_16x16x32_bf16 v[188:191], a[68:71], v[48:51], v[188:191]
    ds_read_b128 a[32:35], v2 offset:53248
    v_cvt_pk_bf16_f32 v54, v32, v33
    v_mfma_f32_16x16x32_bf16 v[188:191], a[64:67], v[44:47], v[188:191]
    ds_read_b128 a[36:39], v3 offset:53248
    v_cvt_pk_bf16_f32 v55, v34, v35
    v_mfma_f32_16x16x32_bf16 v[192:195], a[72:75], v[44:47], v[192:195]
    v_exp_f32 v36, v36
    v_mfma_f32_16x16x32_bf16 v[192:195], a[76:79], v[48:51], v[192:195]
    v_exp_f32 v37, v37
    v_mfma_f32_16x16x32_bf16 v[196:199], a[84:87], v[48:51], v[196:199]
    v_exp_f32 v38, v38
    v_mfma_f32_16x16x32_bf16 v[196:199], a[80:83], v[44:47], v[196:199]
    v_exp_f32 v39, v39
    v_mfma_f32_16x16x32_bf16 v[200:203], a[88:91], v[44:47], v[200:203]
    s_add_u32 m0, s21, 24448
    ds_read_b128 a[40:43], v2 offset:61440
    v_cvt_pk_bf16_f32 v56, v36, v37
    v_mfma_f32_16x16x32_bf16 v[200:203], a[92:95], v[48:51], v[200:203]
    ds_read_b128 a[44:47], v3 offset:61440
    v_cvt_pk_bf16_f32 v57, v38, v39
    v_mfma_f32_16x16x32_bf16 v[204:207], a[100:103], v[48:51], v[204:207]
    v_exp_f32 v40, v40
    v_mfma_f32_16x16x32_bf16 v[204:207], a[96:99], v[44:47], v[204:207]
    v_exp_f32 v41, v41
    v_mfma_f32_16x16x32_bf16 v[208:211], a[104:107], v[44:47], v[208:211]
    v_exp_f32 v42, v42
    v_mfma_f32_16x16x32_bf16 v[208:211], a[108:111], v[48:51], v[208:211]
    v_exp_f32 v43, v43
    v_mfma_f32_16x16x32_bf16 v[212:215], a[116:119], v[48:51], v[212:215]
    ds_read_b128 a[60:63], v3 offset:63488
    v_cvt_pk_bf16_f32 v58, v40, v41
    v_mfma_f32_16x16x32_bf16 v[212:215], a[112:115], v[44:47], v[212:215]
    buffer_load_dwordx4 v0, s[8:11], s26 offen offset:128 nt lds
    v_mfma_f32_16x16x32_bf16 v[216:219], a[120:123], v[44:47], v[216:219]
    ds_read_b128 a[56:59], v2 offset:63488
    v_cvt_pk_bf16_f32 v59, v42, v43
    v_mfma_f32_16x16x32_bf16 v[216:219], a[124:127], v[48:51], v[216:219]
    s_waitcnt lgkmcnt(4)
    ds_read_b128 a[52:55], v3 offset:55296
    v_mfma_f32_16x16x32_bf16 v[28:31], a[0:3], v[60:63], v[12:15]
    ds_read_b128 a[48:51], v2 offset:55296
    v_mfma_f32_16x16x32_bf16 v[28:31], a[4:7], v[64:67], v[28:31]
    v_mfma_f32_16x16x32_bf16 v[28:31], a[8:11], v[68:71], v[28:31]
    v_mfma_f32_16x16x32_bf16 v[28:31], a[12:15], v[72:75], v[28:31]
    v_mfma_f32_16x16x32_bf16 v[32:35], a[28:31], v[72:75], v[12:15]
    s_add_u32 m0, s21, 20480
    v_mfma_f32_16x16x32_bf16 v[32:35], a[24:27], v[68:71], v[32:35]
    v_mfma_f32_16x16x32_bf16 v[32:35], a[20:23], v[64:67], v[32:35]
    v_mfma_f32_16x16x32_bf16 v[32:35], a[16:19], v[60:63], v[32:35]
    s_nop 2
    v_exp_f32 v28, v28
    v_mfma_f32_16x16x32_bf16 v[36:39], a[32:35], v[60:63], v[12:15]
    v_exp_f32 v29, v29
    v_mfma_f32_16x16x32_bf16 v[36:39], a[36:39], v[64:67], v[36:39]
    s_waitcnt lgkmcnt(1)
    v_exp_f32 v30, v30
    v_mfma_f32_16x16x32_bf16 v[36:39], a[40:43], v[68:71], v[36:39]
    v_exp_f32 v31, v31
    v_mfma_f32_16x16x32_bf16 v[36:39], a[44:47], v[72:75], v[36:39]
    buffer_load_dwordx4 v0, s[8:11], s27 offen nt lds
    v_mfma_f32_16x16x32_bf16 v[40:43], a[60:63], v[72:75], v[12:15]
    v_exp_f32 v32, v32
    v_mfma_f32_16x16x32_bf16 v[40:43], a[56:59], v[68:71], v[40:43]
    v_exp_f32 v33, v33
    v_mfma_f32_16x16x32_bf16 v[40:43], a[52:55], v[64:67], v[40:43]
    s_waitcnt lgkmcnt(0)
    v_exp_f32 v34, v34
    v_mfma_f32_16x16x32_bf16 v[40:43], a[48:51], v[60:63], v[40:43]
    v_exp_f32 v35, v35
    v_mfma_f32_16x16x32_bf16 a[208:211], a[192:195], v[52:55], a[208:211]
    v_exp_f32 v36, v36
    v_mfma_f32_16x16x32_bf16 a[208:211], a[192:195], v[56:59], a[208:211]
    v_exp_f32 v37, v37
    v_mfma_f32_16x16x32_bf16 v[220:223], a[68:71], v[56:59], v[220:223]
    ds_read_b64_tr_b16 a[68:69], v4 offset:53248
    v_cvt_pk_bf16_f32 v44, v28, v29
    v_mfma_f32_16x16x32_bf16 v[220:223], a[64:67], v[52:55], v[220:223]
    s_add_u32 m0, s21, 28544
    ds_read_b64_tr_b16 a[70:71], v4 offset:55296
    v_cvt_pk_bf16_f32 v45, v30, v31
    v_mfma_f32_16x16x32_bf16 v[224:227], a[72:75], v[52:55], v[224:227]
    ds_read_b64_tr_b16 a[64:65], v4 offset:49152
    v_cvt_pk_bf16_f32 v46, v32, v33
    v_mfma_f32_16x16x32_bf16 v[224:227], a[76:79], v[56:59], v[224:227]
    ds_read_b64_tr_b16 a[66:67], v4 offset:51200
    v_cvt_pk_bf16_f32 v47, v34, v35
    v_mfma_f32_16x16x32_bf16 v[228:231], a[84:87], v[56:59], v[228:231]
    v_exp_f32 v38, v38
    v_mfma_f32_16x16x32_bf16 v[228:231], a[80:83], v[52:55], v[228:231]
    v_exp_f32 v39, v39
    v_mfma_f32_16x16x32_bf16 v[232:235], a[88:91], v[52:55], v[232:235]
    ds_read_b64_tr_b16 a[72:73], v5 offset:49152
    v_cvt_pk_bf16_f32 v48, v36, v37
    v_mfma_f32_16x16x32_bf16 v[232:235], a[92:95], v[56:59], v[232:235]
    ds_read_b64_tr_b16 a[74:75], v5 offset:51200
    v_cvt_pk_bf16_f32 v49, v38, v39
    v_mfma_f32_16x16x32_bf16 v[236:239], a[100:103], v[56:59], v[236:239]
    buffer_load_dwordx4 v0, s[8:11], s27 offen offset:128 nt lds
    v_mfma_f32_16x16x32_bf16 v[236:239], a[96:99], v[52:55], v[236:239]
    v_exp_f32 v40, v40
    v_mfma_f32_16x16x32_bf16 v[240:243], a[104:107], v[52:55], v[240:243]
    v_exp_f32 v41, v41
    v_mfma_f32_16x16x32_bf16 v[240:243], a[108:111], v[56:59], v[240:243]
    v_exp_f32 v42, v42
    v_mfma_f32_16x16x32_bf16 v[244:247], a[116:119], v[56:59], v[244:247]
    v_exp_f32 v43, v43
    v_mfma_f32_16x16x32_bf16 v[244:247], a[112:115], v[52:55], v[244:247]
    ds_read_b64_tr_b16 a[76:77], v5 offset:53248
    v_cvt_pk_bf16_f32 v50, v40, v41
    v_mfma_f32_16x16x32_bf16 v[248:251], a[120:123], v[52:55], v[248:251]
    ds_read_b64_tr_b16 a[78:79], v5 offset:55296
    v_cvt_pk_bf16_f32 v51, v42, v43
    v_mfma_f32_16x16x32_bf16 v[248:251], a[124:127], v[56:59], v[248:251]
    s_add_u32 m0, s21, 81920
    ds_read_b64_tr_b16 a[84:85], v6 offset:53248
    v_mfma_f32_16x16x32_bf16 v[28:31], a[0:3], v[76:79], v[16:19]
    ds_read_b64_tr_b16 a[86:87], v6 offset:55296
    v_mfma_f32_16x16x32_bf16 v[28:31], a[4:7], v[80:83], v[28:31]
    ds_read_b64_tr_b16 a[80:81], v6 offset:49152
    v_mfma_f32_16x16x32_bf16 v[28:31], a[8:11], v[84:87], v[28:31]
    ds_read_b64_tr_b16 a[82:83], v6 offset:51200
    v_mfma_f32_16x16x32_bf16 v[28:31], a[12:15], v[88:91], v[28:31]
    ds_read_b64_tr_b16 a[88:89], v7 offset:49152
    v_mfma_f32_16x16x32_bf16 v[32:35], a[28:31], v[88:91], v[16:19]
    ds_read_b64_tr_b16 a[90:91], v7 offset:51200
    v_mfma_f32_16x16x32_bf16 v[32:35], a[24:27], v[84:87], v[32:35]
    ds_read_b64_tr_b16 a[92:93], v7 offset:53248
    v_mfma_f32_16x16x32_bf16 v[32:35], a[20:23], v[80:83], v[32:35]
    buffer_load_dwordx4 v0, s[12:15], s26 offen nt lds
    v_mfma_f32_16x16x32_bf16 v[32:35], a[16:19], v[76:79], v[32:35]
    ds_read_b64_tr_b16 a[94:95], v7 offset:55296
    v_mfma_f32_16x16x32_bf16 v[36:39], a[32:35], v[76:79], v[16:19]
L_pad2:
    s_cbranch_vccnz L_touched0
    ds_read_b64_tr_b16 a[100:101], v4 offset:61440
    v_mfma_f32_16x16x32_bf16 v[36:39], a[36:39], v[80:83], v[36:39]
    ds_read_b64_tr_b16 a[102:103], v4 offset:63488
    v_mfma_f32_16x16x32_bf16 v[36:39], a[40:43], v[84:87], v[36:39]
    ds_read_b64_tr_b16 a[96:97], v4 offset:57344
    v_mfma_f32_16x16x32_bf16 v[36:39], a[44:47], v[88:91], v[36:39]
    ds_read_b64_tr_b16 a[98:99], v4 offset:59392
    v_mfma_f32_16x16x32_bf16 v[40:43], a[60:63], v[88:91], v[16:19]
    ds_read_b64_tr_b16 a[104:105], v5 offset:57344
    v_mfma_f32_16x16x32_bf16 v[40:43], a[56:59], v[84:87], v[40:43]
    s_add_u32 s49, s25, 0
    ds_read_b64_tr_b16 a[106:107], v5 offset:59392
    v_mfma_f32_16x16x32_bf16 v[40:43], a[52:55], v[80:83], v[40:43]
    ds_read_b64_tr_b16 a[108:109], v5 offset:61440
    v_mfma_f32_16x16x32_bf16 v[40:43], a[48:51], v[76:79], v[40:43]
    ds_read_b64_tr_b16 a[110:111], v5 offset:63488
    v_mfma_f32_16x16x32_bf16 a[196:199], a[192:195], v[44:47], a[196:199]
    ds_read_b64_tr_b16 a[116:117], v6 offset:61440
    v_mfma_f32_16x16x32_bf16 a[196:199], a[192:195], v[48:51], a[196:199]
    s_waitcnt lgkmcnt(9)
    ds_read_b64_tr_b16 a[118:119], v6 offset:63488
    v_mfma_f32_16x16x32_bf16 v[124:127], a[68:71], v[48:51], v[124:127]
    ds_read_b64_tr_b16 a[112:113], v6 offset:57344
    v_mfma_f32_16x16x32_bf16 v[124:127], a[64:67], v[44:47], v[124:127]
    ds_read_b64_tr_b16 a[114:115], v6 offset:59392
    v_mfma_f32_16x16x32_bf16 v[128:131], a[72:75], v[44:47], v[128:131]
    ds_read_b64_tr_b16 a[120:121], v7 offset:57344
    buffer_load_dwordx4 a[128:131], v1, s[4:7], s49 offen nt
    v_mfma_f32_16x16x32_bf16 v[128:131], a[76:79], v[48:51], v[128:131]
    s_add_u32 m0, s21, 89984
    ds_read_b64_tr_b16 a[122:123], v7 offset:59392
    v_mfma_f32_16x16x32_bf16 v[132:135], a[84:87], v[48:51], v[132:135]
    ds_read_b64_tr_b16 a[124:125], v7 offset:61440
    v_mfma_f32_16x16x32_bf16 v[132:135], a[80:83], v[44:47], v[132:135]
    ds_read_b64_tr_b16 a[126:127], v7 offset:63488
    v_exp_f32 v28, v28
    v_mfma_f32_16x16x32_bf16 v[136:139], a[88:91], v[44:47], v[136:139]
    v_exp_f32 v29, v29
    v_mfma_f32_16x16x32_bf16 v[136:139], a[92:95], v[48:51], v[136:139]
    s_waitcnt lgkmcnt(8)
    buffer_load_dwordx4 v0, s[12:15], s26 offen offset:128 nt lds
    v_mfma_f32_16x16x32_bf16 v[140:143], a[100:103], v[48:51], v[140:143]
    v_exp_f32 v30, v30
    v_mfma_f32_16x16x32_bf16 v[140:143], a[96:99], v[44:47], v[140:143]
    v_exp_f32 v31, v31
    v_mfma_f32_16x16x32_bf16 v[144:147], a[104:107], v[44:47], v[144:147]
    s_add_u32 m0, s21, 86016
    v_exp_f32 v32, v32
    v_mfma_f32_16x16x32_bf16 v[144:147], a[108:111], v[48:51], v[144:147]
    s_waitcnt lgkmcnt(4)
    v_cvt_pk_bf16_f32 v52, v28, v29
    v_cvt_pk_bf16_f32 v53, v30, v31
    v_mfma_f32_16x16x32_bf16 v[148:151], a[116:119], v[48:51], v[148:151]
    v_exp_f32 v33, v33
    v_mfma_f32_16x16x32_bf16 v[148:151], a[112:115], v[44:47], v[148:151]
    s_waitcnt lgkmcnt(2)
    v_exp_f32 v34, v34
    v_mfma_f32_16x16x32_bf16 v[152:155], a[120:123], v[44:47], v[152:155]
    s_waitcnt lgkmcnt(0)
    v_exp_f32 v35, v35
    v_mfma_f32_16x16x32_bf16 v[152:155], a[124:127], v[48:51], v[152:155]
    v_cvt_pk_bf16_f32 v54, v32, v33
    v_cvt_pk_bf16_f32 v55, v34, v35
    v_mfma_f32_16x16x32_bf16 v[28:31], a[0:3], v[92:95], v[20:23]
    s_waitcnt vmcnt(7)
    s_barrier
    v_mfma_f32_16x16x32_bf16 v[28:31], a[4:7], v[96:99], v[28:31]
    buffer_load_dwordx4 v0, s[12:15], s27 offen nt lds
    v_mfma_f32_16x16x32_bf16 v[28:31], a[8:11], v[100:103], v[28:31]
    v_exp_f32 v36, v36
    v_mfma_f32_16x16x32_bf16 v[28:31], a[12:15], v[104:107], v[28:31]
    v_exp_f32 v37, v37
    v_mfma_f32_16x16x32_bf16 v[32:35], a[28:31], v[104:107], v[20:23]
    v_exp_f32 v38, v38
    v_mfma_f32_16x16x32_bf16 v[32:35], a[24:27], v[100:103], v[32:35]
    v_exp_f32 v39, v39
    v_mfma_f32_16x16x32_bf16 v[32:35], a[20:23], v[96:99], v[32:35]
    v_exp_f32 v40, v40
    v_mfma_f32_16x16x32_bf16 v[32:35], a[16:19], v[92:95], v[32:35]
    v_cvt_pk_bf16_f32 v56, v36, v37
    v_cvt_pk_bf16_f32 v57, v38, v39
    v_mfma_f32_16x16x32_bf16 v[36:39], a[32:35], v[92:95], v[20:23]
    s_add_u32 m0, s21, 94080
    v_exp_f32 v41, v41
    v_mfma_f32_16x16x32_bf16 v[36:39], a[36:39], v[96:99], v[36:39]
    v_exp_f32 v42, v42
    v_mfma_f32_16x16x32_bf16 v[36:39], a[40:43], v[100:103], v[36:39]
    v_exp_f32 v43, v43
    v_mfma_f32_16x16x32_bf16 v[36:39], a[44:47], v[104:107], v[36:39]
    v_cvt_pk_bf16_f32 v58, v40, v41
    v_cvt_pk_bf16_f32 v59, v42, v43
    v_mfma_f32_16x16x32_bf16 v[40:43], a[60:63], v[104:107], v[20:23]
    v_exp_f32 v28, v28
    v_mfma_f32_16x16x32_bf16 v[40:43], a[56:59], v[100:103], v[40:43]
    v_exp_f32 v29, v29
    v_mfma_f32_16x16x32_bf16 v[40:43], a[52:55], v[96:99], v[40:43]
    v_exp_f32 v30, v30
    v_mfma_f32_16x16x32_bf16 v[40:43], a[48:51], v[92:95], v[40:43]
    buffer_load_dwordx4 v0, s[12:15], s27 offen offset:128 nt lds
    v_mfma_f32_16x16x32_bf16 a[200:203], a[192:195], v[52:55], a[200:203]
    v_exp_f32 v31, v31
    v_mfma_f32_16x16x32_bf16 a[200:203], a[192:195], v[56:59], a[200:203]
    v_cvt_pk_bf16_f32 v44, v28, v29
    v_cvt_pk_bf16_f32 v45, v30, v31
    v_mfma_f32_16x16x32_bf16 v[156:159], a[68:71], v[56:59], v[156:159]
    v_exp_f32 v32, v32
    v_mfma_f32_16x16x32_bf16 v[156:159], a[64:67], v[52:55], v[156:159]
    v_exp_f32 v33, v33
    v_mfma_f32_16x16x32_bf16 v[160:163], a[72:75], v[52:55], v[160:163]
    v_exp_f32 v34, v34
    v_mfma_f32_16x16x32_bf16 v[160:163], a[76:79], v[56:59], v[160:163]
    v_exp_f32 v35, v35
    v_mfma_f32_16x16x32_bf16 v[164:167], a[84:87], v[56:59], v[164:167]
    v_cvt_pk_bf16_f32 v46, v32, v33
    v_cvt_pk_bf16_f32 v47, v34, v35
    v_mfma_f32_16x16x32_bf16 v[164:167], a[80:83], v[52:55], v[164:167]
    v_exp_f32 v36, v36
    v_mfma_f32_16x16x32_bf16 v[168:171], a[88:91], v[52:55], v[168:171]
    v_exp_f32 v37, v37
    v_mfma_f32_16x16x32_bf16 v[168:171], a[92:95], v[56:59], v[168:171]
    v_exp_f32 v38, v38
    v_mfma_f32_16x16x32_bf16 v[172:175], a[100:103], v[56:59], v[172:175]
    v_exp_f32 v39, v39
    v_mfma_f32_16x16x32_bf16 v[172:175], a[96:99], v[52:55], v[172:175]
    buffer_load_dwordx4 a[132:135], v1, s[4:7], s49 offen offset:64 nt
    v_mfma_f32_16x16x32_bf16 v[176:179], a[104:107], v[52:55], v[176:179]
    s_add_u32 s26, s22, 98304
    v_cvt_pk_bf16_f32 v48, v36, v37
    v_cvt_pk_bf16_f32 v49, v38, v39
    v_mfma_f32_16x16x32_bf16 v[176:179], a[108:111], v[56:59], v[176:179]
    s_add_u32 s27, s22, 106496
    v_exp_f32 v40, v40
    v_mfma_f32_16x16x32_bf16 v[180:183], a[116:119], v[56:59], v[180:183]
    s_add_u32 m0, s21, 32768
    v_exp_f32 v41, v41
    v_mfma_f32_16x16x32_bf16 v[180:183], a[112:115], v[52:55], v[180:183]
    v_exp_f32 v42, v42
    v_mfma_f32_16x16x32_bf16 v[184:187], a[120:123], v[52:55], v[184:187]
    buffer_load_dwordx4 v0, s[8:11], s26 offen nt lds
    v_mfma_f32_16x16x32_bf16 v[184:187], a[124:127], v[56:59], v[184:187]
    v_exp_f32 v43, v43
    v_mfma_f32_16x16x32_bf16 v[28:31], a[0:3], v[108:111], v[24:27]
    ds_read_b128 a[0:3], v2 offset:0
    v_cvt_pk_bf16_f32 v50, v40, v41
    v_mfma_f32_16x16x32_bf16 v[28:31], a[4:7], v[112:115], v[28:31]
    ds_read_b128 a[4:7], v3 offset:0
    v_cvt_pk_bf16_f32 v51, v42, v43
    v_mfma_f32_16x16x32_bf16 v[28:31], a[8:11], v[116:119], v[28:31]
    ds_read_b128 a[8:11], v2 offset:8192
    v_mfma_f32_16x16x32_bf16 v[28:31], a[12:15], v[120:123], v[28:31]
    s_add_u32 m0, s21, 40832
    ds_read_b128 a[12:15], v3 offset:8192
    v_mfma_f32_16x16x32_bf16 v[32:35], a[28:31], v[120:123], v[24:27]
    ds_read_b128 a[28:31], v3 offset:10240
    v_mfma_f32_16x16x32_bf16 v[32:35], a[24:27], v[116:119], v[32:35]
    ds_read_b128 a[24:27], v2 offset:10240
    v_mfma_f32_16x16x32_bf16 v[32:35], a[20:23], v[112:115], v[32:35]
    ds_read_b128 a[20:23], v3 offset:2048
    v_mfma_f32_16x16x32_bf16 v[32:35], a[16:19], v[108:111], v[32:35]
    v_exp_f32 v28, v28
    v_mfma_f32_16x16x32_bf16 v[36:39], a[32:35], v[108:111], v[24:27]
    v_exp_f32 v29, v29
    v_mfma_f32_16x16x32_bf16 v[36:39], a[36:39], v[112:115], v[36:39]
    v_exp_f32 v30, v30
    v_mfma_f32_16x16x32_bf16 v[36:39], a[40:43], v[116:119], v[36:39]
    buffer_load_dwordx4 v0, s[8:11], s26 offen offset:128 nt lds
    v_mfma_f32_16x16x32_bf16 v[36:39], a[44:47], v[120:123], v[36:39]
    v_exp_f32 v31, v31
    v_mfma_f32_16x16x32_bf16 v[40:43], a[60:63], v[120:123], v[24:27]
    ds_read_b128 a[16:19], v2 offset:2048
    v_cvt_pk_bf16_f32 v52, v28, v29
    v_mfma_f32_16x16x32_bf16 v[40:43], a[56:59], v[116:119], v[40:43]
    ds_read_b128 a[32:35], v2 offset:4096
    v_cvt_pk_bf16_f32 v53, v30, v31
    v_mfma_f32_16x16x32_bf16 v[40:43], a[52:55], v[112:115], v[40:43]
    v_exp_f32 v32, v32
    v_mfma_f32_16x16x32_bf16 v[40:43], a[48:51], v[108:111], v[40:43]
    v_exp_f32 v33, v33
    v_mfma_f32_16x16x32_bf16 a[204:207], a[192:195], v[44:47], a[204:207]
    v_exp_f32 v34, v34
    v_mfma_f32_16x16x32_bf16 a[204:207], a[192:195], v[48:51], a[204:207]
    s_add_u32 m0, s21, 36864
    v_exp_f32 v35, v35
    v_mfma_f32_16x16x32_bf16 v[188:191], a[68:71], v[48:51], v[188:191]
    ds_read_b128 a[36:39], v3 offset:4096
    v_cvt_pk_bf16_f32 v54, v32, v33
    v_mfma_f32_16x16x32_bf16 v[188:191], a[64:67], v[44:47], v[188:191]
    ds_read_b128 a[40:43], v2 offset:12288
    v_cvt_pk_bf16_f32 v55, v34, v35
    v_mfma_f32_16x16x32_bf16 v[192:195], a[72:75], v[44:47], v[192:195]
    v_exp_f32 v36, v36
    v_mfma_f32_16x16x32_bf16 v[192:195], a[76:79], v[48:51], v[192:195]
    v_exp_f32 v37, v37
    v_mfma_f32_16x16x32_bf16 v[196:199], a[84:87], v[48:51], v[196:199]
    v_exp_f32 v38, v38
    v_mfma_f32_16x16x32_bf16 v[196:199], a[80:83], v[44:47], v[196:199]
    v_exp_f32 v39, v39
    v_mfma_f32_16x16x32_bf16 v[200:203], a[88:91], v[44:47], v[200:203]
    buffer_load_dwordx4 v0, s[8:11], s27 offen nt lds
    v_mfma_f32_16x16x32_bf16 v[200:203], a[92:95], v[48:51], v[200:203]
    ds_read_b128 a[44:47], v3 offset:12288
    v_cvt_pk_bf16_f32 v56, v36, v37
    v_mfma_f32_16x16x32_bf16 v[204:207], a[100:103], v[48:51], v[204:207]
    ds_read_b128 a[60:63], v3 offset:14336
    v_cvt_pk_bf16_f32 v57, v38, v39
    v_mfma_f32_16x16x32_bf16 v[204:207], a[96:99], v[44:47], v[204:207]
    v_exp_f32 v40, v40
    v_mfma_f32_16x16x32_bf16 v[208:211], a[104:107], v[44:47], v[208:211]
    v_exp_f32 v41, v41
    v_mfma_f32_16x16x32_bf16 v[208:211], a[108:111], v[48:51], v[208:211]
    v_exp_f32 v42, v42
    v_mfma_f32_16x16x32_bf16 v[212:215], a[116:119], v[48:51], v[212:215]
    v_exp_f32 v43, v43
    v_mfma_f32_16x16x32_bf16 v[212:215], a[112:115], v[44:47], v[212:215]
    ds_read_b128 a[56:59], v2 offset:14336
    v_cvt_pk_bf16_f32 v58, v40, v41
    v_mfma_f32_16x16x32_bf16 v[216:219], a[120:123], v[44:47], v[216:219]
    ds_read_b128 a[52:55], v3 offset:6144
    v_cvt_pk_bf16_f32 v59, v42, v43
    v_mfma_f32_16x16x32_bf16 v[216:219], a[124:127], v[48:51], v[216:219]
    s_waitcnt lgkmcnt(4)
    ds_read_b128 a[48:51], v2 offset:6144
    v_mfma_f32_16x16x32_bf16 v[28:31], a[0:3], v[60:63], v[12:15]
    buffer_load_dwordx4 a[136:139], v1, s[4:7], s49 offen offset:128 nt
    v_mfma_f32_16x16x32_bf16 v[28:31], a[4:7], v[64:67], v[28:31]
    s_add_u32 m0, s21, 44928
    v_mfma_f32_16x16x32_bf16 v[28:31], a[8:11], v[68:71], v[28:31]
    v_mfma_f32_16x16x32_bf16 v[28:31], a[12:15], v[72:75], v[28:31]
    v_mfma_f32_16x16x32_bf16 v[32:35], a[28:31], v[72:75], v[12:15]
    v_mfma_f32_16x16x32_bf16 v[32:35], a[24:27], v[68:71], v[32:35]
    buffer_load_dwordx4 v0, s[8:11], s27 offen offset:128 nt lds
    v_mfma_f32_16x16x32_bf16 v[32:35], a[20:23], v[64:67], v[32:35]
    v_mfma_f32_16x16x32_bf16 v[32:35], a[16:19], v[60:63], v[32:35]
    s_nop 2
    v_exp_f32 v28, v28
    v_mfma_f32_16x16x32_bf16 v[36:39], a[32:35], v[60:63], v[12:15]
    v_exp_f32 v29, v29
    v_mfma_f32_16x16x32_bf16 v[36:39], a[36:39], v[64:67], v[36:39]
    v_exp_f32 v30, v30
    v_mfma_f32_16x16x32_bf16 v[36:39], a[40:43], v[68:71], v[36:39]
    s_waitcnt lgkmcnt(0)
    v_exp_f32 v31, v31
    v_mfma_f32_16x16x32_bf16 v[36:39], a[44:47], v[72:75], v[36:39]
    s_add_u32 m0, s21, 98304
    v_exp_f32 v32, v32
    v_mfma_f32_16x16x32_bf16 v[40:43], a[60:63], v[72:75], v[12:15]
    v_exp_f32 v33, v33
    v_mfma_f32_16x16x32_bf16 v[40:43], a[56:59], v[68:71], v[40:43]
    v_exp_f32 v34, v34
    v_mfma_f32_16x16x32_bf16 v[40:43], a[52:55], v[64:67], v[40:43]
    v_exp_f32 v35, v35
    v_mfma_f32_16x16x32_bf16 v[40:43], a[48:51], v[60:63], v[40:43]
    v_exp_f32 v36, v36
    v_mfma_f32_16x16x32_bf16 a[208:211], a[192:195], v[52:55], a[208:211]
    v_exp_f32 v37, v37
    v_mfma_f32_16x16x32_bf16 a[208:211], a[192:195], v[56:59], a[208:211]
    v_exp_f32 v38, v38
    v_mfma_f32_16x16x32_bf16 v[220:223], a[68:71], v[56:59], v[220:223]
    buffer_load_dwordx4 v0, s[12:15], s26 offen nt lds
    v_mfma_f32_16x16x32_bf16 v[220:223], a[64:67], v[52:55], v[220:223]
    ds_read_b64_tr_b16 a[68:69], v4 offset:4096
    v_cvt_pk_bf16_f32 v44, v28, v29
    v_mfma_f32_16x16x32_bf16 v[224:227], a[72:75], v[52:55], v[224:227]
    ds_read_b64_tr_b16 a[70:71], v4 offset:6144
    v_cvt_pk_bf16_f32 v45, v30, v31
    v_mfma_f32_16x16x32_bf16 v[224:227], a[76:79], v[56:59], v[224:227]
    ds_read_b64_tr_b16 a[64:65], v4 offset:0
    v_cvt_pk_bf16_f32 v46, v32, v33
    v_mfma_f32_16x16x32_bf16 v[228:231], a[84:87], v[56:59], v[228:231]
    ds_read_b64_tr_b16 a[66:67], v4 offset:2048
    v_cvt_pk_bf16_f32 v47, v34, v35
    v_mfma_f32_16x16x32_bf16 v[228:231], a[80:83], v[52:55], v[228:231]
    v_exp_f32 v39, v39
    v_mfma_f32_16x16x32_bf16 v[232:235], a[88:91], v[52:55], v[232:235]
    ds_read_b64_tr_b16 a[72:73], v5 offset:0
    v_cvt_pk_bf16_f32 v48, v36, v37
    v_mfma_f32_16x16x32_bf16 v[232:235], a[92:95], v[56:59], v[232:235]
    s_add_u32 m0, s21, 106368
    ds_read_b64_tr_b16 a[74:75], v5 offset:2048
    v_cvt_pk_bf16_f32 v49, v38, v39
    v_mfma_f32_16x16x32_bf16 v[236:239], a[100:103], v[56:59], v[236:239]
    v_exp_f32 v40, v40
    v_mfma_f32_16x16x32_bf16 v[236:239], a[96:99], v[52:55], v[236:239]
    v_exp_f32 v41, v41
    v_mfma_f32_16x16x32_bf16 v[240:243], a[104:107], v[52:55], v[240:243]
    v_exp_f32 v42, v42
    v_mfma_f32_16x16x32_bf16 v[240:243], a[108:111], v[56:59], v[240:243]
    v_exp_f32 v43, v43
    v_mfma_f32_16x16x32_bf16 v[244:247], a[116:119], v[56:59], v[244:247]
    ds_read_b64_tr_b16 a[76:77], v5 offset:4096
    v_cvt_pk_bf16_f32 v50, v40, v41
    v_mfma_f32_16x16x32_bf16 v[244:247], a[112:115], v[52:55], v[244:247]
    ds_read_b64_tr_b16 a[78:79], v5 offset:6144
    v_cvt_pk_bf16_f32 v51, v42, v43
    v_mfma_f32_16x16x32_bf16 v[248:251], a[120:123], v[52:55], v[248:251]
    buffer_load_dwordx4 v0, s[12:15], s26 offen offset:128 nt lds
    v_mfma_f32_16x16x32_bf16 v[248:251], a[124:127], v[56:59], v[248:251]
    ds_read_b64_tr_b16 a[84:85], v6 offset:4096
    v_mfma_f32_16x16x32_bf16 v[28:31], a[0:3], v[76:79], v[16:19]
    ds_read_b64_tr_b16 a[86:87], v6 offset:6144
    v_mfma_f32_16x16x32_bf16 v[28:31], a[4:7], v[80:83], v[28:31]
    ds_read_b64_tr_b16 a[80:81], v6 offset:0
    v_mfma_f32_16x16x32_bf16 v[28:31], a[8:11], v[84:87], v[28:31]
    ds_read_b64_tr_b16 a[82:83], v6 offset:2048
    v_mfma_f32_16x16x32_bf16 v[28:31], a[12:15], v[88:91], v[28:31]
    ds_read_b64_tr_b16 a[88:89], v7 offset:0
    v_mfma_f32_16x16x32_bf16 v[32:35], a[28:31], v[88:91], v[16:19]
    ds_read_b64_tr_b16 a[90:91], v7 offset:2048
    v_mfma_f32_16x16x32_bf16 v[32:35], a[24:27], v[84:87], v[32:35]
    ds_read_b64_tr_b16 a[92:93], v7 offset:4096
    v_mfma_f32_16x16x32_bf16 v[32:35], a[20:23], v[80:83], v[32:35]
    ds_read_b64_tr_b16 a[94:95], v7 offset:6144
    v_mfma_f32_16x16x32_bf16 v[32:35], a[16:19], v[76:79], v[32:35]
    buffer_load_dwordx4 a[140:143], v1, s[4:7], s49 offen offset:192 nt
    v_mfma_f32_16x16x32_bf16 v[36:39], a[32:35], v[76:79], v[16:19]
    s_add_u32 m0, s21, 102400
    ds_read_b64_tr_b16 a[100:101], v4 offset:12288
    v_mfma_f32_16x16x32_bf16 v[36:39], a[36:39], v[80:83], v[36:39]
    ds_read_b64_tr_b16 a[102:103], v4 offset:14336
    v_mfma_f32_16x16x32_bf16 v[36:39], a[40:43], v[84:87], v[36:39]
    ds_read_b64_tr_b16 a[96:97], v4 offset:8192
    v_mfma_f32_16x16x32_bf16 v[36:39], a[44:47], v[88:91], v[36:39]
    ds_read_b64_tr_b16 a[98:99], v4 offset:10240
    v_mfma_f32_16x16x32_bf16 v[40:43], a[60:63], v[88:91], v[16:19]
    ds_read_b64_tr_b16 a[104:105], v5 offset:8192
    buffer_load_dwordx4 v0, s[12:15], s27 offen nt lds
    v_mfma_f32_16x16x32_bf16 v[40:43], a[56:59], v[84:87], v[40:43]
    ds_read_b64_tr_b16 a[106:107], v5 offset:10240
    v_mfma_f32_16x16x32_bf16 v[40:43], a[52:55], v[80:83], v[40:43]
    ds_read_b64_tr_b16 a[108:109], v5 offset:12288
    v_mfma_f32_16x16x32_bf16 v[40:43], a[48:51], v[76:79], v[40:43]
    ds_read_b64_tr_b16 a[110:111], v5 offset:14336
    v_mfma_f32_16x16x32_bf16 a[196:199], a[192:195], v[44:47], a[196:199]
    ds_read_b64_tr_b16 a[116:117], v6 offset:12288
    v_mfma_f32_16x16x32_bf16 a[196:199], a[192:195], v[48:51], a[196:199]
    s_waitcnt lgkmcnt(9)
    ds_read_b64_tr_b16 a[118:119], v6 offset:14336
    v_mfma_f32_16x16x32_bf16 v[124:127], a[68:71], v[48:51], v[124:127]
    ds_read_b64_tr_b16 a[112:113], v6 offset:8192
    v_mfma_f32_16x16x32_bf16 v[124:127], a[64:67], v[44:47], v[124:127]
    s_add_u32 m0, s21, 110464
    ds_read_b64_tr_b16 a[114:115], v6 offset:10240
    v_mfma_f32_16x16x32_bf16 v[128:131], a[72:75], v[44:47], v[128:131]
    ds_read_b64_tr_b16 a[120:121], v7 offset:8192
    v_mfma_f32_16x16x32_bf16 v[128:131], a[76:79], v[48:51], v[128:131]
    ds_read_b64_tr_b16 a[122:123], v7 offset:10240
    v_mfma_f32_16x16x32_bf16 v[132:135], a[84:87], v[48:51], v[132:135]
    ds_read_b64_tr_b16 a[124:125], v7 offset:12288
    v_mfma_f32_16x16x32_bf16 v[132:135], a[80:83], v[44:47], v[132:135]
    ds_read_b64_tr_b16 a[126:127], v7 offset:14336
    v_exp_f32 v28, v28
    v_mfma_f32_16x16x32_bf16 v[136:139], a[88:91], v[44:47], v[136:139]
    v_exp_f32 v29, v29
    v_mfma_f32_16x16x32_bf16 v[136:139], a[92:95], v[48:51], v[136:139]
    s_waitcnt lgkmcnt(8)
    v_exp_f32 v30, v30
    v_mfma_f32_16x16x32_bf16 v[140:143], a[100:103], v[48:51], v[140:143]
    buffer_load_dwordx4 v0, s[12:15], s27 offen offset:128 nt lds
    v_mfma_f32_16x16x32_bf16 v[140:143], a[96:99], v[44:47], v[140:143]
    v_exp_f32 v31, v31
    v_mfma_f32_16x16x32_bf16 v[144:147], a[104:107], v[44:47], v[144:147]
    v_exp_f32 v32, v32
    v_mfma_f32_16x16x32_bf16 v[144:147], a[108:111], v[48:51], v[144:147]
    s_waitcnt lgkmcnt(4)
    v_cvt_pk_bf16_f32 v52, v28, v29
    v_cvt_pk_bf16_f32 v53, v30, v31
    v_mfma_f32_16x16x32_bf16 v[148:151], a[116:119], v[48:51], v[148:151]
    v_exp_f32 v33, v33
    v_mfma_f32_16x16x32_bf16 v[148:151], a[112:115], v[44:47], v[148:151]
    s_waitcnt lgkmcnt(2)
    v_exp_f32 v34, v34
    v_mfma_f32_16x16x32_bf16 v[152:155], a[120:123], v[44:47], v[152:155]
    s_waitcnt lgkmcnt(0)
    v_exp_f32 v35, v35
    v_mfma_f32_16x16x32_bf16 v[152:155], a[124:127], v[48:51], v[152:155]
    s_add_u32 s26, s22, 114688
    v_cvt_pk_bf16_f32 v54, v32, v33
    v_cvt_pk_bf16_f32 v55, v34, v35
    v_mfma_f32_16x16x32_bf16 v[28:31], a[0:3], v[92:95], v[20:23]
    s_waitcnt vmcnt(11)
    s_barrier
    v_mfma_f32_16x16x32_bf16 v[28:31], a[4:7], v[96:99], v[28:31]
    s_add_u32 s27, s22, 122880
    v_exp_f32 v36, v36
    v_mfma_f32_16x16x32_bf16 v[28:31], a[8:11], v[100:103], v[28:31]
    s_add_u32 m0, s21, 49152
    v_exp_f32 v37, v37
    v_mfma_f32_16x16x32_bf16 v[28:31], a[12:15], v[104:107], v[28:31]
    v_exp_f32 v38, v38
    v_mfma_f32_16x16x32_bf16 v[32:35], a[28:31], v[104:107], v[20:23]
    v_exp_f32 v39, v39
    v_mfma_f32_16x16x32_bf16 v[32:35], a[24:27], v[100:103], v[32:35]
    v_cvt_pk_bf16_f32 v56, v36, v37
    v_cvt_pk_bf16_f32 v57, v38, v39
    v_mfma_f32_16x16x32_bf16 v[32:35], a[20:23], v[96:99], v[32:35]
    buffer_load_dwordx4 v0, s[8:11], s26 offen nt lds
    v_mfma_f32_16x16x32_bf16 v[32:35], a[16:19], v[92:95], v[32:35]
    s_add_u32 s49, s25, 4096
    v_exp_f32 v40, v40
    v_mfma_f32_16x16x32_bf16 v[36:39], a[32:35], v[92:95], v[20:23]
    v_exp_f32 v41, v41
    v_mfma_f32_16x16x32_bf16 v[36:39], a[36:39], v[96:99], v[36:39]
    v_exp_f32 v42, v42
    v_mfma_f32_16x16x32_bf16 v[36:39], a[40:43], v[100:103], v[36:39]
    v_exp_f32 v43, v43
    v_mfma_f32_16x16x32_bf16 v[36:39], a[44:47], v[104:107], v[36:39]
    v_cvt_pk_bf16_f32 v58, v40, v41
    v_cvt_pk_bf16_f32 v59, v42, v43
    v_mfma_f32_16x16x32_bf16 v[40:43], a[60:63], v[104:107], v[20:23]
    v_exp_f32 v28, v28
    v_mfma_f32_16x16x32_bf16 v[40:43], a[56:59], v[100:103], v[40:43]
    v_exp_f32 v29, v29
    v_mfma_f32_16x16x32_bf16 v[40:43], a[52:55], v[96:99], v[40:43]
    buffer_load_dwordx4 a[144:147], v1, s[4:7], s49 offen nt
    v_mfma_f32_16x16x32_bf16 v[40:43], a[48:51], v[92:95], v[40:43]
    v_exp_f32 v30, v30
    v_mfma_f32_16x16x32_bf16 a[200:203], a[192:195], v[52:55], a[200:203]
    s_add_u32 m0, s21, 57216
    v_exp_f32 v31, v31
    v_mfma_f32_16x16x32_bf16 a[200:203], a[192:195], v[56:59], a[200:203]
    v_cvt_pk_bf16_f32 v44, v28, v29
    v_cvt_pk_bf16_f32 v45, v30, v31
    v_mfma_f32_16x16x32_bf16 v[156:159], a[68:71], v[56:59], v[156:159]
    v_exp_f32 v32, v32
    v_mfma_f32_16x16x32_bf16 v[156:159], a[64:67], v[52:55], v[156:159]
    v_exp_f32 v33, v33
    v_mfma_f32_16x16x32_bf16 v[160:163], a[72:75], v[52:55], v[160:163]
    v_exp_f32 v34, v34
    v_mfma_f32_16x16x32_bf16 v[160:163], a[76:79], v[56:59], v[160:163]
    v_exp_f32 v35, v35
    v_mfma_f32_16x16x32_bf16 v[164:167], a[84:87], v[56:59], v[164:167]
    v_cvt_pk_bf16_f32 v46, v32, v33
    v_cvt_pk_bf16_f32 v47, v34, v35
    v_mfma_f32_16x16x32_bf16 v[164:167], a[80:83], v[52:55], v[164:167]
    buffer_load_dwordx4 v0, s[8:11], s26 offen offset:128 nt lds
    v_mfma_f32_16x16x32_bf16 v[168:171], a[88:91], v[52:55], v[168:171]
    v_exp_f32 v36, v36
    v_mfma_f32_16x16x32_bf16 v[168:171], a[92:95], v[56:59], v[168:171]
    v_exp_f32 v37, v37
    v_mfma_f32_16x16x32_bf16 v[172:175], a[100:103], v[56:59], v[172:175]
    v_exp_f32 v38, v38
    v_mfma_f32_16x16x32_bf16 v[172:175], a[96:99], v[52:55], v[172:175]
    v_exp_f32 v39, v39
    v_mfma_f32_16x16x32_bf16 v[176:179], a[104:107], v[52:55], v[176:179]
    v_cvt_pk_bf16_f32 v48, v36, v37
    v_cvt_pk_bf16_f32 v49, v38, v39
    v_mfma_f32_16x16x32_bf16 v[176:179], a[108:111], v[56:59], v[176:179]
    v_exp_f32 v40, v40
    v_mfma_f32_16x16x32_bf16 v[180:183], a[116:119], v[56:59], v[180:183]
    v_exp_f32 v41, v41
    v_mfma_f32_16x16x32_bf16 v[180:183], a[112:115], v[52:55], v[180:183]
    v_exp_f32 v42, v42
    v_mfma_f32_16x16x32_bf16 v[184:187], a[120:123], v[52:55], v[184:187]
    v_exp_f32 v43, v43
    v_mfma_f32_16x16x32_bf16 v[184:187], a[124:127], v[56:59], v[184:187]
    s_add_u32 m0, s21, 53248
    v_cvt_pk_bf16_f32 v50, v40, v41
    v_cvt_pk_bf16_f32 v51, v42, v43
    v_mfma_f32_16x16x32_bf16 v[28:31], a[0:3], v[108:111], v[24:27]
    ds_read_b128 a[0:3], v2 offset:16384
    v_mfma_f32_16x16x32_bf16 v[28:31], a[4:7], v[112:115], v[28:31]
    ds_read_b128 a[4:7], v3 offset:16384
    v_mfma_f32_16x16x32_bf16 v[28:31], a[8:11], v[116:119], v[28:31]
    ds_read_b128 a[8:11], v2 offset:24576
    v_mfma_f32_16x16x32_bf16 v[28:31], a[12:15], v[120:123], v[28:31]
    ds_read_b128 a[12:15], v3 offset:24576
    v_mfma_f32_16x16x32_bf16 v[32:35], a[28:31], v[120:123], v[24:27]
    ds_read_b128 a[28:31], v3 offset:26624
    v_mfma_f32_16x16x32_bf16 v[32:35], a[24:27], v[116:119], v[32:35]
    ds_read_b128 a[24:27], v2 offset:26624
    v_mfma_f32_16x16x32_bf16 v[32:35], a[20:23], v[112:115], v[32:35]
    buffer_load_dwordx4 v0, s[8:11], s27 offen nt lds
    v_mfma_f32_16x16x32_bf16 v[32:35], a[16:19], v[108:111], v[32:35]
    v_exp_f32 v28, v28
    v_mfma_f32_16x16x32_bf16 v[36:39], a[32:35], v[108:111], v[24:27]
    v_exp_f32 v29, v29
    v_mfma_f32_16x16x32_bf16 v[36:39], a[36:39], v[112:115], v[36:39]
    v_exp_f32 v30, v30
    v_mfma_f32_16x16x32_bf16 v[36:39], a[40:43], v[116:119], v[36:39]
    v_exp_f32 v31, v31
    v_mfma_f32_16x16x32_bf16 v[36:39], a[44:47], v[120:123], v[36:39]
    ds_read_b128 a[20:23], v3 offset:18432
    v_cvt_pk_bf16_f32 v52, v28, v29
    v_mfma_f32_16x16x32_bf16 v[40:43], a[60:63], v[120:123], v[24:27]
    ds_read_b128 a[16:19], v2 offset:18432
    v_cvt_pk_bf16_f32 v53, v30, v31
    v_mfma_f32_16x16x32_bf16 v[40:43], a[56:59], v[116:119], v[40:43]
    v_exp_f32 v32, v32
    v_mfma_f32_16x16x32_bf16 v[40:43], a[52:55], v[112:115], v[40:43]
    v_exp_f32 v33, v33
    v_mfma_f32_16x16x32_bf16 v[40:43], a[48:51], v[108:111], v[40:43]
    v_exp_f32 v34, v34
    v_mfma_f32_16x16x32_bf16 a[204:207], a[192:195], v[44:47], a[204:207]
    v_exp_f32 v35, v35
    v_mfma_f32_16x16x32_bf16 a[204:207], a[192:195], v[48:51], a[204:207]
    ds_read_b128 a[32:35], v2 offset:20480
    v_cvt_pk_bf16_f32 v54, v32, v33
    v_mfma_f32_16x16x32_bf16 v[188:191], a[68:71], v[48:51], v[188:191]
    ds_read_b128 a[36:39], v3 offset:20480
    v_cvt_pk_bf16_f32 v55, v34, v35
    v_mfma_f32_16x16x32_bf16 v[188:191], a[64:67], v[44:47], v[188:191]
    v_exp_f32 v36, v36
    v_mfma_f32_16x16x32_bf16 v[192:195], a[72:75], v[44:47], v[192:195]
    v_exp_f32 v37, v37
    v_mfma_f32_16x16x32_bf16 v[192:195], a[76:79], v[48:51], v[192:195]
    buffer_load_dwordx4 a[148:151], v1, s[4:7], s49 offen offset:64 nt
    v_mfma_f32_16x16x32_bf16 v[196:199], a[84:87], v[48:51], v[196:199]
    s_add_u32 m0, s21, 61312
    v_exp_f32 v38, v38
    v_mfma_f32_16x16x32_bf16 v[196:199], a[80:83], v[44:47], v[196:199]
    v_exp_f32 v39, v39
    v_mfma_f32_16x16x32_bf16 v[200:203], a[88:91], v[44:47], v[200:203]
    ds_read_b128 a[40:43], v2 offset:28672
    v_cvt_pk_bf16_f32 v56, v36, v37
    v_mfma_f32_16x16x32_bf16 v[200:203], a[92:95], v[48:51], v[200:203]
    ds_read_b128 a[44:47], v3 offset:28672
    v_cvt_pk_bf16_f32 v57, v38, v39
    v_mfma_f32_16x16x32_bf16 v[204:207], a[100:103], v[48:51], v[204:207]
    buffer_load_dwordx4 v0, s[8:11], s27 offen offset:128 nt lds
    v_mfma_f32_16x16x32_bf16 v[204:207], a[96:99], v[44:47], v[204:207]
    v_exp_f32 v40, v40
    v_mfma_f32_16x16x32_bf16 v[208:211], a[104:107], v[44:47], v[208:211]
    v_exp_f32 v41, v41
    v_mfma_f32_16x16x32_bf16 v[208:211], a[108:111], v[48:51], v[208:211]
    v_exp_f32 v42, v42
    v_mfma_f32_16x16x32_bf16 v[212:215], a[116:119], v[48:51], v[212:215]
    v_exp_f32 v43, v43
    v_mfma_f32_16x16x32_bf16 v[212:215], a[112:115], v[44:47], v[212:215]
    ds_read_b128 a[60:63], v3 offset:30720
    v_cvt_pk_bf16_f32 v58, v40, v41
    v_mfma_f32_16x16x32_bf16 v[216:219], a[120:123], v[44:47], v[216:219]
    ds_read_b128 a[56:59], v2 offset:30720
    v_cvt_pk_bf16_f32 v59, v42, v43
    v_mfma_f32_16x16x32_bf16 v[216:219], a[124:127], v[48:51], v[216:219]
    s_waitcnt lgkmcnt(4)
    ds_read_b128 a[52:55], v3 offset:22528
    v_mfma_f32_16x16x32_bf16 v[28:31], a[0:3], v[60:63], v[12:15]
    s_add_u32 m0, s21, 114688
    ds_read_b128 a[48:51], v2 offset:22528
    v_mfma_f32_16x16x32_bf16 v[28:31], a[4:7], v[64:67], v[28:31]
    v_mfma_f32_16x16x32_bf16 v[28:31], a[8:11], v[68:71], v[28:31]
    v_mfma_f32_16x16x32_bf16 v[28:31], a[12:15], v[72:75], v[28:31]
    v_mfma_f32_16x16x32_bf16 v[32:35], a[28:31], v[72:75], v[12:15]
    v_mfma_f32_16x16x32_bf16 v[32:35], a[24:27], v[68:71], v[32:35]
    v_mfma_f32_16x16x32_bf16 v[32:35], a[20:23], v[64:67], v[32:35]
    buffer_load_dwordx4 v0, s[12:15], s26 offen nt lds
    v_mfma_f32_16x16x32_bf16 v[32:35], a[16:19], v[60:63], v[32:35]
    s_nop 2
    v_exp_f32 v28, v28
    v_mfma_f32_16x16x32_bf16 v[36:39], a[32:35], v[60:63], v[12:15]
    v_exp_f32 v29, v29
    v_mfma_f32_16x16x32_bf16 v[36:39], a[36:39], v[64:67], v[36:39]
    s_waitcnt lgkmcnt(1)
    v_exp_f32 v30, v30
    v_mfma_f32_16x16x32_bf16 v[36:39], a[40:43], v[68:71], v[36:39]
    v_exp_f32 v31, v31
    v_mfma_f32_16x16x32_bf16 v[36:39], a[44:47], v[72:75], v[36:39]
    v_exp_f32 v32, v32
    v_mfma_f32_16x16x32_bf16 v[40:43], a[60:63], v[72:75], v[12:15]
    v_exp_f32 v33, v33
    v_mfma_f32_16x16x32_bf16 v[40:43], a[56:59], v[68:71], v[40:43]
    v_exp_f32 v34, v34
    v_mfma_f32_16x16x32_bf16 v[40:43], a[52:55], v[64:67], v[40:43]
    s_waitcnt lgkmcnt(0)
    v_exp_f32 v35, v35
    v_mfma_f32_16x16x32_bf16 v[40:43], a[48:51], v[60:63], v[40:43]
    v_exp_f32 v36, v36
    v_mfma_f32_16x16x32_bf16 a[208:211], a[192:195], v[52:55], a[208:211]
    s_add_u32 m0, s21, 122752
    v_exp_f32 v37, v37
    v_mfma_f32_16x16x32_bf16 a[208:211], a[192:195], v[56:59], a[208:211]
    v_exp_f32 v38, v38
    v_mfma_f32_16x16x32_bf16 v[220:223], a[68:71], v[56:59], v[220:223]
    ds_read_b64_tr_b16 a[68:69], v4 offset:20480
    v_cvt_pk_bf16_f32 v44, v28, v29
    v_mfma_f32_16x16x32_bf16 v[220:223], a[64:67], v[52:55], v[220:223]
    ds_read_b64_tr_b16 a[70:71], v4 offset:22528
    v_cvt_pk_bf16_f32 v45, v30, v31
    v_mfma_f32_16x16x32_bf16 v[224:227], a[72:75], v[52:55], v[224:227]
    ds_read_b64_tr_b16 a[64:65], v4 offset:16384
    v_cvt_pk_bf16_f32 v46, v32, v33
    v_mfma_f32_16x16x32_bf16 v[224:227], a[76:79], v[56:59], v[224:227]
    ds_read_b64_tr_b16 a[66:67], v4 offset:18432
    v_cvt_pk_bf16_f32 v47, v34, v35
    v_mfma_f32_16x16x32_bf16 v[228:231], a[84:87], v[56:59], v[228:231]
L_pad3:
    s_cbranch_vccnz L_touched0
    v_exp_f32 v39, v39
    v_mfma_f32_16x16x32_bf16 v[228:231], a[80:83], v[52:55], v[228:231]
    buffer_load_dwordx4 v0, s[12:15], s26 offen offset:128 nt lds
    v_mfma_f32_16x16x32_bf16 v[232:235], a[88:91], v[52:55], v[232:235]
    ds_read_b64_tr_b16 a[72:73], v5 offset:16384
    v_cvt_pk_bf16_f32 v48, v36, v37
    v_mfma_f32_16x16x32_bf16 v[232:235], a[92:95], v[56:59], v[232:235]
    ds_read_b64_tr_b16 a[74:75], v5 offset:18432
    v_cvt_pk_bf16_f32 v49, v38, v39
    v_mfma_f32_16x16x32_bf16 v[236:239], a[100:103], v[56:59], v[236:239]
    v_exp_f32 v40, v40
    v_mfma_f32_16x16x32_bf16 v[236:239], a[96:99], v[52:55], v[236:239]
    v_exp_f32 v41, v41
    v_mfma_f32_16x16x32_bf16 v[240:243], a[104:107], v[52:55], v[240:243]
    buffer_load_dwordx4 a[152:155], v1, s[4:7], s49 offen offset:128 nt
    v_mfma_f32_16x16x32_bf16 v[240:243], a[108:111], v[56:59], v[240:243]
    v_exp_f32 v42, v42
    v_mfma_f32_16x16x32_bf16 v[244:247], a[116:119], v[56:59], v[244:247]
    v_exp_f32 v43, v43
    v_mfma_f32_16x16x32_bf16 v[244:247], a[112:115], v[52:55], v[244:247]
    ds_read_b64_tr_b16 a[76:77], v5 offset:20480
    v_cvt_pk_bf16_f32 v50, v40, v41
    v_mfma_f32_16x16x32_bf16 v[248:251], a[120:123], v[52:55], v[248:251]
    ds_read_b64_tr_b16 a[78:79], v5 offset:22528
    v_cvt_pk_bf16_f32 v51, v42, v43
    v_mfma_f32_16x16x32_bf16 v[248:251], a[124:127], v[56:59], v[248:251]
    s_add_u32 m0, s21, 118784
    ds_read_b64_tr_b16 a[84:85], v6 offset:20480
    v_mfma_f32_16x16x32_bf16 v[28:31], a[0:3], v[76:79], v[16:19]
    ds_read_b64_tr_b16 a[86:87], v6 offset:22528
    v_mfma_f32_16x16x32_bf16 v[28:31], a[4:7], v[80:83], v[28:31]
    ds_read_b64_tr_b16 a[80:81], v6 offset:16384
    v_mfma_f32_16x16x32_bf16 v[28:31], a[8:11], v[84:87], v[28:31]
    ds_read_b64_tr_b16 a[82:83], v6 offset:18432
    v_mfma_f32_16x16x32_bf16 v[28:31], a[12:15], v[88:91], v[28:31]
    ds_read_b64_tr_b16 a[88:89], v7 offset:16384
    v_mfma_f32_16x16x32_bf16 v[32:35], a[28:31], v[88:91], v[16:19]
    ds_read_b64_tr_b16 a[90:91], v7 offset:18432
    v_mfma_f32_16x16x32_bf16 v[32:35], a[24:27], v[84:87], v[32:35]
    ds_read_b64_tr_b16 a[92:93], v7 offset:20480
    v_mfma_f32_16x16x32_bf16 v[32:35], a[20:23], v[80:83], v[32:35]
    buffer_load_dwordx4 v0, s[12:15], s27 offen nt lds
    v_mfma_f32_16x16x32_bf16 v[32:35], a[16:19], v[76:79], v[32:35]
    ds_read_b64_tr_b16 a[94:95], v7 offset:22528
    v_mfma_f32_16x16x32_bf16 v[36:39], a[32:35], v[76:79], v[16:19]
    ds_read_b64_tr_b16 a[100:101], v4 offset:28672
    v_mfma_f32_16x16x32_bf16 v[36:39], a[36:39], v[80:83], v[36:39]
    ds_read_b64_tr_b16 a[102:103], v4 offset:30720
    v_mfma_f32_16x16x32_bf16 v[36:39], a[40:43], v[84:87], v[36:39]
    ds_read_b64_tr_b16 a[96:97], v4 offset:24576
    v_mfma_f32_16x16x32_bf16 v[36:39], a[44:47], v[88:91], v[36:39]
    ds_read_b64_tr_b16 a[98:99], v4 offset:26624
    v_mfma_f32_16x16x32_bf16 v[40:43], a[60:63], v[88:91], v[16:19]
    ds_read_b64_tr_b16 a[104:105], v5 offset:24576
    v_mfma_f32_16x16x32_bf16 v[40:43], a[56:59], v[84:87], v[40:43]
    ds_read_b64_tr_b16 a[106:107], v5 offset:26624
    v_mfma_f32_16x16x32_bf16 v[40:43], a[52:55], v[80:83], v[40:43]
    ds_read_b64_tr_b16 a[108:109], v5 offset:28672
    v_mfma_f32_16x16x32_bf16 v[40:43], a[48:51], v[76:79], v[40:43]
    ds_read_b64_tr_b16 a[110:111], v5 offset:30720
    v_mfma_f32_16x16x32_bf16 a[196:199], a[192:195], v[44:47], a[196:199]
    s_add_u32 m0, s21, 126848
    ds_read_b64_tr_b16 a[116:117], v6 offset:28672
    v_mfma_f32_16x16x32_bf16 a[196:199], a[192:195], v[48:51], a[196:199]
    s_waitcnt lgkmcnt(9)
    ds_read_b64_tr_b16 a[118:119], v6 offset:30720
    v_mfma_f32_16x16x32_bf16 v[124:127], a[68:71], v[48:51], v[124:127]
    ds_read_b64_tr_b16 a[112:113], v6 offset:24576
    v_mfma_f32_16x16x32_bf16 v[124:127], a[64:67], v[44:47], v[124:127]
    ds_read_b64_tr_b16 a[114:115], v6 offset:26624
    v_mfma_f32_16x16x32_bf16 v[128:131], a[72:75], v[44:47], v[128:131]
    ds_read_b64_tr_b16 a[120:121], v7 offset:24576
    v_mfma_f32_16x16x32_bf16 v[128:131], a[76:79], v[48:51], v[128:131]
    ds_read_b64_tr_b16 a[122:123], v7 offset:26624
    v_mfma_f32_16x16x32_bf16 v[132:135], a[84:87], v[48:51], v[132:135]
    ds_read_b64_tr_b16 a[124:125], v7 offset:28672
    v_exp_f32 v28, v28
    v_mfma_f32_16x16x32_bf16 v[132:135], a[80:83], v[44:47], v[132:135]
    ds_read_b64_tr_b16 a[126:127], v7 offset:30720
    buffer_load_dwordx4 v0, s[12:15], s27 offen offset:128 nt lds
    v_mfma_f32_16x16x32_bf16 v[136:139], a[88:91], v[44:47], v[136:139]
    v_exp_f32 v29, v29
    v_mfma_f32_16x16x32_bf16 v[136:139], a[92:95], v[48:51], v[136:139]
    s_waitcnt lgkmcnt(8)
    v_exp_f32 v30, v30
    v_mfma_f32_16x16x32_bf16 v[140:143], a[100:103], v[48:51], v[140:143]
    v_exp_f32 v31, v31
    v_mfma_f32_16x16x32_bf16 v[140:143], a[96:99], v[44:47], v[140:143]
    v_exp_f32 v32, v32
    v_mfma_f32_16x16x32_bf16 v[144:147], a[104:107], v[44:47], v[144:147]
    v_cvt_pk_bf16_f32 v52, v28, v29
    v_cvt_pk_bf16_f32 v53, v30, v31
    v_mfma_f32_16x16x32_bf16 v[144:147], a[108:111], v[48:51], v[144:147]
    s_waitcnt lgkmcnt(4)
    v_exp_f32 v33, v33
    v_mfma_f32_16x16x32_bf16 v[148:151], a[116:119], v[48:51], v[148:151]
    v_exp_f32 v34, v34
    v_mfma_f32_16x16x32_bf16 v[148:151], a[112:115], v[44:47], v[148:151]
    s_waitcnt lgkmcnt(2)
    v_exp_f32 v35, v35
    v_mfma_f32_16x16x32_bf16 v[152:155], a[120:123], v[44:47], v[152:155]
    s_waitcnt lgkmcnt(0)
    v_exp_f32 v36, v36
    v_mfma_f32_16x16x32_bf16 v[152:155], a[124:127], v[48:51], v[152:155]
    v_cvt_pk_bf16_f32 v54, v32, v33
    v_cvt_pk_bf16_f32 v55, v34, v35
    v_mfma_f32_16x16x32_bf16 v[28:31], a[0:3], v[92:95], v[20:23]
    s_waitcnt vmcnt(11)
    s_barrier
    v_mfma_f32_16x16x32_bf16 v[28:31], a[4:7], v[96:99], v[28:31]
    buffer_load_dwordx4 a[156:159], v1, s[4:7], s49 offen offset:192 nt
    v_mfma_f32_16x16x32_bf16 v[28:31], a[8:11], v[100:103], v[28:31]
    s_add_u32 s26, s23, 0
    v_exp_f32 v37, v37
    v_mfma_f32_16x16x32_bf16 v[28:31], a[12:15], v[104:107], v[28:31]
    s_add_u32 s27, s23, 8192
    v_exp_f32 v38, v38
    v_mfma_f32_16x16x32_bf16 v[32:35], a[28:31], v[104:107], v[20:23]
    s_add_u32 m0, s21, 0
    v_exp_f32 v39, v39
    v_mfma_f32_16x16x32_bf16 v[32:35], a[24:27], v[100:103], v[32:35]
    v_cvt_pk_bf16_f32 v56, v36, v37
    v_cvt_pk_bf16_f32 v57, v38, v39
    v_mfma_f32_16x16x32_bf16 v[32:35], a[20:23], v[96:99], v[32:35]
    buffer_load_dwordx4 v0, s[8:11], s26 offen nt lds
    v_mfma_f32_16x16x32_bf16 v[32:35], a[16:19], v[92:95], v[32:35]
    v_exp_f32 v40, v40
    v_mfma_f32_16x16x32_bf16 v[36:39], a[32:35], v[92:95], v[20:23]
    v_exp_f32 v41, v41
    v_mfma_f32_16x16x32_bf16 v[36:39], a[36:39], v[96:99], v[36:39]
    v_exp_f32 v42, v42
    v_mfma_f32_16x16x32_bf16 v[36:39], a[40:43], v[100:103], v[36:39]
    v_exp_f32 v43, v43
    v_mfma_f32_16x16x32_bf16 v[36:39], a[44:47], v[104:107], v[36:39]
    v_cvt_pk_bf16_f32 v58, v40, v41
    v_cvt_pk_bf16_f32 v59, v42, v43
    v_mfma_f32_16x16x32_bf16 v[40:43], a[60:63], v[104:107], v[20:23]
    v_exp_f32 v28, v28
    v_mfma_f32_16x16x32_bf16 v[40:43], a[56:59], v[100:103], v[40:43]
    v_exp_f32 v29, v29
    v_mfma_f32_16x16x32_bf16 v[40:43], a[52:55], v[96:99], v[40:43]
    v_exp_f32 v30, v30
    v_mfma_f32_16x16x32_bf16 v[40:43], a[48:51], v[92:95], v[40:43]
    v_exp_f32 v31, v31
    v_mfma_f32_16x16x32_bf16 a[200:203], a[192:195], v[52:55], a[200:203]
    s_add_u32 m0, s21, 8064
    v_cvt_pk_bf16_f32 v44, v28, v29
    v_cvt_pk_bf16_f32 v45, v30, v31
    v_mfma_f32_16x16x32_bf16 a[200:203], a[192:195], v[56:59], a[200:203]
    v_exp_f32 v32, v32
    v_mfma_f32_16x16x32_bf16 v[156:159], a[68:71], v[56:59], v[156:159]
    v_exp_f32 v33, v33
    v_mfma_f32_16x16x32_bf16 v[156:159], a[64:67], v[52:55], v[156:159]
    v_exp_f32 v34, v34
    v_mfma_f32_16x16x32_bf16 v[160:163], a[72:75], v[52:55], v[160:163]
    v_exp_f32 v35, v35
    v_mfma_f32_16x16x32_bf16 v[160:163], a[76:79], v[56:59], v[160:163]
    v_cvt_pk_bf16_f32 v46, v32, v33
    v_cvt_pk_bf16_f32 v47, v34, v35
    v_mfma_f32_16x16x32_bf16 v[164:167], a[84:87], v[56:59], v[164:167]
    v_exp_f32 v36, v36
    v_mfma_f32_16x16x32_bf16 v[164:167], a[80:83], v[52:55], v[164:167]
    buffer_load_dwordx4 v0, s[8:11], s26 offen offset:128 nt lds
    v_mfma_f32_16x16x32_bf16 v[168:171], a[88:91], v[52:55], v[168:171]
    v_exp_f32 v37, v37
    v_mfma_f32_16x16x32_bf16 v[168:171], a[92:95], v[56:59], v[168:171]
    v_exp_f32 v38, v38
    v_mfma_f32_16x16x32_bf16 v[172:175], a[100:103], v[56:59], v[172:175]
    v_exp_f32 v39, v39
    v_mfma_f32_16x16x32_bf16 v[172:175], a[96:99], v[52:55], v[172:175]
    v_cvt_pk_bf16_f32 v48, v36, v37
    v_cvt_pk_bf16_f32 v49, v38, v39
    v_mfma_f32_16x16x32_bf16 v[176:179], a[104:107], v[52:55], v[176:179]
    v_exp_f32 v40, v40
    v_mfma_f32_16x16x32_bf16 v[176:179], a[108:111], v[56:59], v[176:179]
    v_exp_f32 v41, v41
    v_mfma_f32_16x16x32_bf16 v[180:183], a[116:119], v[56:59], v[180:183]
    v_exp_f32 v42, v42
    v_mfma_f32_16x16x32_bf16 v[180:183], a[112:115], v[52:55], v[180:183]
    v_exp_f32 v43, v43
    v_mfma_f32_16x16x32_bf16 v[184:187], a[120:123], v[52:55], v[184:187]
    v_cvt_pk_bf16_f32 v50, v40, v41
    v_cvt_pk_bf16_f32 v51, v42, v43
    v_mfma_f32_16x16x32_bf16 v[184:187], a[124:127], v[56:59], v[184:187]
    s_add_u32 m0, s21, 4096
    v_mfma_f32_16x16x32_bf16 v[28:31], a[0:3], v[108:111], v[24:27]
    ds_read_b128 a[0:3], v2 offset:32768
    v_mfma_f32_16x16x32_bf16 v[28:31], a[4:7], v[112:115], v[28:31]
    ds_read_b128 a[4:7], v3 offset:32768
    v_mfma_f32_16x16x32_bf16 v[28:31], a[8:11], v[116:119], v[28:31]
    ds_read_b128 a[8:11], v2 offset:40960
    v_mfma_f32_16x16x32_bf16 v[28:31], a[12:15], v[120:123], v[28:31]
    ds_read_b128 a[12:15], v3 offset:40960
    v_mfma_f32_16x16x32_bf16 v[32:35], a[28:31], v[120:123], v[24:27]
    ds_read_b128 a[28:31], v3 offset:43008
    v_mfma_f32_16x16x32_bf16 v[32:35], a[24:27], v[116:119], v[32:35]
    ds_read_b128 a[24:27], v2 offset:43008
    v_mfma_f32_16x16x32_bf16 v[32:35], a[20:23], v[112:115], v[32:35]
    buffer_load_dwordx4 v0, s[8:11], s27 offen nt lds
    v_mfma_f32_16x16x32_bf16 v[32:35], a[16:19], v[108:111], v[32:35]
    s_add_u32 s49, s25, 8192
    v_exp_f32 v28, v28
    v_mfma_f32_16x16x32_bf16 v[36:39], a[32:35], v[108:111], v[24:27]
    v_exp_f32 v29, v29
    v_mfma_f32_16x16x32_bf16 v[36:39], a[36:39], v[112:115], v[36:39]
    v_exp_f32 v30, v30
    v_mfma_f32_16x16x32_bf16 v[36:39], a[40:43], v[116:119], v[36:39]
    v_exp_f32 v31, v31
    v_mfma_f32_16x16x32_bf16 v[36:39], a[44:47], v[120:123], v[36:39]
    buffer_load_dwordx4 a[160:163], v1, s[4:7], s49 offen nt
    v_mfma_f32_16x16x32_bf16 v[40:43], a[60:63], v[120:123], v[24:27]
    ds_read_b128 a[20:23], v3 offset:34816
    v_cvt_pk_bf16_f32 v52, v28, v29
    v_mfma_f32_16x16x32_bf16 v[40:43], a[56:59], v[116:119], v[40:43]
    ds_read_b128 a[16:19], v2 offset:34816
    v_cvt_pk_bf16_f32 v53, v30, v31
    v_mfma_f32_16x16x32_bf16 v[40:43], a[52:55], v[112:115], v[40:43]
    v_exp_f32 v32, v32
    v_mfma_f32_16x16x32_bf16 v[40:43], a[48:51], v[108:111], v[40:43]
    v_exp_f32 v33, v33
    v_mfma_f32_16x16x32_bf16 a[204:207], a[192:195], v[44:47], a[204:207]
    s_add_u32 m0, s21, 12160
    v_exp_f32 v34, v34
    v_mfma_f32_16x16x32_bf16 a[204:207], a[192:195], v[48:51], a[204:207]
    v_exp_f32 v35, v35
    v_mfma_f32_16x16x32_bf16 v[188:191], a[68:71], v[48:51], v[188:191]
    ds_read_b128 a[32:35], v2 offset:36864
    v_cvt_pk_bf16_f32 v54, v32, v33
    v_mfma_f32_16x16x32_bf16 v[188:191], a[64:67], v[44:47], v[188:191]
    ds_read_b128 a[36:39], v3 offset:36864
    v_cvt_pk_bf16_f32 v55, v34, v35
    v_mfma_f32_16x16x32_bf16 v[192:195], a[72:75], v[44:47], v[192:195]
    v_exp_f32 v36, v36
    v_mfma_f32_16x16x32_bf16 v[192:195], a[76:79], v[48:51], v[192:195]
    v_exp_f32 v37, v37
    v_mfma_f32_16x16x32_bf16 v[196:199], a[84:87], v[48:51], v[196:199]
    v_exp_f32 v38, v38
    v_mfma_f32_16x16x32_bf16 v[196:199], a[80:83], v[44:47], v[196:199]
    buffer_load_dwordx4 v0, s[8:11], s27 offen offset:128 nt lds
    v_mfma_f32_16x16x32_bf16 v[200:203], a[88:91], v[44:47], v[200:203]
    v_exp_f32 v39, v39
    v_mfma_f32_16x16x32_bf16 v[200:203], a[92:95], v[48:51], v[200:203]
    ds_read_b128 a[40:43], v2 offset:45056
    v_cvt_pk_bf16_f32 v56, v36, v37
    v_mfma_f32_16x16x32_bf16 v[204:207], a[100:103], v[48:51], v[204:207]
    ds_read_b128 a[44:47], v3 offset:45056
    v_cvt_pk_bf16_f32 v57, v38, v39
    v_mfma_f32_16x16x32_bf16 v[204:207], a[96:99], v[44:47], v[204:207]
    v_exp_f32 v40, v40
    v_mfma_f32_16x16x32_bf16 v[208:211], a[104:107], v[44:47], v[208:211]
    v_exp_f32 v41, v41
    v_mfma_f32_16x16x32_bf16 v[208:211], a[108:111], v[48:51], v[208:211]
    v_exp_f32 v42, v42
    v_mfma_f32_16x16x32_bf16 v[212:215], a[116:119], v[48:51], v[212:215]
    v_exp_f32 v43, v43
    v_mfma_f32_16x16x32_bf16 v[212:215], a[112:115], v[44:47], v[212:215]
    ds_read_b128 a[60:63], v3 offset:47104
    v_cvt_pk_bf16_f32 v58, v40, v41
    v_mfma_f32_16x16x32_bf16 v[216:219], a[120:123], v[44:47], v[216:219]
    ds_read_b128 a[56:59], v2 offset:47104
    v_cvt_pk_bf16_f32 v59, v42, v43
    v_mfma_f32_16x16x32_bf16 v[216:219], a[124:127], v[48:51], v[216:219]
    s_waitcnt lgkmcnt(4)
    ds_read_b128 a[52:55], v3 offset:38912
    v_mfma_f32_16x16x32_bf16 v[28:31], a[0:3], v[60:63], v[12:15]
    s_add_u32 m0, s21, 65536
    ds_read_b128 a[48:51], v2 offset:38912
    v_mfma_f32_16x16x32_bf16 v[28:31], a[4:7], v[64:67], v[28:31]
    v_mfma_f32_16x16x32_bf16 v[28:31], a[8:11], v[68:71], v[28:31]
    v_mfma_f32_16x16x32_bf16 v[28:31], a[12:15], v[72:75], v[28:31]
    v_mfma_f32_16x16x32_bf16 v[32:35], a[28:31], v[72:75], v[12:15]
    v_mfma_f32_16x16x32_bf16 v[32:35], a[24:27], v[68:71], v[32:35]
    v_mfma_f32_16x16x32_bf16 v[32:35], a[20:23], v[64:67], v[32:35]
    buffer_load_dwordx4 v0, s[12:15], s26 offen nt lds
    v_mfma_f32_16x16x32_bf16 v[32:35], a[16:19], v[60:63], v[32:35]
    s_nop 2
    v_exp_f32 v28, v28
    v_mfma_f32_16x16x32_bf16 v[36:39], a[32:35], v[60:63], v[12:15]
    v_exp_f32 v29, v29
    v_mfma_f32_16x16x32_bf16 v[36:39], a[36:39], v[64:67], v[36:39]
    s_waitcnt lgkmcnt(1)
    v_exp_f32 v30, v30
    v_mfma_f32_16x16x32_bf16 v[36:39], a[40:43], v[68:71], v[36:39]
    v_exp_f32 v31, v31
    v_mfma_f32_16x16x32_bf16 v[36:39], a[44:47], v[72:75], v[36:39]
    v_exp_f32 v32, v32
    v_mfma_f32_16x16x32_bf16 v[40:43], a[60:63], v[72:75], v[12:15]
    v_exp_f32 v33, v33
    v_mfma_f32_16x16x32_bf16 v[40:43], a[56:59], v[68:71], v[40:43]
    v_exp_f32 v34, v34
    v_mfma_f32_16x16x32_bf16 v[40:43], a[52:55], v[64:67], v[40:43]
    s_waitcnt lgkmcnt(0)
    buffer_load_dwordx4 a[164:167], v1, s[4:7], s49 offen offset:64 nt
    v_mfma_f32_16x16x32_bf16 v[40:43], a[48:51], v[60:63], v[40:43]
    v_exp_f32 v35, v35
    v_mfma_f32_16x16x32_bf16 a[208:211], a[192:195], v[52:55], a[208:211]
    s_add_u32 m0, s21, 73600
    v_exp_f32 v36, v36
    v_mfma_f32_16x16x32_bf16 a[208:211], a[192:195], v[56:59], a[208:211]
    v_exp_f32 v37, v37
    v_mfma_f32_16x16x32_bf16 v[220:223], a[68:71], v[56:59], v[220:223]
    ds_read_b64_tr_b16 a[68:69], v4 offset:36864
    v_cvt_pk_bf16_f32 v44, v28, v29
    v_mfma_f32_16x16x32_bf16 v[220:223], a[64:67], v[52:55], v[220:223]
    ds_read_b64_tr_b16 a[70:71], v4 offset:38912
    v_cvt_pk_bf16_f32 v45, v30, v31
    v_mfma_f32_16x16x32_bf16 v[224:227], a[72:75], v[52:55], v[224:227]
    ds_read_b64_tr_b16 a[64:65], v4 offset:32768
    v_cvt_pk_bf16_f32 v46, v32, v33
    v_mfma_f32_16x16x32_bf16 v[224:227], a[76:79], v[56:59], v[224:227]
    ds_read_b64_tr_b16 a[66:67], v4 offset:34816
    v_cvt_pk_bf16_f32 v47, v34, v35
    v_mfma_f32_16x16x32_bf16 v[228:231], a[84:87], v[56:59], v[228:231]
    v_exp_f32 v38, v38
    v_mfma_f32_16x16x32_bf16 v[228:231], a[80:83], v[52:55], v[228:231]
    buffer_load_dwordx4 v0, s[12:15], s26 offen offset:128 nt lds
    v_mfma_f32_16x16x32_bf16 v[232:235], a[88:91], v[52:55], v[232:235]
    v_exp_f32 v39, v39
    v_mfma_f32_16x16x32_bf16 v[232:235], a[92:95], v[56:59], v[232:235]
    ds_read_b64_tr_b16 a[72:73], v5 offset:32768
    v_cvt_pk_bf16_f32 v48, v36, v37
    v_mfma_f32_16x16x32_bf16 v[236:239], a[100:103], v[56:59], v[236:239]
    ds_read_b64_tr_b16 a[74:75], v5 offset:34816
    v_cvt_pk_bf16_f32 v49, v38, v39
    v_mfma_f32_16x16x32_bf16 v[236:239], a[96:99], v[52:55], v[236:239]
    v_exp_f32 v40, v40
    v_mfma_f32_16x16x32_bf16 v[240:243], a[104:107], v[52:55], v[240:243]
    v_exp_f32 v41, v41
    v_mfma_f32_16x16x32_bf16 v[240:243], a[108:111], v[56:59], v[240:243]
    v_exp_f32 v42, v42
    v_mfma_f32_16x16x32_bf16 v[244:247], a[116:119], v[56:59], v[244:247]
    v_exp_f32 v43, v43
    v_mfma_f32_16x16x32_bf16 v[244:247], a[112:115], v[52:55], v[244:247]
    ds_read_b64_tr_b16 a[76:77], v5 offset:36864
    v_cvt_pk_bf16_f32 v50, v40, v41
    v_mfma_f32_16x16x32_bf16 v[248:251], a[120:123], v[52:55], v[248:251]
    ds_read_b64_tr_b16 a[78:79], v5 offset:38912
    v_cvt_pk_bf16_f32 v51, v42, v43
    v_mfma_f32_16x16x32_bf16 v[248:251], a[124:127], v[56:59], v[248:251]
    s_add_u32 m0, s21, 69632
    ds_read_b64_tr_b16 a[84:85], v6 offset:36864
    v_mfma_f32_16x16x32_bf16 v[28:31], a[0:3], v[76:79], v[16:19]
    ds_read_b64_tr_b16 a[86:87], v6 offset:38912
    v_mfma_f32_16x16x32_bf16 v[28:31], a[4:7], v[80:83], v[28:31]
    ds_read_b64_tr_b16 a[80:81], v6 offset:32768
    v_mfma_f32_16x16x32_bf16 v[28:31], a[8:11], v[84:87], v[28:31]
    ds_read_b64_tr_b16 a[82:83], v6 offset:34816
    v_mfma_f32_16x16x32_bf16 v[28:31], a[12:15], v[88:91], v[28:31]
    ds_read_b64_tr_b16 a[88:89], v7 offset:32768
    v_mfma_f32_16x16x32_bf16 v[32:35], a[28:31], v[88:91], v[16:19]
    ds_read_b64_tr_b16 a[90:91], v7 offset:34816
    v_mfma_f32_16x16x32_bf16 v[32:35], a[24:27], v[84:87], v[32:35]
    ds_read_b64_tr_b16 a[92:93], v7 offset:36864
    v_mfma_f32_16x16x32_bf16 v[32:35], a[20:23], v[80:83], v[32:35]
    buffer_load_dwordx4 v0, s[12:15], s27 offen nt lds
    v_mfma_f32_16x16x32_bf16 v[32:35], a[16:19], v[76:79], v[32:35]
    ds_read_b64_tr_b16 a[94:95], v7 offset:38912
    v_mfma_f32_16x16x32_bf16 v[36:39], a[32:35], v[76:79], v[16:19]
    ds_read_b64_tr_b16 a[100:101], v4 offset:45056
    v_mfma_f32_16x16x32_bf16 v[36:39], a[36:39], v[80:83], v[36:39]
    ds_read_b64_tr_b16 a[102:103], v4 offset:47104
    v_mfma_f32_16x16x32_bf16 v[36:39], a[40:43], v[84:87], v[36:39]
    ds_read_b64_tr_b16 a[96:97], v4 offset:40960
    v_mfma_f32_16x16x32_bf16 v[36:39], a[44:47], v[88:91], v[36:39]
    ds_read_b64_tr_b16 a[98:99], v4 offset:43008
    v_mfma_f32_16x16x32_bf16 v[40:43], a[60:63], v[88:91], v[16:19]
    ds_read_b64_tr_b16 a[104:105], v5 offset:40960
    v_mfma_f32_16x16x32_bf16 v[40:43], a[56:59], v[84:87], v[40:43]
    ds_read_b64_tr_b16 a[106:107], v5 offset:43008
    v_mfma_f32_16x16x32_bf16 v[40:43], a[52:55], v[80:83], v[40:43]
    ds_read_b64_tr_b16 a[108:109], v5 offset:45056
    v_mfma_f32_16x16x32_bf16 v[40:43], a[48:51], v[76:79], v[40:43]
    ds_read_b64_tr_b16 a[110:111], v5 offset:47104
    v_mfma_f32_16x16x32_bf16 a[196:199], a[192:195], v[44:47], a[196:199]
    ds_read_b64_tr_b16 a[116:117], v6 offset:45056
    v_mfma_f32_16x16x32_bf16 a[196:199], a[192:195], v[48:51], a[196:199]
    s_waitcnt lgkmcnt(9)
    ds_read_b64_tr_b16 a[118:119], v6 offset:47104
    v_mfma_f32_16x16x32_bf16 v[124:127], a[68:71], v[48:51], v[124:127]
    ds_read_b64_tr_b16 a[112:113], v6 offset:40960
    v_mfma_f32_16x16x32_bf16 v[124:127], a[64:67], v[44:47], v[124:127]
    ds_read_b64_tr_b16 a[114:115], v6 offset:43008
    v_mfma_f32_16x16x32_bf16 v[128:131], a[72:75], v[44:47], v[128:131]
    ds_read_b64_tr_b16 a[120:121], v7 offset:40960
    v_mfma_f32_16x16x32_bf16 v[128:131], a[76:79], v[48:51], v[128:131]
    ds_read_b64_tr_b16 a[122:123], v7 offset:43008
    buffer_load_dwordx4 a[168:171], v1, s[4:7], s49 offen offset:128 nt
    v_mfma_f32_16x16x32_bf16 v[132:135], a[84:87], v[48:51], v[132:135]
    s_add_u32 m0, s21, 77696
    ds_read_b64_tr_b16 a[124:125], v7 offset:45056
    v_mfma_f32_16x16x32_bf16 v[132:135], a[80:83], v[44:47], v[132:135]
    ds_read_b64_tr_b16 a[126:127], v7 offset:47104
    v_exp_f32 v28, v28
    v_mfma_f32_16x16x32_bf16 v[136:139], a[88:91], v[44:47], v[136:139]
    v_exp_f32 v29, v29
    v_mfma_f32_16x16x32_bf16 v[136:139], a[92:95], v[48:51], v[136:139]
    s_waitcnt lgkmcnt(8)
    v_exp_f32 v30, v30
    v_mfma_f32_16x16x32_bf16 v[140:143], a[100:103], v[48:51], v[140:143]
    buffer_load_dwordx4 v0, s[12:15], s27 offen offset:128 nt lds
    v_mfma_f32_16x16x32_bf16 v[140:143], a[96:99], v[44:47], v[140:143]
    v_exp_f32 v31, v31
    v_mfma_f32_16x16x32_bf16 v[144:147], a[104:107], v[44:47], v[144:147]
    v_exp_f32 v32, v32
    v_mfma_f32_16x16x32_bf16 v[144:147], a[108:111], v[48:51], v[144:147]
    s_waitcnt lgkmcnt(4)
    v_cvt_pk_bf16_f32 v52, v28, v29
    v_cvt_pk_bf16_f32 v53, v30, v31
    v_mfma_f32_16x16x32_bf16 v[148:151], a[116:119], v[48:51], v[148:151]
    v_exp_f32 v33, v33
    v_mfma_f32_16x16x32_bf16 v[148:151], a[112:115], v[44:47], v[148:151]
    s_waitcnt lgkmcnt(2)
    v_exp_f32 v34, v34
    v_mfma_f32_16x16x32_bf16 v[152:155], a[120:123], v[44:47], v[152:155]
    s_waitcnt lgkmcnt(0)
    v_exp_f32 v35, v35
    v_mfma_f32_16x16x32_bf16 v[152:155], a[124:127], v[48:51], v[152:155]
    s_add_u32 s26, s23, 16384
    v_cvt_pk_bf16_f32 v54, v32, v33
    v_cvt_pk_bf16_f32 v55, v34, v35
    v_mfma_f32_16x16x32_bf16 v[28:31], a[0:3], v[92:95], v[20:23]
    s_waitcnt vmcnt(12)
    s_barrier
    v_mfma_f32_16x16x32_bf16 v[28:31], a[4:7], v[96:99], v[28:31]
    s_add_u32 s27, s23, 24576
    v_exp_f32 v36, v36
    v_mfma_f32_16x16x32_bf16 v[28:31], a[8:11], v[100:103], v[28:31]
    s_add_u32 m0, s21, 16384
    v_exp_f32 v37, v37
    v_mfma_f32_16x16x32_bf16 v[28:31], a[12:15], v[104:107], v[28:31]
    v_exp_f32 v38, v38
    v_mfma_f32_16x16x32_bf16 v[32:35], a[28:31], v[104:107], v[20:23]
    v_exp_f32 v39, v39
    v_mfma_f32_16x16x32_bf16 v[32:35], a[24:27], v[100:103], v[32:35]
    v_cvt_pk_bf16_f32 v56, v36, v37
    v_cvt_pk_bf16_f32 v57, v38, v39
    v_mfma_f32_16x16x32_bf16 v[32:35], a[20:23], v[96:99], v[32:35]
    buffer_load_dwordx4 v0, s[8:11], s26 offen nt lds
    v_mfma_f32_16x16x32_bf16 v[32:35], a[16:19], v[92:95], v[32:35]
    v_exp_f32 v40, v40
    v_mfma_f32_16x16x32_bf16 v[36:39], a[32:35], v[92:95], v[20:23]
    v_exp_f32 v41, v41
    v_mfma_f32_16x16x32_bf16 v[36:39], a[36:39], v[96:99], v[36:39]
    v_exp_f32 v42, v42
    v_mfma_f32_16x16x32_bf16 v[36:39], a[40:43], v[100:103], v[36:39]
    v_exp_f32 v43, v43
    v_mfma_f32_16x16x32_bf16 v[36:39], a[44:47], v[104:107], v[36:39]
    v_cvt_pk_bf16_f32 v58, v40, v41
    v_cvt_pk_bf16_f32 v59, v42, v43
    v_mfma_f32_16x16x32_bf16 v[40:43], a[60:63], v[104:107], v[20:23]
    v_exp_f32 v28, v28
    v_mfma_f32_16x16x32_bf16 v[40:43], a[56:59], v[100:103], v[40:43]
    v_exp_f32 v29, v29
    v_mfma_f32_16x16x32_bf16 v[40:43], a[52:55], v[96:99], v[40:43]
    v_exp_f32 v30, v30
    v_mfma_f32_16x16x32_bf16 v[40:43], a[48:51], v[92:95], v[40:43]
    v_exp_f32 v31, v31
    v_mfma_f32_16x16x32_bf16 a[200:203], a[192:195], v[52:55], a[200:203]
    s_add_u32 m0, s21, 24448
    v_cvt_pk_bf16_f32 v44, v28, v29
    v_cvt_pk_bf16_f32 v45, v30, v31
    v_mfma_f32_16x16x32_bf16 a[200:203], a[192:195], v[56:59], a[200:203]
    v_exp_f32 v32, v32
    v_mfma_f32_16x16x32_bf16 v[156:159], a[68:71], v[56:59], v[156:159]
    v_exp_f32 v33, v33
    v_mfma_f32_16x16x32_bf16 v[156:159], a[64:67], v[52:55], v[156:159]
    v_exp_f32 v34, v34
    v_mfma_f32_16x16x32_bf16 v[160:163], a[72:75], v[52:55], v[160:163]
    v_exp_f32 v35, v35
    v_mfma_f32_16x16x32_bf16 v[160:163], a[76:79], v[56:59], v[160:163]
    v_cvt_pk_bf16_f32 v46, v32, v33
    v_cvt_pk_bf16_f32 v47, v34, v35
    v_mfma_f32_16x16x32_bf16 v[164:167], a[84:87], v[56:59], v[164:167]
    v_exp_f32 v36, v36
    v_mfma_f32_16x16x32_bf16 v[164:167], a[80:83], v[52:55], v[164:167]
    buffer_load_dwordx4 v0, s[8:11], s26 offen offset:128 nt lds
    v_mfma_f32_16x16x32_bf16 v[168:171], a[88:91], v[52:55], v[168:171]
    v_exp_f32 v37, v37
    v_mfma_f32_16x16x32_bf16 v[168:171], a[92:95], v[56:59], v[168:171]
    v_exp_f32 v38, v38
    v_mfma_f32_16x16x32_bf16 v[172:175], a[100:103], v[56:59], v[172:175]
    v_exp_f32 v39, v39
    v_mfma_f32_16x16x32_bf16 v[172:175], a[96:99], v[52:55], v[172:175]
    v_cvt_pk_bf16_f32 v48, v36, v37
    v_cvt_pk_bf16_f32 v49, v38, v39
    v_mfma_f32_16x16x32_bf16 v[176:179], a[104:107], v[52:55], v[176:179]
    buffer_load_dwordx4 a[172:175], v1, s[4:7], s49 offen offset:192 nt
    v_mfma_f32_16x16x32_bf16 v[176:179], a[108:111], v[56:59], v[176:179]
    v_exp_f32 v40, v40
    v_mfma_f32_16x16x32_bf16 v[180:183], a[116:119], v[56:59], v[180:183]
    v_exp_f32 v41, v41
    v_mfma_f32_16x16x32_bf16 v[180:183], a[112:115], v[52:55], v[180:183]
    v_exp_f32 v42, v42
    v_mfma_f32_16x16x32_bf16 v[184:187], a[120:123], v[52:55], v[184:187]
    v_exp_f32 v43, v43
    v_mfma_f32_16x16x32_bf16 v[184:187], a[124:127], v[56:59], v[184:187]
    s_add_u32 m0, s21, 20480
    v_cvt_pk_bf16_f32 v50, v40, v41
    v_cvt_pk_bf16_f32 v51, v42, v43
    v_mfma_f32_16x16x32_bf16 v[28:31], a[0:3], v[108:111], v[24:27]
    ds_read_b128 a[0:3], v2 offset:49152
    v_mfma_f32_16x16x32_bf16 v[28:31], a[4:7], v[112:115], v[28:31]
    ds_read_b128 a[4:7], v3 offset:49152
    v_mfma_f32_16x16x32_bf16 v[28:31], a[8:11], v[116:119], v[28:31]
    ds_read_b128 a[8:11], v2 offset:57344
    v_mfma_f32_16x16x32_bf16 v[28:31], a[12:15], v[120:123], v[28:31]
    ds_read_b128 a[12:15], v3 offset:57344
    v_mfma_f32_16x16x32_bf16 v[32:35], a[28:31], v[120:123], v[24:27]
    ds_read_b128 a[28:31], v3 offset:59392
    v_mfma_f32_16x16x32_bf16 v[32:35], a[24:27], v[116:119], v[32:35]
    ds_read_b128 a[24:27], v2 offset:59392
    v_mfma_f32_16x16x32_bf16 v[32:35], a[20:23], v[112:115], v[32:35]
    buffer_load_dwordx4 v0, s[8:11], s27 offen nt lds
    v_mfma_f32_16x16x32_bf16 v[32:35], a[16:19], v[108:111], v[32:35]
    v_exp_f32 v28, v28
    v_mfma_f32_16x16x32_bf16 v[36:39], a[32:35], v[108:111], v[24:27]
    v_exp_f32 v29, v29
    v_mfma_f32_16x16x32_bf16 v[36:39], a[36:39], v[112:115], v[36:39]
    v_exp_f32 v30, v30
    v_mfma_f32_16x16x32_bf16 v[36:39], a[40:43], v[116:119], v[36:39]
    v_exp_f32 v31, v31
    v_mfma_f32_16x16x32_bf16 v[36:39], a[44:47], v[120:123], v[36:39]
    ds_read_b128 a[20:23], v3 offset:51200
    v_cvt_pk_bf16_f32 v52, v28, v29
    v_mfma_f32_16x16x32_bf16 v[40:43], a[60:63], v[120:123], v[24:27]
    ds_read_b128 a[16:19], v2 offset:51200
    v_cvt_pk_bf16_f32 v53, v30, v31
    v_mfma_f32_16x16x32_bf16 v[40:43], a[56:59], v[116:119], v[40:43]
    v_exp_f32 v32, v32
    v_mfma_f32_16x16x32_bf16 v[40:43], a[52:55], v[112:115], v[40:43]
    v_exp_f32 v33, v33
    v_mfma_f32_16x16x32_bf16 v[40:43], a[48:51], v[108:111], v[40:43]
    v_exp_f32 v34, v34
    v_mfma_f32_16x16x32_bf16 a[204:207], a[192:195], v[44:47], a[204:207]
    s_add_u32 m0, s21, 28544
    v_exp_f32 v35, v35
    v_mfma_f32_16x16x32_bf16 a[204:207], a[192:195], v[48:51], a[204:207]
    ds_read_b128 a[32:35], v2 offset:53248
    v_cvt_pk_bf16_f32 v54, v32, v33
    v_mfma_f32_16x16x32_bf16 v[188:191], a[68:71], v[48:51], v[188:191]
    ds_read_b128 a[36:39], v3 offset:53248
    v_cvt_pk_bf16_f32 v55, v34, v35
    v_mfma_f32_16x16x32_bf16 v[188:191], a[64:67], v[44:47], v[188:191]
    v_exp_f32 v36, v36
    v_mfma_f32_16x16x32_bf16 v[192:195], a[72:75], v[44:47], v[192:195]
    v_exp_f32 v37, v37
    v_mfma_f32_16x16x32_bf16 v[192:195], a[76:79], v[48:51], v[192:195]
    v_exp_f32 v38, v38
    v_mfma_f32_16x16x32_bf16 v[196:199], a[84:87], v[48:51], v[196:199]
    v_exp_f32 v39, v39
    v_mfma_f32_16x16x32_bf16 v[196:199], a[80:83], v[44:47], v[196:199]
    buffer_load_dwordx4 v0, s[8:11], s27 offen offset:128 nt lds
    v_mfma_f32_16x16x32_bf16 v[200:203], a[88:91], v[44:47], v[200:203]
    ds_read_b128 a[40:43], v2 offset:61440
    v_cvt_pk_bf16_f32 v56, v36, v37
    v_mfma_f32_16x16x32_bf16 v[200:203], a[92:95], v[48:51], v[200:203]
    ds_read_b128 a[44:47], v3 offset:61440
    v_cvt_pk_bf16_f32 v57, v38, v39
    v_mfma_f32_16x16x32_bf16 v[204:207], a[100:103], v[48:51], v[204:207]
    v_exp_f32 v40, v40
    v_mfma_f32_16x16x32_bf16 v[204:207], a[96:99], v[44:47], v[204:207]
    v_exp_f32 v41, v41
    v_mfma_f32_16x16x32_bf16 v[208:211], a[104:107], v[44:47], v[208:211]
    s_add_u32 s49, s25, 12288
    v_exp_f32 v42, v42
    v_mfma_f32_16x16x32_bf16 v[208:211], a[108:111], v[48:51], v[208:211]
    v_exp_f32 v43, v43
    v_mfma_f32_16x16x32_bf16 v[212:215], a[116:119], v[48:51], v[212:215]
    ds_read_b128 a[60:63], v3 offset:63488
    v_cvt_pk_bf16_f32 v58, v40, v41
    v_mfma_f32_16x16x32_bf16 v[212:215], a[112:115], v[44:47], v[212:215]
    ds_read_b128 a[56:59], v2 offset:63488
    v_cvt_pk_bf16_f32 v59, v42, v43
    v_mfma_f32_16x16x32_bf16 v[216:219], a[120:123], v[44:47], v[216:219]
    ds_read_b128 a[52:55], v3 offset:55296
    v_mfma_f32_16x16x32_bf16 v[216:219], a[124:127], v[48:51], v[216:219]
    s_waitcnt lgkmcnt(5)
    ds_read_b128 a[48:51], v2 offset:55296
    v_mfma_f32_16x16x32_bf16 v[28:31], a[0:3], v[60:63], v[12:15]
L_pad4:
    s_cbranch_vccnz L_touched1
    v_mfma_f32_16x16x32_bf16 v[28:31], a[4:7], v[64:67], v[28:31]
    buffer_load_dwordx4 a[176:179], v1, s[4:7], s49 offen nt
    v_mfma_f32_16x16x32_bf16 v[28:31], a[8:11], v[68:71], v[28:31]
    s_add_u32 m0, s21, 81920
    v_mfma_f32_16x16x32_bf16 v[28:31], a[12:15], v[72:75], v[28:31]
    v_mfma_f32_16x16x32_bf16 v[32:35], a[28:31], v[72:75], v[12:15]
    v_mfma_f32_16x16x32_bf16 v[32:35], a[24:27], v[68:71], v[32:35]
    v_mfma_f32_16x16x32_bf16 v[32:35], a[20:23], v[64:67], v[32:35]
    v_mfma_f32_16x16x32_bf16 v[32:35], a[16:19], v[60:63], v[32:35]
    buffer_load_dwordx4 v0, s[12:15], s26 offen nt lds
    v_mfma_f32_16x16x32_bf16 v[36:39], a[32:35], v[60:63], v[12:15]
    s_nop 1
    v_exp_f32 v28, v28
    v_mfma_f32_16x16x32_bf16 v[36:39], a[36:39], v[64:67], v[36:39]
    s_waitcnt lgkmcnt(0)
    v_exp_f32 v29, v29
    v_mfma_f32_16x16x32_bf16 v[36:39], a[40:43], v[68:71], v[36:39]
    v_exp_f32 v30, v30
    v_mfma_f32_16x16x32_bf16 v[36:39], a[44:47], v[72:75], v[36:39]
    v_exp_f32 v31, v31
    v_mfma_f32_16x16x32_bf16 v[40:43], a[60:63], v[72:75], v[12:15]
    v_exp_f32 v32, v32
    v_mfma_f32_16x16x32_bf16 v[40:43], a[56:59], v[68:71], v[40:43]
    v_exp_f32 v33, v33
    v_mfma_f32_16x16x32_bf16 v[40:43], a[52:55], v[64:67], v[40:43]
    v_exp_f32 v34, v34
    v_mfma_f32_16x16x32_bf16 v[40:43], a[48:51], v[60:63], v[40:43]
    v_exp_f32 v35, v35
    v_mfma_f32_16x16x32_bf16 a[208:211], a[192:195], v[52:55], a[208:211]
    v_exp_f32 v36, v36
    v_mfma_f32_16x16x32_bf16 a[208:211], a[192:195], v[56:59], a[208:211]
    s_add_u32 m0, s21, 89984
    v_exp_f32 v37, v37
    v_mfma_f32_16x16x32_bf16 v[220:223], a[68:71], v[56:59], v[220:223]
    ds_read_b64_tr_b16 a[68:69], v4 offset:53248
    v_cvt_pk_bf16_f32 v44, v28, v29
    v_mfma_f32_16x16x32_bf16 v[220:223], a[64:67], v[52:55], v[220:223]
    ds_read_b64_tr_b16 a[70:71], v4 offset:55296
    v_cvt_pk_bf16_f32 v45, v30, v31
    v_mfma_f32_16x16x32_bf16 v[224:227], a[72:75], v[52:55], v[224:227]
    ds_read_b64_tr_b16 a[64:65], v4 offset:49152
    v_cvt_pk_bf16_f32 v46, v32, v33
    v_mfma_f32_16x16x32_bf16 v[224:227], a[76:79], v[56:59], v[224:227]
    ds_read_b64_tr_b16 a[66:67], v4 offset:51200
    v_cvt_pk_bf16_f32 v47, v34, v35
    v_mfma_f32_16x16x32_bf16 v[228:231], a[84:87], v[56:59], v[228:231]
    v_exp_f32 v38, v38
    v_mfma_f32_16x16x32_bf16 v[228:231], a[80:83], v[52:55], v[228:231]
    v_exp_f32 v39, v39
    v_mfma_f32_16x16x32_bf16 v[232:235], a[88:91], v[52:55], v[232:235]
    buffer_load_dwordx4 v0, s[12:15], s26 offen offset:128 nt lds
    v_mfma_f32_16x16x32_bf16 v[232:235], a[92:95], v[56:59], v[232:235]
    ds_read_b64_tr_b16 a[72:73], v5 offset:49152
    v_cvt_pk_bf16_f32 v48, v36, v37
    v_mfma_f32_16x16x32_bf16 v[236:239], a[100:103], v[56:59], v[236:239]
    ds_read_b64_tr_b16 a[74:75], v5 offset:51200
    v_cvt_pk_bf16_f32 v49, v38, v39
    v_mfma_f32_16x16x32_bf16 v[236:239], a[96:99], v[52:55], v[236:239]
    v_exp_f32 v40, v40
    v_mfma_f32_16x16x32_bf16 v[240:243], a[104:107], v[52:55], v[240:243]
    v_exp_f32 v41, v41
    v_mfma_f32_16x16x32_bf16 v[240:243], a[108:111], v[56:59], v[240:243]
    v_exp_f32 v42, v42
    v_mfma_f32_16x16x32_bf16 v[244:247], a[116:119], v[56:59], v[244:247]
    v_exp_f32 v43, v43
    v_mfma_f32_16x16x32_bf16 v[244:247], a[112:115], v[52:55], v[244:247]
    ds_read_b64_tr_b16 a[76:77], v5 offset:53248
    v_cvt_pk_bf16_f32 v50, v40, v41
    v_mfma_f32_16x16x32_bf16 v[248:251], a[120:123], v[52:55], v[248:251]
    ds_read_b64_tr_b16 a[78:79], v5 offset:55296
    v_cvt_pk_bf16_f32 v51, v42, v43
    v_mfma_f32_16x16x32_bf16 v[248:251], a[124:127], v[56:59], v[248:251]
    ds_read_b64_tr_b16 a[84:85], v6 offset:53248
    v_mfma_f32_16x16x32_bf16 v[28:31], a[0:3], v[76:79], v[16:19]
    s_add_u32 m0, s21, 86016
    ds_read_b64_tr_b16 a[86:87], v6 offset:55296
    v_mfma_f32_16x16x32_bf16 v[28:31], a[4:7], v[80:83], v[28:31]
    ds_read_b64_tr_b16 a[80:81], v6 offset:49152
    v_mfma_f32_16x16x32_bf16 v[28:31], a[8:11], v[84:87], v[28:31]
    ds_read_b64_tr_b16 a[82:83], v6 offset:51200
    v_mfma_f32_16x16x32_bf16 v[28:31], a[12:15], v[88:91], v[28:31]
    ds_read_b64_tr_b16 a[88:89], v7 offset:49152
    v_mfma_f32_16x16x32_bf16 v[32:35], a[28:31], v[88:91], v[16:19]
    ds_read_b64_tr_b16 a[90:91], v7 offset:51200
    v_mfma_f32_16x16x32_bf16 v[32:35], a[24:27], v[84:87], v[32:35]
    ds_read_b64_tr_b16 a[92:93], v7 offset:53248
    v_mfma_f32_16x16x32_bf16 v[32:35], a[20:23], v[80:83], v[32:35]
    ds_read_b64_tr_b16 a[94:95], v7 offset:55296
    v_mfma_f32_16x16x32_bf16 v[32:35], a[16:19], v[76:79], v[32:35]
    buffer_load_dwordx4 v0, s[12:15], s27 offen nt lds
    v_mfma_f32_16x16x32_bf16 v[36:39], a[32:35], v[76:79], v[16:19]
    ds_read_b64_tr_b16 a[100:101], v4 offset:61440
    v_exp_f32 v28, v28
    v_mfma_f32_16x16x32_bf16 v[36:39], a[36:39], v[80:83], v[36:39]
    ds_read_b64_tr_b16 a[102:103], v4 offset:63488
    v_exp_f32 v29, v29
    v_mfma_f32_16x16x32_bf16 v[36:39], a[40:43], v[84:87], v[36:39]
    ds_read_b64_tr_b16 a[96:97], v4 offset:57344
    v_cvt_pk_bf16_f32 v52, v28, v29
    v_mfma_f32_16x16x32_bf16 v[36:39], a[44:47], v[88:91], v[36:39]
    ds_read_b64_tr_b16 a[98:99], v4 offset:59392
    v_mfma_f32_16x16x32_bf16 v[40:43], a[60:63], v[88:91], v[16:19]
    ds_read_b64_tr_b16 a[104:105], v5 offset:57344
    buffer_load_dwordx4 a[180:183], v1, s[4:7], s49 offen offset:64 nt
    v_mfma_f32_16x16x32_bf16 v[40:43], a[56:59], v[84:87], v[40:43]
    ds_read_b64_tr_b16 a[106:107], v5 offset:59392
    v_mfma_f32_16x16x32_bf16 v[40:43], a[52:55], v[80:83], v[40:43]
    ds_read_b64_tr_b16 a[108:109], v5 offset:61440
    v_mfma_f32_16x16x32_bf16 v[40:43], a[48:51], v[76:79], v[40:43]
    ds_read_b64_tr_b16 a[110:111], v5 offset:63488
    v_mfma_f32_16x16x32_bf16 a[196:199], a[192:195], v[44:47], a[196:199]
    ds_read_b64_tr_b16 a[116:117], v6 offset:61440
    v_exp_f32 v30, v30
    v_mfma_f32_16x16x32_bf16 a[196:199], a[192:195], v[48:51], a[196:199]
    s_waitcnt lgkmcnt(9)
    ds_read_b64_tr_b16 a[118:119], v6 offset:63488
    v_exp_f32 v31, v31
    v_mfma_f32_16x16x32_bf16 v[124:127], a[68:71], v[48:51], v[124:127]
    s_add_u32 m0, s21, 94080
    ds_read_b64_tr_b16 a[112:113], v6 offset:57344
    v_cvt_pk_bf16_f32 v53, v30, v31
    v_mfma_f32_16x16x32_bf16 v[124:127], a[64:67], v[44:47], v[124:127]
    ds_read_b64_tr_b16 a[114:115], v6 offset:59392
    v_mfma_f32_16x16x32_bf16 v[128:131], a[72:75], v[44:47], v[128:131]
    ds_read_b64_tr_b16 a[120:121], v7 offset:57344
    v_mfma_f32_16x16x32_bf16 v[128:131], a[76:79], v[48:51], v[128:131]
    ds_read_b64_tr_b16 a[122:123], v7 offset:59392
    v_mfma_f32_16x16x32_bf16 v[132:135], a[84:87], v[48:51], v[132:135]
    ds_read_b64_tr_b16 a[124:125], v7 offset:61440
    v_mfma_f32_16x16x32_bf16 v[132:135], a[80:83], v[44:47], v[132:135]
    ds_read_b64_tr_b16 a[126:127], v7 offset:63488
    v_mfma_f32_16x16x32_bf16 v[136:139], a[88:91], v[44:47], v[136:139]
    buffer_load_dwordx4 v0, s[12:15], s27 offen offset:128 nt lds
    v_mfma_f32_16x16x32_bf16 v[136:139], a[92:95], v[48:51], v[136:139]
    s_waitcnt lgkmcnt(8)
    v_exp_f32 v32, v32
    v_mfma_f32_16x16x32_bf16 v[140:143], a[100:103], v[48:51], v[140:143]
    v_exp_f32 v33, v33
    v_mfma_f32_16x16x32_bf16 v[140:143], a[96:99], v[44:47], v[140:143]
    v_exp_f32 v34, v34
    v_mfma_f32_16x16x32_bf16 v[144:147], a[104:107], v[44:47], v[144:147]
    v_exp_f32 v35, v35
    v_mfma_f32_16x16x32_bf16 v[144:147], a[108:111], v[48:51], v[144:147]
    s_waitcnt lgkmcnt(4)
    v_exp_f32 v36, v36
    v_mfma_f32_16x16x32_bf16 v[148:151], a[116:119], v[48:51], v[148:151]
    v_exp_f32 v37, v37
    v_mfma_f32_16x16x32_bf16 v[148:151], a[112:115], v[44:47], v[148:151]
    s_waitcnt lgkmcnt(2)
    v_exp_f32 v38, v38
    v_mfma_f32_16x16x32_bf16 v[152:155], a[120:123], v[44:47], v[152:155]
    s_waitcnt lgkmcnt(0)
    v_exp_f32 v39, v39
    v_mfma_f32_16x16x32_bf16 v[152:155], a[124:127], v[48:51], v[152:155]
    s_add_u32 s26, s23, 32768
    v_exp_f32 v40, v40
    v_accvgpr_read_b32 v8, a196
    v_rcp_f32 v60, v8
    v_cmp_nlt_f32 s[32:33], v8, s30
    v_pk_mul_f32 v[124:125], v[124:125], v[60:61] op_sel_hi:[1,0]
    v_pk_mul_f32 v[126:127], v[126:127], v[60:61] op_sel_hi:[1,0]
    v_pk_mul_f32 v[128:129], v[128:129], v[60:61] op_sel_hi:[1,0]
    v_pk_mul_f32 v[130:131], v[130:131], v[60:61] op_sel_hi:[1,0]
    v_pk_mul_f32 v[132:133], v[132:133], v[60:61] op_sel_hi:[1,0]
    v_pk_mul_f32 v[134:135], v[134:135], v[60:61] op_sel_hi:[1,0]
    v_pk_mul_f32 v[136:137], v[136:137], v[60:61] op_sel_hi:[1,0]
    v_pk_mul_f32 v[138:139], v[138:139], v[60:61] op_sel_hi:[1,0]
    v_pk_mul_f32 v[140:141], v[140:141], v[60:61] op_sel_hi:[1,0]
    v_pk_mul_f32 v[142:143], v[142:143], v[60:61] op_sel_hi:[1,0]
    v_pk_mul_f32 v[144:145], v[144:145], v[60:61] op_sel_hi:[1,0]
    v_pk_mul_f32 v[146:147], v[146:147], v[60:61] op_sel_hi:[1,0]
    v_pk_mul_f32 v[148:149], v[148:149], v[60:61] op_sel_hi:[1,0]
    v_pk_mul_f32 v[150:151], v[150:151], v[60:61] op_sel_hi:[1,0]
    v_pk_mul_f32 v[152:153], v[152:153], v[60:61] op_sel_hi:[1,0]
    v_pk_mul_f32 v[154:155], v[154:155], v[60:61] op_sel_hi:[1,0]
    s_waitcnt vmcnt(36)
    v_mfma_f32_16x16x32_bf16 v[60:63], a[214:217], a[128:131], 0
    s_waitcnt vmcnt(11)
    s_barrier
    v_cvt_pk_bf16_f32 v124, v124, v125
    v_cvt_pk_bf16_f32 v125, v126, v127
    v_mfma_f32_16x16x32_bf16 v[60:63], a[218:221], a[128:131], v[60:63]
    s_add_u32 s27, s23, 40960
    v_cvt_pk_bf16_f32 v128, v128, v129
    v_cvt_pk_bf16_f32 v129, v130, v131
    v_mfma_f32_16x16x32_bf16 v[8:11], a[212:215], a[128:131], 0
    s_add_u32 m0, s21, 32768
    v_cvt_pk_bf16_f32 v132, v132, v133
    v_cvt_pk_bf16_f32 v133, v134, v135
    v_mfma_f32_16x16x32_bf16 v[8:11], a[216:219], a[128:131], v[8:11]
    v_cvt_pk_bf16_f32 v136, v136, v137
    v_cvt_pk_bf16_f32 v137, v138, v139
    v_mfma_f32_16x16x32_bf16 v[64:67], a[214:217], a[132:135], 0
    v_cvt_pk_bf16_f32 v140, v140, v141
    v_cvt_pk_bf16_f32 v141, v142, v143
    v_mfma_f32_16x16x32_bf16 v[64:67], a[218:221], a[132:135], v[64:67]
    v_cvt_pk_bf16_f32 v60, v60, v61
    v_cvt_pk_bf16_f32 v61, v62, v63
    v_mfma_f32_16x16x32_bf16 v[12:15], a[212:215], a[132:135], 0
    ds_write_b64 v252, v[124:125] offset:0
    v_cvt_pk_bf16_f32 v144, v144, v145
    v_cvt_pk_bf16_f32 v145, v146, v147
    v_mfma_f32_16x16x32_bf16 v[12:15], a[216:219], a[132:135], v[12:15]
    v_cvt_pk_bf16_f32 v62, v8, v9
    v_cvt_pk_bf16_f32 v63, v10, v11
    v_mfma_f32_16x16x32_bf16 v[68:71], a[214:217], a[136:139], 0
    ds_write_b64 v252, v[128:129] offset:32
    buffer_load_dwordx4 v0, s[8:11], s26 offen nt lds
    v_cvt_pk_bf16_f32 v148, v148, v149
    v_cvt_pk_bf16_f32 v149, v150, v151
    v_mfma_f32_16x16x32_bf16 v[68:71], a[218:221], a[136:139], v[68:71]
    v_cvt_pk_bf16_f32 v64, v64, v65
    v_cvt_pk_bf16_f32 v65, v66, v67
    v_mfma_f32_16x16x32_bf16 v[8:11], a[212:215], a[136:139], 0
    ds_write_b64 v252, v[132:133] offset:64
    v_cvt_pk_bf16_f32 v152, v152, v153
    v_cvt_pk_bf16_f32 v153, v154, v155
    v_mfma_f32_16x16x32_bf16 v[8:11], a[216:219], a[136:139], v[8:11]
    v_cvt_pk_bf16_f32 v66, v12, v13
    v_cvt_pk_bf16_f32 v67, v14, v15
    v_mfma_f32_16x16x32_bf16 v[72:75], a[214:217], a[140:143], 0
    ds_write_b64 v252, v[136:137] offset:96
    v_cvt_pk_bf16_f32 v54, v32, v33
    v_mfma_f32_16x16x32_bf16 v[72:75], a[218:221], a[140:143], v[72:75]
    v_cvt_pk_bf16_f32 v68, v68, v69
    v_cvt_pk_bf16_f32 v69, v70, v71
    v_mfma_f32_16x16x32_bf16 v[12:15], a[212:215], a[140:143], 0
    ds_write_b64 v252, v[140:141] offset:128
    v_cvt_pk_bf16_f32 v55, v34, v35
    v_mfma_f32_16x16x32_bf16 v[12:15], a[216:219], a[140:143], v[12:15]
    buffer_load_dwordx4 a[184:187], v1, s[4:7], s49 offen offset:128 nt
    v_cvt_pk_bf16_f32 v70, v8, v9
    v_cvt_pk_bf16_f32 v71, v10, v11
    v_mfma_f32_16x16x32_bf16 v[28:31], a[0:3], v[92:95], v[20:23]
    ds_write_b64 v252, v[144:145] offset:160
    v_cvt_pk_bf16_f32 v56, v36, v37
    v_mfma_f32_16x16x32_bf16 v[28:31], a[4:7], v[96:99], v[28:31]
    v_cvt_pk_bf16_f32 v72, v72, v73
    v_cvt_pk_bf16_f32 v73, v74, v75
    v_mfma_f32_16x16x32_bf16 v[28:31], a[8:11], v[100:103], v[28:31]
    ds_write_b64 v252, v[148:149] offset:192
    v_cvt_pk_bf16_f32 v57, v38, v39
    v_mfma_f32_16x16x32_bf16 v[28:31], a[12:15], v[104:107], v[28:31]
    v_cvt_pk_bf16_f32 v74, v12, v13
    v_cvt_pk_bf16_f32 v75, v14, v15
    v_mfma_f32_16x16x32_bf16 v[32:35], a[28:31], v[104:107], v[20:23]
    ds_write_b64 v252, v[152:153] offset:224
    v_mfma_f32_16x16x32_bf16 v[32:35], a[24:27], v[100:103], v[32:35]
    v_exp_f32 v41, v41
    v_mfma_f32_16x16x32_bf16 v[32:35], a[20:23], v[96:99], v[32:35]
    ds_read_b128 a[128:131], v253 offset:0
    v_cvt_pk_bf16_f32 v58, v40, v41
    v_mfma_f32_16x16x32_bf16 v[32:35], a[16:19], v[92:95], v[32:35]
    v_exp_f32 v42, v42
    v_mfma_f32_16x16x32_bf16 v[36:39], a[32:35], v[92:95], v[20:23]
    ds_read_b128 a[132:135], v253 offset:1088
    v_mfma_f32_16x16x32_bf16 v[36:39], a[36:39], v[96:99], v[36:39]
    v_exp_f32 v43, v43
    v_mfma_f32_16x16x32_bf16 v[36:39], a[40:43], v[100:103], v[36:39]
    ds_read_b128 a[136:139], v253 offset:2176
    v_cvt_pk_bf16_f32 v59, v42, v43
    v_mfma_f32_16x16x32_bf16 v[36:39], a[44:47], v[104:107], v[36:39]
    s_add_u32 m0, s21, 40832
    v_exp_f32 v28, v28
    v_mfma_f32_16x16x32_bf16 v[40:43], a[60:63], v[104:107], v[20:23]
    ds_read_b128 a[140:143], v253 offset:3264
    v_mfma_f32_16x16x32_bf16 v[40:43], a[56:59], v[100:103], v[40:43]
    v_exp_f32 v29, v29
    v_mfma_f32_16x16x32_bf16 v[40:43], a[52:55], v[96:99], v[40:43]
    v_exp_f32 v30, v30
    v_mfma_f32_16x16x32_bf16 v[40:43], a[48:51], v[92:95], v[40:43]
    v_exp_f32 v31, v31
    v_mfma_f32_16x16x32_bf16 a[200:203], a[192:195], v[52:55], a[200:203]
    v_cvt_pk_bf16_f32 v44, v28, v29
    v_cvt_pk_bf16_f32 v45, v30, v31
    v_mfma_f32_16x16x32_bf16 a[200:203], a[192:195], v[56:59], a[200:203]
    v_exp_f32 v32, v32
    v_mfma_f32_16x16x32_bf16 v[156:159], a[68:71], v[56:59], v[156:159]
    buffer_load_dwordx4 v0, s[8:11], s26 offen offset:128 nt lds
    v_mfma_f32_16x16x32_bf16 v[156:159], a[64:67], v[52:55], v[156:159]
    v_exp_f32 v33, v33
    v_mfma_f32_16x16x32_bf16 v[160:163], a[72:75], v[52:55], v[160:163]
    v_exp_f32 v34, v34
    v_mfma_f32_16x16x32_bf16 v[160:163], a[76:79], v[56:59], v[160:163]
    v_exp_f32 v35, v35
    v_mfma_f32_16x16x32_bf16 v[164:167], a[84:87], v[56:59], v[164:167]
    v_cvt_pk_bf16_f32 v46, v32, v33
    v_cvt_pk_bf16_f32 v47, v34, v35
    v_mfma_f32_16x16x32_bf16 v[164:167], a[80:83], v[52:55], v[164:167]
    v_exp_f32 v36, v36
    v_mfma_f32_16x16x32_bf16 v[168:171], a[88:91], v[52:55], v[168:171]
    v_exp_f32 v37, v37
    v_mfma_f32_16x16x32_bf16 v[168:171], a[92:95], v[56:59], v[168:171]
    v_exp_f32 v38, v38
    v_mfma_f32_16x16x32_bf16 v[172:175], a[100:103], v[56:59], v[172:175]
    v_exp_f32 v39, v39
    v_mfma_f32_16x16x32_bf16 v[172:175], a[96:99], v[52:55], v[172:175]
    v_cvt_pk_bf16_f32 v48, v36, v37
    v_cvt_pk_bf16_f32 v49, v38, v39
    v_mfma_f32_16x16x32_bf16 v[176:179], a[104:107], v[52:55], v[176:179]
    v_exp_f32 v40, v40
    v_mfma_f32_16x16x32_bf16 v[176:179], a[108:111], v[56:59], v[176:179]
    v_exp_f32 v41, v41
    v_mfma_f32_16x16x32_bf16 v[180:183], a[116:119], v[56:59], v[180:183]
    v_exp_f32 v42, v42
    v_mfma_f32_16x16x32_bf16 v[180:183], a[112:115], v[52:55], v[180:183]
    v_exp_f32 v43, v43
    v_mfma_f32_16x16x32_bf16 v[184:187], a[120:123], v[52:55], v[184:187]
    v_cvt_pk_bf16_f32 v50, v40, v41
    v_cvt_pk_bf16_f32 v51, v42, v43
    v_mfma_f32_16x16x32_bf16 v[184:187], a[124:127], v[56:59], v[184:187]
    v_accvgpr_read_b32 v9, a200
    v_rcp_f32 v76, v9
    v_cmp_nlt_f32 s[34:35], v9, s30
    v_pk_mul_f32 v[156:157], v[156:157], v[76:77] op_sel_hi:[1,0]
    v_pk_mul_f32 v[158:159], v[158:159], v[76:77] op_sel_hi:[1,0]
    v_pk_mul_f32 v[160:161], v[160:161], v[76:77] op_sel_hi:[1,0]
    v_pk_mul_f32 v[162:163], v[162:163], v[76:77] op_sel_hi:[1,0]
    v_pk_mul_f32 v[164:165], v[164:165], v[76:77] op_sel_hi:[1,0]
    v_pk_mul_f32 v[166:167], v[166:167], v[76:77] op_sel_hi:[1,0]
    v_pk_mul_f32 v[168:169], v[168:169], v[76:77] op_sel_hi:[1,0]
    v_pk_mul_f32 v[170:171], v[170:171], v[76:77] op_sel_hi:[1,0]
    v_pk_mul_f32 v[172:173], v[172:173], v[76:77] op_sel_hi:[1,0]
    v_pk_mul_f32 v[174:175], v[174:175], v[76:77] op_sel_hi:[1,0]
    v_pk_mul_f32 v[176:177], v[176:177], v[76:77] op_sel_hi:[1,0]
    v_pk_mul_f32 v[178:179], v[178:179], v[76:77] op_sel_hi:[1,0]
    v_pk_mul_f32 v[180:181], v[180:181], v[76:77] op_sel_hi:[1,0]
    v_pk_mul_f32 v[182:183], v[182:183], v[76:77] op_sel_hi:[1,0]
    v_pk_mul_f32 v[184:185], v[184:185], v[76:77] op_sel_hi:[1,0]
    v_pk_mul_f32 v[186:187], v[186:187], v[76:77] op_sel_hi:[1,0]
    s_waitcnt vmcnt(25)
    v_mfma_f32_16x16x32_bf16 v[76:79], a[214:217], a[144:147], 0
    v_cvt_pk_bf16_f32 v156, v156, v157
    v_cvt_pk_bf16_f32 v157, v158, v159
    v_mfma_f32_16x16x32_bf16 v[76:79], a[218:221], a[144:147], v[76:79]
    v_cvt_pk_bf16_f32 v160, v160, v161
    v_cvt_pk_bf16_f32 v161, v162, v163
    v_mfma_f32_16x16x32_bf16 v[8:11], a[212:215], a[144:147], 0
    v_cvt_pk_bf16_f32 v164, v164, v165
    v_cvt_pk_bf16_f32 v165, v166, v167
    v_mfma_f32_16x16x32_bf16 v[8:11], a[216:219], a[144:147], v[8:11]
    v_cvt_pk_bf16_f32 v168, v168, v169
    v_cvt_pk_bf16_f32 v169, v170, v171
    v_mfma_f32_16x16x32_bf16 v[80:83], a[214:217], a[148:151], 0
    v_cvt_pk_bf16_f32 v172, v172, v173
    v_cvt_pk_bf16_f32 v173, v174, v175
    v_mfma_f32_16x16x32_bf16 v[80:83], a[218:221], a[148:151], v[80:83]
    v_cvt_pk_bf16_f32 v76, v76, v77
    v_cvt_pk_bf16_f32 v77, v78, v79
    v_mfma_f32_16x16x32_bf16 v[16:19], a[212:215], a[148:151], 0
    ds_write_b64 v252, v[156:157] offset:0
    buffer_load_dwordx4 a[188:191], v1, s[4:7], s49 offen offset:192 nt
    v_cvt_pk_bf16_f32 v176, v176, v177
    v_cvt_pk_bf16_f32 v177, v178, v179
    v_mfma_f32_16x16x32_bf16 v[16:19], a[216:219], a[148:151], v[16:19]
    s_add_u32 m0, s21, 36864
    v_cvt_pk_bf16_f32 v78, v8, v9
    v_cvt_pk_bf16_f32 v79, v10, v11
    v_mfma_f32_16x16x32_bf16 v[84:87], a[214:217], a[152:155], 0
    ds_write_b64 v252, v[160:161] offset:32
    v_cvt_pk_bf16_f32 v180, v180, v181
    v_cvt_pk_bf16_f32 v181, v182, v183
    v_mfma_f32_16x16x32_bf16 v[84:87], a[218:221], a[152:155], v[84:87]
    v_cvt_pk_bf16_f32 v80, v80, v81
    v_cvt_pk_bf16_f32 v81, v82, v83
    v_mfma_f32_16x16x32_bf16 v[8:11], a[212:215], a[152:155], 0
    ds_write_b64 v252, v[164:165] offset:64
    v_cvt_pk_bf16_f32 v184, v184, v185
    v_cvt_pk_bf16_f32 v185, v186, v187
    v_mfma_f32_16x16x32_bf16 v[8:11], a[216:219], a[152:155], v[8:11]
    buffer_load_dwordx4 v0, s[8:11], s27 offen nt lds
    v_cvt_pk_bf16_f32 v82, v16, v17
    v_cvt_pk_bf16_f32 v83, v18, v19
    v_mfma_f32_16x16x32_bf16 v[88:91], a[214:217], a[156:159], 0
    ds_write_b64 v252, v[168:169] offset:96
    v_mfma_f32_16x16x32_bf16 v[88:91], a[218:221], a[156:159], v[88:91]
    v_cvt_pk_bf16_f32 v84, v84, v85
    v_cvt_pk_bf16_f32 v85, v86, v87
    v_mfma_f32_16x16x32_bf16 v[16:19], a[212:215], a[156:159], 0
    ds_write_b64 v252, v[172:173] offset:128
    v_mfma_f32_16x16x32_bf16 v[16:19], a[216:219], a[156:159], v[16:19]
    v_cvt_pk_bf16_f32 v86, v8, v9
    v_cvt_pk_bf16_f32 v87, v10, v11
    v_mfma_f32_16x16x32_bf16 v[28:31], a[0:3], v[108:111], v[24:27]
    ds_write_b64 v252, v[176:177] offset:160
    v_mfma_f32_16x16x32_bf16 v[28:31], a[4:7], v[112:115], v[28:31]
    v_cvt_pk_bf16_f32 v88, v88, v89
    v_cvt_pk_bf16_f32 v89, v90, v91
    v_mfma_f32_16x16x32_bf16 v[28:31], a[8:11], v[116:119], v[28:31]
    ds_write_b64 v252, v[180:181] offset:192
    v_mfma_f32_16x16x32_bf16 v[28:31], a[12:15], v[120:123], v[28:31]
    v_cvt_pk_bf16_f32 v90, v16, v17
    v_cvt_pk_bf16_f32 v91, v18, v19
    v_mfma_f32_16x16x32_bf16 v[32:35], a[28:31], v[120:123], v[24:27]
    ds_write_b64 v252, v[184:185] offset:224
    v_mfma_f32_16x16x32_bf16 v[32:35], a[24:27], v[116:119], v[32:35]
    ds_read_b128 a[0:3], v2 offset:0
    v_mfma_f32_16x16x32_bf16 v[32:35], a[20:23], v[112:115], v[32:35]
    ds_read_b128 a[144:147], v253 offset:0
    v_mfma_f32_16x16x32_bf16 v[32:35], a[16:19], v[108:111], v[32:35]
    s_add_u32 s50, s24, 0
    ds_read_b128 a[4:7], v3 offset:0
    v_mfma_f32_16x16x32_bf16 v[36:39], a[32:35], v[108:111], v[24:27]
    ds_read_b128 a[8:11], v2 offset:8192
    ds_read_b128 a[148:151], v253 offset:1088
    v_mfma_f32_16x16x32_bf16 v[36:39], a[36:39], v[112:115], v[36:39]
    ds_read_b128 a[12:15], v3 offset:8192
    v_mfma_f32_16x16x32_bf16 v[36:39], a[40:43], v[116:119], v[36:39]
    ds_read_b128 a[152:155], v253 offset:2176
    v_mfma_f32_16x16x32_bf16 v[36:39], a[44:47], v[120:123], v[36:39]
    v_exp_f32 v28, v28
    v_mfma_f32_16x16x32_bf16 v[40:43], a[60:63], v[120:123], v[24:27]
    ds_read_b128 a[156:159], v253 offset:3264
    v_mfma_f32_16x16x32_bf16 v[40:43], a[56:59], v[116:119], v[40:43]
    v_exp_f32 v29, v29
    v_mfma_f32_16x16x32_bf16 v[40:43], a[52:55], v[112:115], v[40:43]
    s_waitcnt lgkmcnt(15)
    buffer_store_dwordx4 a[128:131], v254, s[16:19], s50 offen sc1
    v_mfma_f32_16x16x32_bf16 v[40:43], a[48:51], v[108:111], v[40:43]
    s_waitcnt lgkmcnt(7)
    v_exp_f32 v30, v30
    v_mfma_f32_16x16x32_bf16 v[124:127], a[0:3], v[60:63], 0
    s_waitcnt lgkmcnt(5)
    v_exp_f32 v31, v31
    v_mfma_f32_16x16x32_bf16 v[124:127], a[4:7], v[64:67], v[124:127]
    s_waitcnt lgkmcnt(4)
    ds_read_b128 a[28:31], v3 offset:10240
    v_cvt_pk_bf16_f32 v52, v28, v29
    v_mfma_f32_16x16x32_bf16 v[124:127], a[8:11], v[68:71], v[124:127]
    s_waitcnt lgkmcnt(3)
    ds_read_b128 a[24:27], v2 offset:10240
    v_cvt_pk_bf16_f32 v53, v30, v31
    v_mfma_f32_16x16x32_bf16 v[124:127], a[12:15], v[72:75], v[124:127]
    s_add_u32 m0, s21, 44928
    v_exp_f32 v32, v32
    v_mfma_f32_16x16x32_bf16 a[204:207], a[192:195], v[44:47], a[204:207]
    v_exp_f32 v33, v33
    v_mfma_f32_16x16x32_bf16 a[204:207], a[192:195], v[48:51], a[204:207]
    buffer_load_dwordx4 v0, s[8:11], s27 offen offset:128 nt lds
    v_mfma_f32_16x16x32_bf16 v[188:191], a[68:71], v[48:51], v[188:191]
    v_exp_f32 v34, v34
    v_mfma_f32_16x16x32_bf16 v[188:191], a[64:67], v[44:47], v[188:191]
    ds_read_b128 a[20:23], v3 offset:2048
    v_max3_f32 v124, v124, v125, v126
    v_mfma_f32_16x16x32_bf16 v[192:195], a[72:75], v[44:47], v[192:195]
    v_max_f32 v124, v124, v127
    v_mov_b32 v125, v124
    v_mfma_f32_16x16x32_bf16 v[192:195], a[76:79], v[48:51], v[192:195]
    v_exp_f32 v35, v35
    v_mfma_f32_16x16x32_bf16 v[196:199], a[84:87], v[48:51], v[196:199]
    v_permlane32_swap_b32 v125, v124
    v_mfma_f32_16x16x32_bf16 v[196:199], a[80:83], v[44:47], v[196:199]
    v_max_f32 v124, v125, v124
    v_mov_b32 v125, v124
    v_mfma_f32_16x16x32_bf16 v[200:203], a[88:91], v[44:47], v[200:203]
    ds_read_b128 a[16:19], v2 offset:2048
    v_cvt_pk_bf16_f32 v54, v32, v33
    v_mfma_f32_16x16x32_bf16 v[200:203], a[92:95], v[48:51], v[200:203]
    v_permlane16_swap_b32 v125, v124
    v_mfma_f32_16x16x32_bf16 v[204:207], a[100:103], v[48:51], v[204:207]
    ds_read_b128 a[32:35], v2 offset:4096
    v_min_f32 v12, -v125, -v124
    v_mfma_f32_16x16x32_bf16 v[204:207], a[96:99], v[44:47], v[204:207]
    ds_read_b128 a[36:39], v3 offset:4096
    v_min_f32 v13, -v125, -v124
    v_mfma_f32_16x16x32_bf16 v[208:211], a[104:107], v[44:47], v[208:211]
    ds_read_b128 a[40:43], v2 offset:12288
    v_min_f32 v14, -v125, -v124
    v_mfma_f32_16x16x32_bf16 v[208:211], a[108:111], v[48:51], v[208:211]
    ds_read_b128 a[44:47], v3 offset:12288
    v_min_f32 v15, -v125, -v124
    v_mfma_f32_16x16x32_bf16 v[212:215], a[116:119], v[48:51], v[212:215]
    v_exp_f32 v36, v36
    v_mfma_f32_16x16x32_bf16 v[212:215], a[112:115], v[44:47], v[212:215]
    ds_read_b128 a[60:63], v3 offset:14336
    v_cvt_pk_bf16_f32 v55, v34, v35
    v_mfma_f32_16x16x32_bf16 v[216:219], a[120:123], v[44:47], v[216:219]
    ds_read_b128 a[56:59], v2 offset:14336
    v_mfma_f32_16x16x32_bf16 v[216:219], a[124:127], v[48:51], v[216:219]
    ds_read_b128 a[52:55], v3 offset:6144
    v_accvgpr_read_b32 v10, a204
    v_rcp_f32 v92, v10
    v_cmp_nlt_f32 s[36:37], v10, s30
    v_pk_mul_f32 v[188:189], v[188:189], v[92:93] op_sel_hi:[1,0]
    v_pk_mul_f32 v[190:191], v[190:191], v[92:93] op_sel_hi:[1,0]
    v_pk_mul_f32 v[192:193], v[192:193], v[92:93] op_sel_hi:[1,0]
    v_pk_mul_f32 v[194:195], v[194:195], v[92:93] op_sel_hi:[1,0]
    v_pk_mul_f32 v[196:197], v[196:197], v[92:93] op_sel_hi:[1,0]
    v_pk_mul_f32 v[198:199], v[198:199], v[92:93] op_sel_hi:[1,0]
    v_pk_mul_f32 v[200:201], v[200:201], v[92:93] op_sel_hi:[1,0]
    v_pk_mul_f32 v[202:203], v[202:203], v[92:93] op_sel_hi:[1,0]
    v_pk_mul_f32 v[204:205], v[204:205], v[92:93] op_sel_hi:[1,0]
    v_pk_mul_f32 v[206:207], v[206:207], v[92:93] op_sel_hi:[1,0]
    v_pk_mul_f32 v[208:209], v[208:209], v[92:93] op_sel_hi:[1,0]
    v_pk_mul_f32 v[210:211], v[210:211], v[92:93] op_sel_hi:[1,0]
    v_pk_mul_f32 v[212:213], v[212:213], v[92:93] op_sel_hi:[1,0]
    v_pk_mul_f32 v[214:215], v[214:215], v[92:93] op_sel_hi:[1,0]
    v_pk_mul_f32 v[216:217], v[216:217], v[92:93] op_sel_hi:[1,0]
    v_pk_mul_f32 v[218:219], v[218:219], v[92:93] op_sel_hi:[1,0]
    s_waitcnt vmcnt(15)
    v_mfma_f32_16x16x32_bf16 v[92:95], a[214:217], a[160:163], 0
    v_cvt_pk_bf16_f32 v188, v188, v189
    v_cvt_pk_bf16_f32 v189, v190, v191
    v_mfma_f32_16x16x32_bf16 v[92:95], a[218:221], a[160:163], v[92:95]
    v_cvt_pk_bf16_f32 v192, v192, v193
    v_cvt_pk_bf16_f32 v193, v194, v195
    v_mfma_f32_16x16x32_bf16 v[8:11], a[212:215], a[160:163], 0
    s_add_u32 m0, s21, 98304
    v_cvt_pk_bf16_f32 v196, v196, v197
    v_cvt_pk_bf16_f32 v197, v198, v199
    v_mfma_f32_16x16x32_bf16 v[8:11], a[216:219], a[160:163], v[8:11]
    v_cvt_pk_bf16_f32 v200, v200, v201
    v_cvt_pk_bf16_f32 v201, v202, v203
    v_mfma_f32_16x16x32_bf16 v[96:99], a[214:217], a[164:167], 0
    v_cvt_pk_bf16_f32 v204, v204, v205
    v_cvt_pk_bf16_f32 v205, v206, v207
    v_mfma_f32_16x16x32_bf16 v[96:99], a[218:221], a[164:167], v[96:99]
    ds_read_b128 a[48:51], v2 offset:6144
    v_cvt_pk_bf16_f32 v92, v92, v93
    v_cvt_pk_bf16_f32 v93, v94, v95
    v_mfma_f32_16x16x32_bf16 v[20:23], a[212:215], a[164:167], 0
    ds_write_b64 v252, v[188:189] offset:0
    v_cvt_pk_bf16_f32 v208, v208, v209
    v_cvt_pk_bf16_f32 v209, v210, v211
    v_mfma_f32_16x16x32_bf16 v[20:23], a[216:219], a[164:167], v[20:23]
    v_cvt_pk_bf16_f32 v94, v8, v9
    v_cvt_pk_bf16_f32 v95, v10, v11
    v_mfma_f32_16x16x32_bf16 v[100:103], a[214:217], a[168:171], 0
    ds_write_b64 v252, v[192:193] offset:32
    v_cvt_pk_bf16_f32 v212, v212, v213
    v_cvt_pk_bf16_f32 v213, v214, v215
    v_mfma_f32_16x16x32_bf16 v[100:103], a[218:221], a[168:171], v[100:103]
    buffer_load_dwordx4 v0, s[12:15], s26 offen nt lds
    v_cvt_pk_bf16_f32 v96, v96, v97
    v_cvt_pk_bf16_f32 v97, v98, v99
    v_mfma_f32_16x16x32_bf16 v[8:11], a[212:215], a[168:171], 0
    ds_write_b64 v252, v[196:197] offset:64
    v_cvt_pk_bf16_f32 v216, v216, v217
    v_cvt_pk_bf16_f32 v217, v218, v219
    v_mfma_f32_16x16x32_bf16 v[8:11], a[216:219], a[168:171], v[8:11]
    v_cvt_pk_bf16_f32 v98, v20, v21
    v_cvt_pk_bf16_f32 v99, v22, v23
    v_mfma_f32_16x16x32_bf16 v[104:107], a[214:217], a[172:175], 0
    ds_write_b64 v252, v[200:201] offset:96
    v_exp_f32 v37, v37
    v_mfma_f32_16x16x32_bf16 v[104:107], a[218:221], a[172:175], v[104:107]
    v_cvt_pk_bf16_f32 v100, v100, v101
    v_cvt_pk_bf16_f32 v101, v102, v103
    v_mfma_f32_16x16x32_bf16 v[20:23], a[212:215], a[172:175], 0
    ds_write_b64 v252, v[204:205] offset:128
    v_cvt_pk_bf16_f32 v56, v36, v37
    v_mfma_f32_16x16x32_bf16 v[20:23], a[216:219], a[172:175], v[20:23]
    v_cvt_pk_bf16_f32 v102, v8, v9
    v_cvt_pk_bf16_f32 v103, v10, v11
    v_mfma_f32_16x16x32_bf16 v[28:31], a[0:3], v[60:63], v[12:15]
L_pad5:
    s_cbranch_vccnz L_touched1
    ds_write_b64 v252, v[208:209] offset:160
    v_exp_f32 v38, v38
    v_mfma_f32_16x16x32_bf16 v[28:31], a[4:7], v[64:67], v[28:31]
    v_cvt_pk_bf16_f32 v104, v104, v105
    v_cvt_pk_bf16_f32 v105, v106, v107
    v_mfma_f32_16x16x32_bf16 v[28:31], a[8:11], v[68:71], v[28:31]
    ds_write_b64 v252, v[212:213] offset:192
    v_exp_f32 v39, v39
    v_mfma_f32_16x16x32_bf16 v[28:31], a[12:15], v[72:75], v[28:31]
    s_waitcnt lgkmcnt(5)
    v_cvt_pk_bf16_f32 v106, v20, v21
    v_cvt_pk_bf16_f32 v107, v22, v23
    v_mfma_f32_16x16x32_bf16 v[32:35], a[28:31], v[72:75], v[12:15]
    ds_write_b64 v252, v[216:217] offset:224
    v_cvt_pk_bf16_f32 v57, v38, v39
    v_mfma_f32_16x16x32_bf16 v[32:35], a[24:27], v[68:71], v[32:35]
    v_exp_f32 v40, v40
    v_mfma_f32_16x16x32_bf16 v[32:35], a[20:23], v[64:67], v[32:35]
    ds_read_b128 a[160:163], v253 offset:0
    v_exp_f32 v41, v41
    v_mfma_f32_16x16x32_bf16 v[32:35], a[16:19], v[60:63], v[32:35]
    v_exp_f32 v42, v42
    v_mfma_f32_16x16x32_bf16 v[36:39], a[32:35], v[60:63], v[12:15]
    ds_read_b128 a[164:167], v253 offset:1088
    v_cvt_pk_bf16_f32 v58, v40, v41
    v_mfma_f32_16x16x32_bf16 v[36:39], a[36:39], v[64:67], v[36:39]
    v_exp_f32 v43, v43
    v_mfma_f32_16x16x32_bf16 v[36:39], a[40:43], v[68:71], v[36:39]
    ds_read_b128 a[168:171], v253 offset:2176
    v_cvt_pk_bf16_f32 v59, v42, v43
    v_mfma_f32_16x16x32_bf16 v[36:39], a[44:47], v[72:75], v[36:39]
    v_exp_f32 v28, v28
    v_mfma_f32_16x16x32_bf16 v[40:43], a[60:63], v[72:75], v[12:15]
    s_add_u32 m0, s21, 106368
    ds_read_b128 a[172:175], v253 offset:3264
    v_mfma_f32_16x16x32_bf16 v[40:43], a[56:59], v[68:71], v[40:43]
    v_exp_f32 v29, v29
    v_mfma_f32_16x16x32_bf16 v[40:43], a[52:55], v[64:67], v[40:43]
    v_exp_f32 v30, v30
    v_mfma_f32_16x16x32_bf16 v[40:43], a[48:51], v[60:63], v[40:43]
    v_exp_f32 v31, v31
    v_mfma_f32_16x16x32_bf16 v[156:159], a[0:3], v[76:79], 0
    v_exp_f32 v32, v32
    v_mfma_f32_16x16x32_bf16 v[156:159], a[4:7], v[80:83], v[156:159]
    v_exp_f32 v33, v33
    v_mfma_f32_16x16x32_bf16 v[156:159], a[8:11], v[84:87], v[156:159]
    v_exp_f32 v34, v34
    v_mfma_f32_16x16x32_bf16 v[156:159], a[12:15], v[88:91], v[156:159]
    buffer_load_dwordx4 v0, s[12:15], s26 offen offset:128 nt lds
    v_mfma_f32_16x16x32_bf16 a[208:211], a[192:195], v[52:55], a[208:211]
    v_exp_f32 v35, v35
    v_mfma_f32_16x16x32_bf16 a[208:211], a[192:195], v[56:59], a[208:211]
    v_exp_f32 v36, v36
    v_mfma_f32_16x16x32_bf16 v[220:223], a[68:71], v[56:59], v[220:223]
    ds_read_b64_tr_b16 a[68:69], v4 offset:4096
    v_cvt_pk_bf16_f32 v44, v28, v29
    v_mfma_f32_16x16x32_bf16 v[220:223], a[64:67], v[52:55], v[220:223]
    ds_read_b64_tr_b16 a[70:71], v4 offset:6144
    v_max3_f32 v156, v156, v157, v158
    v_mfma_f32_16x16x32_bf16 v[224:227], a[72:75], v[52:55], v[224:227]
    buffer_store_dwordx4 a[132:135], v254, s[16:19], s50 offen offset:1024 sc1
    v_max_f32 v156, v156, v159
    v_mov_b32 v157, v156
    v_mfma_f32_16x16x32_bf16 v[224:227], a[76:79], v[56:59], v[224:227]
    ds_read_b64_tr_b16 a[64:65], v4 offset:0
    v_cvt_pk_bf16_f32 v45, v30, v31
    v_mfma_f32_16x16x32_bf16 v[228:231], a[84:87], v[56:59], v[228:231]
    v_permlane32_swap_b32 v157, v156
    v_mfma_f32_16x16x32_bf16 v[228:231], a[80:83], v[52:55], v[228:231]
    v_max_f32 v156, v157, v156
    v_mov_b32 v157, v156
    v_mfma_f32_16x16x32_bf16 v[232:235], a[88:91], v[52:55], v[232:235]
    ds_read_b64_tr_b16 a[66:67], v4 offset:2048
    v_cvt_pk_bf16_f32 v46, v32, v33
    v_mfma_f32_16x16x32_bf16 v[232:235], a[92:95], v[56:59], v[232:235]
    v_permlane16_swap_b32 v157, v156
    v_mfma_f32_16x16x32_bf16 v[236:239], a[100:103], v[56:59], v[236:239]
    ds_read_b64_tr_b16 a[72:73], v5 offset:0
    v_min_f32 v16, -v157, -v156
    v_mfma_f32_16x16x32_bf16 v[236:239], a[96:99], v[52:55], v[236:239]
    ds_read_b64_tr_b16 a[74:75], v5 offset:2048
    v_min_f32 v17, -v157, -v156
    v_mfma_f32_16x16x32_bf16 v[240:243], a[104:107], v[52:55], v[240:243]
    ds_read_b64_tr_b16 a[76:77], v5 offset:4096
    v_min_f32 v18, -v157, -v156
    v_mfma_f32_16x16x32_bf16 v[240:243], a[108:111], v[56:59], v[240:243]
    ds_read_b64_tr_b16 a[78:79], v5 offset:6144
    v_min_f32 v19, -v157, -v156
    v_mfma_f32_16x16x32_bf16 v[244:247], a[116:119], v[56:59], v[244:247]
    ds_read_b64_tr_b16 a[84:85], v6 offset:4096
    v_cvt_pk_bf16_f32 v47, v34, v35
    v_mfma_f32_16x16x32_bf16 v[244:247], a[112:115], v[52:55], v[244:247]
    v_exp_f32 v37, v37
    v_mfma_f32_16x16x32_bf16 v[248:251], a[120:123], v[52:55], v[248:251]
    ds_read_b64_tr_b16 a[86:87], v6 offset:6144
    v_cvt_pk_bf16_f32 v48, v36, v37
    v_mfma_f32_16x16x32_bf16 v[248:251], a[124:127], v[56:59], v[248:251]
    ds_read_b64_tr_b16 a[80:81], v6 offset:0
    v_accvgpr_read_b32 v11, a208
    v_rcp_f32 v108, v11
    v_cmp_nlt_f32 s[38:39], v11, s30
    v_pk_mul_f32 v[220:221], v[220:221], v[108:109] op_sel_hi:[1,0]
    v_pk_mul_f32 v[222:223], v[222:223], v[108:109] op_sel_hi:[1,0]
    v_pk_mul_f32 v[224:225], v[224:225], v[108:109] op_sel_hi:[1,0]
    v_pk_mul_f32 v[226:227], v[226:227], v[108:109] op_sel_hi:[1,0]
    v_pk_mul_f32 v[228:229], v[228:229], v[108:109] op_sel_hi:[1,0]
    v_pk_mul_f32 v[230:231], v[230:231], v[108:109] op_sel_hi:[1,0]
    v_pk_mul_f32 v[232:233], v[232:233], v[108:109] op_sel_hi:[1,0]
    v_pk_mul_f32 v[234:235], v[234:235], v[108:109] op_sel_hi:[1,0]
    v_pk_mul_f32 v[236:237], v[236:237], v[108:109] op_sel_hi:[1,0]
    v_pk_mul_f32 v[238:239], v[238:239], v[108:109] op_sel_hi:[1,0]
    v_pk_mul_f32 v[240:241], v[240:241], v[108:109] op_sel_hi:[1,0]
    v_pk_mul_f32 v[242:243], v[242:243], v[108:109] op_sel_hi:[1,0]
    v_pk_mul_f32 v[244:245], v[244:245], v[108:109] op_sel_hi:[1,0]
    v_pk_mul_f32 v[246:247], v[246:247], v[108:109] op_sel_hi:[1,0]
    v_pk_mul_f32 v[248:249], v[248:249], v[108:109] op_sel_hi:[1,0]
    v_pk_mul_f32 v[250:251], v[250:251], v[108:109] op_sel_hi:[1,0]
    s_waitcnt vmcnt(6)
    v_mfma_f32_16x16x32_bf16 v[108:111], a[214:217], a[176:179], 0
    v_cvt_pk_bf16_f32 v220, v220, v221
    v_cvt_pk_bf16_f32 v221, v222, v223
    v_mfma_f32_16x16x32_bf16 v[108:111], a[218:221], a[176:179], v[108:111]
    s_add_u32 m0, s21, 102400
    v_cvt_pk_bf16_f32 v224, v224, v225
    v_cvt_pk_bf16_f32 v225, v226, v227
    v_mfma_f32_16x16x32_bf16 v[8:11], a[212:215], a[176:179], 0
    v_cvt_pk_bf16_f32 v228, v228, v229
    v_cvt_pk_bf16_f32 v229, v230, v231
    v_mfma_f32_16x16x32_bf16 v[8:11], a[216:219], a[176:179], v[8:11]
    v_cvt_pk_bf16_f32 v232, v232, v233
    v_cvt_pk_bf16_f32 v233, v234, v235
    v_mfma_f32_16x16x32_bf16 v[112:115], a[214:217], a[180:183], 0
    v_cvt_pk_bf16_f32 v236, v236, v237
    v_cvt_pk_bf16_f32 v237, v238, v239
    v_mfma_f32_16x16x32_bf16 v[112:115], a[218:221], a[180:183], v[112:115]
    v_cvt_pk_bf16_f32 v108, v108, v109
    v_cvt_pk_bf16_f32 v109, v110, v111
    v_mfma_f32_16x16x32_bf16 v[24:27], a[212:215], a[180:183], 0
    ds_write_b64 v252, v[220:221] offset:0
    v_cvt_pk_bf16_f32 v240, v240, v241
    v_cvt_pk_bf16_f32 v241, v242, v243
    v_mfma_f32_16x16x32_bf16 v[24:27], a[216:219], a[180:183], v[24:27]
    v_cvt_pk_bf16_f32 v110, v8, v9
    v_cvt_pk_bf16_f32 v111, v10, v11
    v_mfma_f32_16x16x32_bf16 v[116:119], a[214:217], a[184:187], 0
    ds_write_b64 v252, v[224:225] offset:32
    buffer_load_dwordx4 v0, s[12:15], s27 offen nt lds
    v_cvt_pk_bf16_f32 v244, v244, v245
    v_cvt_pk_bf16_f32 v245, v246, v247
    v_mfma_f32_16x16x32_bf16 v[116:119], a[218:221], a[184:187], v[116:119]
    v_cvt_pk_bf16_f32 v112, v112, v113
    v_cvt_pk_bf16_f32 v113, v114, v115
    v_mfma_f32_16x16x32_bf16 v[8:11], a[212:215], a[184:187], 0
    ds_write_b64 v252, v[228:229] offset:64
    v_cvt_pk_bf16_f32 v248, v248, v249
    v_cvt_pk_bf16_f32 v249, v250, v251
    v_mfma_f32_16x16x32_bf16 v[8:11], a[216:219], a[184:187], v[8:11]
    v_cvt_pk_bf16_f32 v114, v24, v25
    v_cvt_pk_bf16_f32 v115, v26, v27
    v_mfma_f32_16x16x32_bf16 v[120:123], a[214:217], a[188:191], 0
    ds_write_b64 v252, v[232:233] offset:96
    v_exp_f32 v38, v38
    v_mfma_f32_16x16x32_bf16 v[120:123], a[218:221], a[188:191], v[120:123]
    v_cvt_pk_bf16_f32 v116, v116, v117
    v_cvt_pk_bf16_f32 v117, v118, v119
    v_mfma_f32_16x16x32_bf16 v[24:27], a[212:215], a[188:191], 0
    ds_write_b64 v252, v[236:237] offset:128
    v_exp_f32 v39, v39
    v_mfma_f32_16x16x32_bf16 v[24:27], a[216:219], a[188:191], v[24:27]
    v_cvt_pk_bf16_f32 v118, v8, v9
    v_cvt_pk_bf16_f32 v119, v10, v11
    v_mfma_f32_16x16x32_bf16 v[28:31], a[0:3], v[76:79], v[16:19]
    ds_write_b64 v252, v[240:241] offset:160
    v_cvt_pk_bf16_f32 v49, v38, v39
    v_mfma_f32_16x16x32_bf16 v[28:31], a[4:7], v[80:83], v[28:31]
    v_cvt_pk_bf16_f32 v120, v120, v121
    v_cvt_pk_bf16_f32 v121, v122, v123
    v_mfma_f32_16x16x32_bf16 v[28:31], a[8:11], v[84:87], v[28:31]
    ds_write_b64 v252, v[244:245] offset:192
    v_exp_f32 v40, v40
    v_mfma_f32_16x16x32_bf16 v[28:31], a[12:15], v[88:91], v[28:31]
    v_cvt_pk_bf16_f32 v122, v24, v25
    v_cvt_pk_bf16_f32 v123, v26, v27
    v_mfma_f32_16x16x32_bf16 v[32:35], a[28:31], v[88:91], v[16:19]
    ds_write_b64 v252, v[248:249] offset:224
    v_exp_f32 v41, v41
    v_mfma_f32_16x16x32_bf16 v[32:35], a[24:27], v[84:87], v[32:35]
    v_exp_f32 v42, v42
    v_mfma_f32_16x16x32_bf16 v[32:35], a[20:23], v[80:83], v[32:35]
    ds_read_b128 a[176:179], v253 offset:0
    v_cvt_pk_bf16_f32 v50, v40, v41
    v_mfma_f32_16x16x32_bf16 v[32:35], a[16:19], v[76:79], v[32:35]
    ds_read_b64_tr_b16 a[82:83], v6 offset:2048
    v_exp_f32 v43, v43
    v_mfma_f32_16x16x32_bf16 v[36:39], a[32:35], v[76:79], v[16:19]
    ds_read_b128 a[180:183], v253 offset:1088
    v_cvt_pk_bf16_f32 v51, v42, v43
    v_mfma_f32_16x16x32_bf16 v[36:39], a[36:39], v[80:83], v[36:39]
    ds_read_b64_tr_b16 a[88:89], v7 offset:0
    v_mfma_f32_16x16x32_bf16 v[36:39], a[40:43], v[84:87], v[36:39]
    ds_read_b128 a[184:187], v253 offset:2176
    v_mfma_f32_16x16x32_bf16 v[36:39], a[44:47], v[88:91], v[36:39]
    s_add_u32 m0, s21, 110464
    ds_read_b64_tr_b16 a[90:91], v7 offset:2048
    v_mfma_f32_16x16x32_bf16 v[40:43], a[60:63], v[88:91], v[16:19]
    ds_read_b128 a[188:191], v253 offset:3264
    v_mfma_f32_16x16x32_bf16 v[40:43], a[56:59], v[84:87], v[40:43]
    ds_read_b64_tr_b16 a[92:93], v7 offset:4096
    v_mfma_f32_16x16x32_bf16 v[40:43], a[52:55], v[80:83], v[40:43]
    ds_read_b64_tr_b16 a[94:95], v7 offset:6144
    v_mfma_f32_16x16x32_bf16 v[40:43], a[48:51], v[76:79], v[40:43]
    ds_read_b64_tr_b16 a[100:101], v4 offset:12288
    v_mfma_f32_16x16x32_bf16 v[188:191], a[0:3], v[92:95], 0
    ds_read_b64_tr_b16 a[102:103], v4 offset:14336
    v_exp_f32 v28, v28
    v_mfma_f32_16x16x32_bf16 v[188:191], a[4:7], v[96:99], v[188:191]
    ds_read_b64_tr_b16 a[96:97], v4 offset:8192
    v_exp_f32 v29, v29
    v_mfma_f32_16x16x32_bf16 v[188:191], a[8:11], v[100:103], v[188:191]
    ds_read_b64_tr_b16 a[98:99], v4 offset:10240
    buffer_load_dwordx4 v0, s[12:15], s27 offen offset:128 nt lds
    v_mfma_f32_16x16x32_bf16 v[188:191], a[12:15], v[104:107], v[188:191]
    ds_read_b64_tr_b16 a[104:105], v5 offset:8192
    v_cvt_pk_bf16_f32 v52, v28, v29
    v_mfma_f32_16x16x32_bf16 a[196:199], a[192:195], v[44:47], 0
    ds_read_b64_tr_b16 a[106:107], v5 offset:10240
    v_exp_f32 v30, v30
    v_mfma_f32_16x16x32_bf16 a[196:199], a[192:195], v[48:51], a[196:199]
    s_waitcnt lgkmcnt(9)
    ds_read_b64_tr_b16 a[108:109], v5 offset:12288
    ds_read_b64_tr_b16 a[110:111], v5 offset:14336
    v_mfma_f32_16x16x32_bf16 v[124:127], a[68:71], v[48:51], 0
    ds_read_b64_tr_b16 a[116:117], v6 offset:12288
    ds_read_b64_tr_b16 a[118:119], v6 offset:14336
    v_mfma_f32_16x16x32_bf16 v[124:127], a[64:67], v[44:47], v[124:127]
    ds_read_b64_tr_b16 a[112:113], v6 offset:8192
    v_max3_f32 v188, v188, v189, v190
    v_mfma_f32_16x16x32_bf16 v[128:131], a[72:75], v[44:47], 0
    ds_read_b64_tr_b16 a[114:115], v6 offset:10240
    v_max_f32 v188, v188, v191
    v_mov_b32 v189, v188
    v_mfma_f32_16x16x32_bf16 v[128:131], a[76:79], v[48:51], v[128:131]
    ds_read_b64_tr_b16 a[120:121], v7 offset:8192
    ds_read_b64_tr_b16 a[122:123], v7 offset:10240
    v_mfma_f32_16x16x32_bf16 v[132:135], a[84:87], v[48:51], 0
    ds_read_b64_tr_b16 a[124:125], v7 offset:12288
    buffer_store_dwordx4 a[136:139], v254, s[16:19], s50 offen offset:2048 sc1
    v_permlane32_swap_b32 v189, v188
    v_mfma_f32_16x16x32_bf16 v[132:135], a[80:83], v[44:47], v[132:135]
    ds_read_b64_tr_b16 a[126:127], v7 offset:14336
    v_max_f32 v188, v189, v188
    v_mov_b32 v189, v188
    v_mfma_f32_16x16x32_bf16 v[136:139], a[88:91], v[44:47], 0
    s_waitcnt lgkmcnt(12)
    v_exp_f32 v31, v31
    v_mfma_f32_16x16x32_bf16 v[136:139], a[92:95], v[48:51], v[136:139]
    v_permlane16_swap_b32 v189, v188
    v_mfma_f32_16x16x32_bf16 v[140:143], a[100:103], v[48:51], 0
    v_min_f32 v20, -v189, -v188
    v_cvt_pk_bf16_f32 v53, v30, v31
    v_mfma_f32_16x16x32_bf16 v[140:143], a[96:99], v[44:47], v[140:143]
    s_waitcnt lgkmcnt(8)
    v_min_f32 v21, -v189, -v188
    v_mfma_f32_16x16x32_bf16 v[144:147], a[104:107], v[44:47], 0
    v_min_f32 v22, -v189, -v188
    v_mfma_f32_16x16x32_bf16 v[144:147], a[108:111], v[48:51], v[144:147]
    s_waitcnt lgkmcnt(5)
    v_min_f32 v23, -v189, -v188
    v_exp_f32 v32, v32
    v_mfma_f32_16x16x32_bf16 v[148:151], a[116:119], v[48:51], 0
    s_waitcnt lgkmcnt(4)
    v_exp_f32 v33, v33
    v_mfma_f32_16x16x32_bf16 v[148:151], a[112:115], v[44:47], v[148:151]
    s_waitcnt lgkmcnt(2)
    v_exp_f32 v34, v34
    v_mfma_f32_16x16x32_bf16 v[152:155], a[120:123], v[44:47], 0
    s_waitcnt lgkmcnt(0)
    v_exp_f32 v35, v35
    v_mfma_f32_16x16x32_bf16 v[152:155], a[124:127], v[48:51], v[152:155]
    s_add_u32 s26, s23, 49152
    v_cvt_pk_bf16_f32 v54, v32, v33
    v_cvt_pk_bf16_f32 v55, v34, v35
    v_mfma_f32_16x16x32_bf16 v[28:31], a[0:3], v[92:95], v[20:23]
    s_waitcnt vmcnt(13)
    s_barrier
    v_mfma_f32_16x16x32_bf16 v[28:31], a[4:7], v[96:99], v[28:31]
    s_add_u32 s27, s23, 57344
    v_exp_f32 v36, v36
    v_mfma_f32_16x16x32_bf16 v[28:31], a[8:11], v[100:103], v[28:31]
    s_add_u32 m0, s21, 49152
    v_exp_f32 v37, v37
    v_mfma_f32_16x16x32_bf16 v[28:31], a[12:15], v[104:107], v[28:31]
    v_exp_f32 v38, v38
    v_mfma_f32_16x16x32_bf16 v[32:35], a[28:31], v[104:107], v[20:23]
    v_exp_f32 v39, v39
    v_mfma_f32_16x16x32_bf16 v[32:35], a[24:27], v[100:103], v[32:35]
    v_exp_f32 v40, v40
    v_mfma_f32_16x16x32_bf16 v[32:35], a[20:23], v[96:99], v[32:35]
    v_cvt_pk_bf16_f32 v56, v36, v37
    v_cvt_pk_bf16_f32 v57, v38, v39
    v_mfma_f32_16x16x32_bf16 v[32:35], a[16:19], v[92:95], v[32:35]
    buffer_load_dwordx4 v0, s[8:11], s26 offen nt lds
    v_mfma_f32_16x16x32_bf16 v[36:39], a[32:35], v[92:95], v[20:23]
    v_exp_f32 v41, v41
    v_mfma_f32_16x16x32_bf16 v[36:39], a[36:39], v[96:99], v[36:39]
    v_exp_f32 v42, v42
    v_mfma_f32_16x16x32_bf16 v[36:39], a[40:43], v[100:103], v[36:39]
    v_exp_f32 v43, v43
    v_mfma_f32_16x16x32_bf16 v[36:39], a[44:47], v[104:107], v[36:39]
    v_cvt_pk_bf16_f32 v58, v40, v41
    v_cvt_pk_bf16_f32 v59, v42, v43
    v_mfma_f32_16x16x32_bf16 v[40:43], a[60:63], v[104:107], v[20:23]
    v_exp_f32 v28, v28
    v_mfma_f32_16x16x32_bf16 v[40:43], a[56:59], v[100:103], v[40:43]
    v_exp_f32 v29, v29
    v_mfma_f32_16x16x32_bf16 v[40:43], a[52:55], v[96:99], v[40:43]
    v_exp_f32 v30, v30
    v_mfma_f32_16x16x32_bf16 v[40:43], a[48:51], v[92:95], v[40:43]
    v_exp_f32 v31, v31
    v_mfma_f32_16x16x32_bf16 v[220:223], a[0:3], v[108:111], 0
    v_exp_f32 v32, v32
    v_mfma_f32_16x16x32_bf16 v[220:223], a[4:7], v[112:115], v[220:223]
    s_add_u32 m0, s21, 57216
    v_exp_f32 v33, v33
    v_mfma_f32_16x16x32_bf16 v[220:223], a[8:11], v[116:119], v[220:223]
    v_exp_f32 v34, v34
    v_mfma_f32_16x16x32_bf16 v[220:223], a[12:15], v[120:123], v[220:223]
    v_exp_f32 v35, v35
    v_mfma_f32_16x16x32_bf16 a[200:203], a[192:195], v[52:55], 0
    v_exp_f32 v36, v36
    v_mfma_f32_16x16x32_bf16 a[200:203], a[192:195], v[56:59], a[200:203]
    v_exp_f32 v37, v37
    v_mfma_f32_16x16x32_bf16 v[156:159], a[68:71], v[56:59], 0
    v_exp_f32 v38, v38
    v_mfma_f32_16x16x32_bf16 v[156:159], a[64:67], v[52:55], v[156:159]
    v_max3_f32 v220, v220, v221, v222
    v_cvt_pk_bf16_f32 v44, v28, v29
    v_mfma_f32_16x16x32_bf16 v[160:163], a[72:75], v[52:55], 0
    buffer_load_dwordx4 v0, s[8:11], s26 offen offset:128 nt lds
    v_max_f32 v220, v220, v223
    v_mov_b32 v221, v220
    v_mfma_f32_16x16x32_bf16 v[160:163], a[76:79], v[56:59], v[160:163]
    v_exp_f32 v39, v39
    v_mfma_f32_16x16x32_bf16 v[164:167], a[84:87], v[56:59], 0
    v_permlane32_swap_b32 v221, v220
    v_mfma_f32_16x16x32_bf16 v[164:167], a[80:83], v[52:55], v[164:167]
    v_max_f32 v220, v221, v220
    v_mov_b32 v221, v220
    v_mfma_f32_16x16x32_bf16 v[168:171], a[88:91], v[52:55], 0
    v_exp_f32 v40, v40
    v_mfma_f32_16x16x32_bf16 v[168:171], a[92:95], v[56:59], v[168:171]
    v_permlane16_swap_b32 v221, v220
    v_mfma_f32_16x16x32_bf16 v[172:175], a[100:103], v[56:59], 0
    v_min_f32 v24, -v221, -v220
    v_cvt_pk_bf16_f32 v45, v30, v31
    v_mfma_f32_16x16x32_bf16 v[172:175], a[96:99], v[52:55], v[172:175]
    v_min_f32 v25, -v221, -v220
    v_cvt_pk_bf16_f32 v46, v32, v33
    v_mfma_f32_16x16x32_bf16 v[176:179], a[104:107], v[52:55], 0
    v_min_f32 v26, -v221, -v220
    v_cvt_pk_bf16_f32 v47, v34, v35
    v_mfma_f32_16x16x32_bf16 v[176:179], a[108:111], v[56:59], v[176:179]
    v_min_f32 v27, -v221, -v220
    v_cvt_pk_bf16_f32 v48, v36, v37
    v_mfma_f32_16x16x32_bf16 v[180:183], a[116:119], v[56:59], 0
    s_add_u32 m0, s21, 53248
    v_exp_f32 v41, v41
    v_mfma_f32_16x16x32_bf16 v[180:183], a[112:115], v[52:55], v[180:183]
    v_cvt_pk_bf16_f32 v49, v38, v39
    v_cvt_pk_bf16_f32 v50, v40, v41
    v_mfma_f32_16x16x32_bf16 v[184:187], a[120:123], v[52:55], 0
    v_exp_f32 v42, v42
    v_mfma_f32_16x16x32_bf16 v[184:187], a[124:127], v[56:59], v[184:187]
    v_exp_f32 v43, v43
    v_mfma_f32_16x16x32_bf16 v[28:31], a[0:3], v[108:111], v[24:27]
    ds_read_b128 a[0:3], v2 offset:16384
    v_cvt_pk_bf16_f32 v51, v42, v43
    v_mfma_f32_16x16x32_bf16 v[28:31], a[4:7], v[112:115], v[28:31]
    ds_read_b128 a[4:7], v3 offset:16384
    v_mfma_f32_16x16x32_bf16 v[28:31], a[8:11], v[116:119], v[28:31]
    ds_read_b128 a[8:11], v2 offset:24576
    v_mfma_f32_16x16x32_bf16 v[28:31], a[12:15], v[120:123], v[28:31]
    buffer_load_dwordx4 v0, s[8:11], s27 offen nt lds
    v_mfma_f32_16x16x32_bf16 v[32:35], a[28:31], v[120:123], v[24:27]
    ds_read_b128 a[12:15], v3 offset:24576
    v_mfma_f32_16x16x32_bf16 v[32:35], a[24:27], v[116:119], v[32:35]
    ds_read_b128 a[28:31], v3 offset:26624
    v_mfma_f32_16x16x32_bf16 v[32:35], a[20:23], v[112:115], v[32:35]
    ds_read_b128 a[24:27], v2 offset:26624
    v_mfma_f32_16x16x32_bf16 v[32:35], a[16:19], v[108:111], v[32:35]
    v_exp_f32 v28, v28
    v_mfma_f32_16x16x32_bf16 v[36:39], a[32:35], v[108:111], v[24:27]
    v_exp_f32 v29, v29
    v_mfma_f32_16x16x32_bf16 v[36:39], a[36:39], v[112:115], v[36:39]
    v_exp_f32 v30, v30
    v_mfma_f32_16x16x32_bf16 v[36:39], a[40:43], v[116:119], v[36:39]
    v_exp_f32 v31, v31
    v_mfma_f32_16x16x32_bf16 v[36:39], a[44:47], v[120:123], v[36:39]
    buffer_store_dwordx4 a[140:143], v254, s[16:19], s50 offen offset:3072 sc1
    v_mfma_f32_16x16x32_bf16 v[40:43], a[60:63], v[120:123], v[24:27]
    ds_read_b128 a[20:23], v3 offset:18432
    v_cvt_pk_bf16_f32 v52, v28, v29
    v_mfma_f32_16x16x32_bf16 v[40:43], a[56:59], v[116:119], v[40:43]
    ds_read_b128 a[16:19], v2 offset:18432
    v_cvt_pk_bf16_f32 v53, v30, v31
    v_mfma_f32_16x16x32_bf16 v[40:43], a[52:55], v[112:115], v[40:43]
    s_add_u32 m0, s21, 61312
    v_exp_f32 v32, v32
    v_mfma_f32_16x16x32_bf16 v[40:43], a[48:51], v[108:111], v[40:43]
    v_exp_f32 v33, v33
    v_mfma_f32_16x16x32_bf16 a[204:207], a[192:195], v[44:47], 0
    v_exp_f32 v34, v34
    v_mfma_f32_16x16x32_bf16 a[204:207], a[192:195], v[48:51], a[204:207]
    v_exp_f32 v35, v35
    v_mfma_f32_16x16x32_bf16 v[188:191], a[68:71], v[48:51], 0
    ds_read_b128 a[32:35], v2 offset:20480
    v_cvt_pk_bf16_f32 v54, v32, v33
    v_mfma_f32_16x16x32_bf16 v[188:191], a[64:67], v[44:47], v[188:191]
    ds_read_b128 a[36:39], v3 offset:20480
    v_cvt_pk_bf16_f32 v55, v34, v35
    v_mfma_f32_16x16x32_bf16 v[192:195], a[72:75], v[44:47], 0
    v_exp_f32 v36, v36
    v_mfma_f32_16x16x32_bf16 v[192:195], a[76:79], v[48:51], v[192:195]
    buffer_load_dwordx4 v0, s[8:11], s27 offen offset:128 nt lds
    v_mfma_f32_16x16x32_bf16 v[196:199], a[84:87], v[48:51], 0
    v_exp_f32 v37, v37
    v_mfma_f32_16x16x32_bf16 v[196:199], a[80:83], v[44:47], v[196:199]
    v_exp_f32 v38, v38
    v_mfma_f32_16x16x32_bf16 v[200:203], a[88:91], v[44:47], 0
    v_exp_f32 v39, v39
    v_mfma_f32_16x16x32_bf16 v[200:203], a[92:95], v[48:51], v[200:203]
    ds_read_b128 a[40:43], v2 offset:28672
    v_cvt_pk_bf16_f32 v56, v36, v37
    v_mfma_f32_16x16x32_bf16 v[204:207], a[100:103], v[48:51], 0
    ds_read_b128 a[44:47], v3 offset:28672
    v_cvt_pk_bf16_f32 v57, v38, v39
    v_mfma_f32_16x16x32_bf16 v[204:207], a[96:99], v[44:47], v[204:207]
    v_exp_f32 v40, v40
    v_mfma_f32_16x16x32_bf16 v[208:211], a[104:107], v[44:47], 0
    v_exp_f32 v41, v41
    v_mfma_f32_16x16x32_bf16 v[208:211], a[108:111], v[48:51], v[208:211]
    v_exp_f32 v42, v42
    v_mfma_f32_16x16x32_bf16 v[212:215], a[116:119], v[48:51], 0
    v_exp_f32 v43, v43
    v_mfma_f32_16x16x32_bf16 v[212:215], a[112:115], v[44:47], v[212:215]
    s_add_u32 m0, s21, 114688
    ds_read_b128 a[60:63], v3 offset:30720
    v_cvt_pk_bf16_f32 v58, v40, v41
    v_mfma_f32_16x16x32_bf16 v[216:219], a[120:123], v[44:47], 0
    ds_read_b128 a[56:59], v2 offset:30720
    v_cvt_pk_bf16_f32 v59, v42, v43
    v_mfma_f32_16x16x32_bf16 v[216:219], a[124:127], v[48:51], v[216:219]
    s_waitcnt lgkmcnt(4)
    ds_read_b128 a[52:55], v3 offset:22528
    v_mfma_f32_16x16x32_bf16 v[28:31], a[0:3], v[60:63], v[12:15]
    ds_read_b128 a[48:51], v2 offset:22528
    v_mfma_f32_16x16x32_bf16 v[28:31], a[4:7], v[64:67], v[28:31]
    v_mfma_f32_16x16x32_bf16 v[28:31], a[8:11], v[68:71], v[28:31]
    v_mfma_f32_16x16x32_bf16 v[28:31], a[12:15], v[72:75], v[28:31]
    v_mfma_f32_16x16x32_bf16 v[32:35], a[28:31], v[72:75], v[12:15]
    buffer_load_dwordx4 v0, s[12:15], s26 offen nt lds
    v_mfma_f32_16x16x32_bf16 v[32:35], a[24:27], v[68:71], v[32:35]
    v_mfma_f32_16x16x32_bf16 v[32:35], a[20:23], v[64:67], v[32:35]
    v_mfma_f32_16x16x32_bf16 v[32:35], a[16:19], v[60:63], v[32:35]
    s_nop 2
    v_exp_f32 v28, v28
    v_mfma_f32_16x16x32_bf16 v[36:39], a[32:35], v[60:63], v[12:15]
    v_exp_f32 v29, v29
    v_mfma_f32_16x16x32_bf16 v[36:39], a[36:39], v[64:67], v[36:39]
    s_waitcnt lgkmcnt(1)
    v_exp_f32 v30, v30
    v_mfma_f32_16x16x32_bf16 v[36:39], a[40:43], v[68:71], v[36:39]
    v_exp_f32 v31, v31
    v_mfma_f32_16x16x32_bf16 v[36:39], a[44:47], v[72:75], v[36:39]
    v_exp_f32 v32, v32
    v_mfma_f32_16x16x32_bf16 v[40:43], a[60:63], v[72:75], v[12:15]
    v_exp_f32 v33, v33
    v_mfma_f32_16x16x32_bf16 v[40:43], a[56:59], v[68:71], v[40:43]
    v_exp_f32 v34, v34
    v_mfma_f32_16x16x32_bf16 v[40:43], a[52:55], v[64:67], v[40:43]
    s_waitcnt lgkmcnt(0)
    v_exp_f32 v35, v35
    v_mfma_f32_16x16x32_bf16 v[40:43], a[48:51], v[60:63], v[40:43]
    s_add_u32 m0, s21, 122752
    v_exp_f32 v36, v36
    v_mfma_f32_16x16x32_bf16 a[208:211], a[192:195], v[52:55], 0
    v_exp_f32 v37, v37
    v_mfma_f32_16x16x32_bf16 a[208:211], a[192:195], v[56:59], a[208:211]
    v_exp_f32 v38, v38
    v_mfma_f32_16x16x32_bf16 v[220:223], a[68:71], v[56:59], 0
    ds_read_b64_tr_b16 a[68:69], v4 offset:20480
    v_cvt_pk_bf16_f32 v44, v28, v29
    v_mfma_f32_16x16x32_bf16 v[220:223], a[64:67], v[52:55], v[220:223]
    ds_read_b64_tr_b16 a[70:71], v4 offset:22528
    v_cvt_pk_bf16_f32 v45, v30, v31
    v_mfma_f32_16x16x32_bf16 v[224:227], a[72:75], v[52:55], 0
    ds_read_b64_tr_b16 a[64:65], v4 offset:16384
    v_cvt_pk_bf16_f32 v46, v32, v33
    v_mfma_f32_16x16x32_bf16 v[224:227], a[76:79], v[56:59], v[224:227]
    buffer_load_dwordx4 v0, s[12:15], s26 offen offset:128 nt lds
    v_mfma_f32_16x16x32_bf16 v[228:231], a[84:87], v[56:59], 0
    ds_read_b64_tr_b16 a[66:67], v4 offset:18432
    v_cvt_pk_bf16_f32 v47, v34, v35
    v_mfma_f32_16x16x32_bf16 v[228:231], a[80:83], v[52:55], v[228:231]
    v_exp_f32 v39, v39
    v_mfma_f32_16x16x32_bf16 v[232:235], a[88:91], v[52:55], 0
    ds_read_b64_tr_b16 a[72:73], v5 offset:16384
    v_cvt_pk_bf16_f32 v48, v36, v37
    v_mfma_f32_16x16x32_bf16 v[232:235], a[92:95], v[56:59], v[232:235]
    ds_read_b64_tr_b16 a[74:75], v5 offset:18432
    v_cvt_pk_bf16_f32 v49, v38, v39
    v_mfma_f32_16x16x32_bf16 v[236:239], a[100:103], v[56:59], 0
    v_exp_f32 v40, v40
    v_mfma_f32_16x16x32_bf16 v[236:239], a[96:99], v[52:55], v[236:239]
    v_exp_f32 v41, v41
    v_mfma_f32_16x16x32_bf16 v[240:243], a[104:107], v[52:55], 0
    v_exp_f32 v42, v42
    v_mfma_f32_16x16x32_bf16 v[240:243], a[108:111], v[56:59], v[240:243]
    v_exp_f32 v43, v43
    v_mfma_f32_16x16x32_bf16 v[244:247], a[116:119], v[56:59], 0
    s_add_u32 s50, s24, 4096
    ds_read_b64_tr_b16 a[76:77], v5 offset:20480
    v_cvt_pk_bf16_f32 v50, v40, v41
    v_mfma_f32_16x16x32_bf16 v[244:247], a[112:115], v[52:55], v[244:247]
    ds_read_b64_tr_b16 a[78:79], v5 offset:22528
    v_cvt_pk_bf16_f32 v51, v42, v43
    v_mfma_f32_16x16x32_bf16 v[248:251], a[120:123], v[52:55], 0
    ds_read_b64_tr_b16 a[84:85], v6 offset:20480
    v_mfma_f32_16x16x32_bf16 v[248:251], a[124:127], v[56:59], v[248:251]
    ds_read_b64_tr_b16 a[86:87], v6 offset:22528
    v_mfma_f32_16x16x32_bf16 v[28:31], a[0:3], v[76:79], v[16:19]
    ds_read_b64_tr_b16 a[80:81], v6 offset:16384
    v_mfma_f32_16x16x32_bf16 v[28:31], a[4:7], v[80:83], v[28:31]
    ds_read_b64_tr_b16 a[82:83], v6 offset:18432
    v_mfma_f32_16x16x32_bf16 v[28:31], a[8:11], v[84:87], v[28:31]
    ds_read_b64_tr_b16 a[88:89], v7 offset:16384
    v_mfma_f32_16x16x32_bf16 v[28:31], a[12:15], v[88:91], v[28:31]
    buffer_store_dwordx4 a[144:147], v254, s[16:19], s50 offen sc1
    v_mfma_f32_16x16x32_bf16 v[32:35], a[28:31], v[88:91], v[16:19]
    s_add_u32 m0, s21, 118784
    ds_read_b64_tr_b16 a[90:91], v7 offset:18432
    v_mfma_f32_16x16x32_bf16 v[32:35], a[24:27], v[84:87], v[32:35]
    ds_read_b64_tr_b16 a[92:93], v7 offset:20480
    v_mfma_f32_16x16x32_bf16 v[32:35], a[20:23], v[80:83], v[32:35]
    ds_read_b64_tr_b16 a[94:95], v7 offset:22528
    v_mfma_f32_16x16x32_bf16 v[32:35], a[16:19], v[76:79], v[32:35]
    ds_read_b64_tr_b16 a[100:101], v4 offset:28672
    v_mfma_f32_16x16x32_bf16 v[36:39], a[32:35], v[76:79], v[16:19]
    buffer_load_dwordx4 v0, s[12:15], s27 offen nt lds
    v_mfma_f32_16x16x32_bf16 v[36:39], a[36:39], v[80:83], v[36:39]
    ds_read_b64_tr_b16 a[102:103], v4 offset:30720
    v_mfma_f32_16x16x32_bf16 v[36:39], a[40:43], v[84:87], v[36:39]
    ds_read_b64_tr_b16 a[96:97], v4 offset:24576
    v_mfma_f32_16x16x32_bf16 v[36:39], a[44:47], v[88:91], v[36:39]
    ds_read_b64_tr_b16 a[98:99], v4 offset:26624
    v_mfma_f32_16x16x32_bf16 v[40:43], a[60:63], v[88:91], v[16:19]
    ds_read_b64_tr_b16 a[104:105], v5 offset:24576
    v_mfma_f32_16x16x32_bf16 v[40:43], a[56:59], v[84:87], v[40:43]
    ds_read_b64_tr_b16 a[106:107], v5 offset:26624
    v_mfma_f32_16x16x32_bf16 v[40:43], a[52:55], v[80:83], v[40:43]
    ds_read_b64_tr_b16 a[108:109], v5 offset:28672
    v_mfma_f32_16x16x32_bf16 v[40:43], a[48:51], v[76:79], v[40:43]
    s_add_u32 m0, s21, 126848
    ds_read_b64_tr_b16 a[110:111], v5 offset:30720
    v_mfma_f32_16x16x32_bf16 a[196:199], a[192:195], v[44:47], a[196:199]
    ds_read_b64_tr_b16 a[116:117], v6 offset:28672
    v_mfma_f32_16x16x32_bf16 a[196:199], a[192:195], v[48:51], a[196:199]
    s_waitcnt lgkmcnt(8)
    ds_read_b64_tr_b16 a[118:119], v6 offset:30720
    v_mfma_f32_16x16x32_bf16 v[124:127], a[68:71], v[48:51], v[124:127]
    ds_read_b64_tr_b16 a[112:113], v6 offset:24576
    v_mfma_f32_16x16x32_bf16 v[124:127], a[64:67], v[44:47], v[124:127]
L_pad6:
    s_cbranch_vccnz L_touched1
    ds_read_b64_tr_b16 a[114:115], v6 offset:26624
    v_mfma_f32_16x16x32_bf16 v[128:131], a[72:75], v[44:47], v[128:131]
    ds_read_b64_tr_b16 a[120:121], v7 offset:24576
    v_mfma_f32_16x16x32_bf16 v[128:131], a[76:79], v[48:51], v[128:131]
    ds_read_b64_tr_b16 a[122:123], v7 offset:26624
    v_mfma_f32_16x16x32_bf16 v[132:135], a[84:87], v[48:51], v[132:135]
    ds_read_b64_tr_b16 a[124:125], v7 offset:28672
    buffer_load_dwordx4 v0, s[12:15], s27 offen offset:128 nt lds
    v_mfma_f32_16x16x32_bf16 v[132:135], a[80:83], v[44:47], v[132:135]
    ds_read_b64_tr_b16 a[126:127], v7 offset:30720
    v_mfma_f32_16x16x32_bf16 v[136:139], a[88:91], v[44:47], v[136:139]
    v_exp_f32 v28, v28
    v_mfma_f32_16x16x32_bf16 v[136:139], a[92:95], v[48:51], v[136:139]
    s_waitcnt lgkmcnt(8)
    v_exp_f32 v29, v29
    v_mfma_f32_16x16x32_bf16 v[140:143], a[100:103], v[48:51], v[140:143]
    v_exp_f32 v30, v30
    v_mfma_f32_16x16x32_bf16 v[140:143], a[96:99], v[44:47], v[140:143]
    v_exp_f32 v31, v31
    v_mfma_f32_16x16x32_bf16 v[144:147], a[104:107], v[44:47], v[144:147]
    v_cvt_pk_bf16_f32 v52, v28, v29
    v_cvt_pk_bf16_f32 v53, v30, v31
    v_mfma_f32_16x16x32_bf16 v[144:147], a[108:111], v[48:51], v[144:147]
    s_waitcnt lgkmcnt(4)
    v_exp_f32 v32, v32
    v_mfma_f32_16x16x32_bf16 v[148:151], a[116:119], v[48:51], v[148:151]
    v_exp_f32 v33, v33
    v_mfma_f32_16x16x32_bf16 v[148:151], a[112:115], v[44:47], v[148:151]
    s_waitcnt lgkmcnt(2)
    v_exp_f32 v34, v34
    v_mfma_f32_16x16x32_bf16 v[152:155], a[120:123], v[44:47], v[152:155]
    s_waitcnt lgkmcnt(0)
    v_exp_f32 v35, v35
    v_mfma_f32_16x16x32_bf16 v[152:155], a[124:127], v[48:51], v[152:155]
    s_add_u32 s26, s23, 65536
    v_cvt_pk_bf16_f32 v54, v32, v33
    v_cvt_pk_bf16_f32 v55, v34, v35
    v_mfma_f32_16x16x32_bf16 v[28:31], a[0:3], v[92:95], v[20:23]
    s_waitcnt vmcnt(11)
    s_barrier
    v_mfma_f32_16x16x32_bf16 v[28:31], a[4:7], v[96:99], v[28:31]
    s_add_u32 s27, s23, 73728
    v_exp_f32 v36, v36
    v_mfma_f32_16x16x32_bf16 v[28:31], a[8:11], v[100:103], v[28:31]
    s_add_u32 m0, s21, 0
    v_exp_f32 v37, v37
    v_mfma_f32_16x16x32_bf16 v[28:31], a[12:15], v[104:107], v[28:31]
    v_exp_f32 v38, v38
    v_mfma_f32_16x16x32_bf16 v[32:35], a[28:31], v[104:107], v[20:23]
    v_exp_f32 v39, v39
    v_mfma_f32_16x16x32_bf16 v[32:35], a[24:27], v[100:103], v[32:35]
    v_cvt_pk_bf16_f32 v56, v36, v37
    v_cvt_pk_bf16_f32 v57, v38, v39
    v_mfma_f32_16x16x32_bf16 v[32:35], a[20:23], v[96:99], v[32:35]
    buffer_load_dwordx4 v0, s[8:11], s26 offen nt lds
    v_mfma_f32_16x16x32_bf16 v[32:35], a[16:19], v[92:95], v[32:35]
    v_exp_f32 v40, v40
    v_mfma_f32_16x16x32_bf16 v[36:39], a[32:35], v[92:95], v[20:23]
    v_exp_f32 v41, v41
    v_mfma_f32_16x16x32_bf16 v[36:39], a[36:39], v[96:99], v[36:39]
    v_exp_f32 v42, v42
    v_mfma_f32_16x16x32_bf16 v[36:39], a[40:43], v[100:103], v[36:39]
    v_exp_f32 v43, v43
    v_mfma_f32_16x16x32_bf16 v[36:39], a[44:47], v[104:107], v[36:39]
    v_cvt_pk_bf16_f32 v58, v40, v41
    v_cvt_pk_bf16_f32 v59, v42, v43
    v_mfma_f32_16x16x32_bf16 v[40:43], a[60:63], v[104:107], v[20:23]
    v_exp_f32 v28, v28
    v_mfma_f32_16x16x32_bf16 v[40:43], a[56:59], v[100:103], v[40:43]
    v_exp_f32 v29, v29
    v_mfma_f32_16x16x32_bf16 v[40:43], a[52:55], v[96:99], v[40:43]
    v_exp_f32 v30, v30
    v_mfma_f32_16x16x32_bf16 v[40:43], a[48:51], v[92:95], v[40:43]
    v_exp_f32 v31, v31
    v_mfma_f32_16x16x32_bf16 a[200:203], a[192:195], v[52:55], a[200:203]
    s_add_u32 m0, s21, 8064
    v_cvt_pk_bf16_f32 v44, v28, v29
    v_cvt_pk_bf16_f32 v45, v30, v31
    v_mfma_f32_16x16x32_bf16 a[200:203], a[192:195], v[56:59], a[200:203]
    v_exp_f32 v32, v32
    v_mfma_f32_16x16x32_bf16 v[156:159], a[68:71], v[56:59], v[156:159]
    v_exp_f32 v33, v33
    v_mfma_f32_16x16x32_bf16 v[156:159], a[64:67], v[52:55], v[156:159]
    v_exp_f32 v34, v34
    v_mfma_f32_16x16x32_bf16 v[160:163], a[72:75], v[52:55], v[160:163]
    v_exp_f32 v35, v35
    v_mfma_f32_16x16x32_bf16 v[160:163], a[76:79], v[56:59], v[160:163]
    v_cvt_pk_bf16_f32 v46, v32, v33
    v_cvt_pk_bf16_f32 v47, v34, v35
    v_mfma_f32_16x16x32_bf16 v[164:167], a[84:87], v[56:59], v[164:167]
    v_exp_f32 v36, v36
    v_mfma_f32_16x16x32_bf16 v[164:167], a[80:83], v[52:55], v[164:167]
    buffer_load_dwordx4 v0, s[8:11], s26 offen offset:128 nt lds
    v_mfma_f32_16x16x32_bf16 v[168:171], a[88:91], v[52:55], v[168:171]
    v_exp_f32 v37, v37
    v_mfma_f32_16x16x32_bf16 v[168:171], a[92:95], v[56:59], v[168:171]
    v_exp_f32 v38, v38
    v_mfma_f32_16x16x32_bf16 v[172:175], a[100:103], v[56:59], v[172:175]
    v_exp_f32 v39, v39
    v_mfma_f32_16x16x32_bf16 v[172:175], a[96:99], v[52:55], v[172:175]
    v_cvt_pk_bf16_f32 v48, v36, v37
    v_cvt_pk_bf16_f32 v49, v38, v39
    v_mfma_f32_16x16x32_bf16 v[176:179], a[104:107], v[52:55], v[176:179]
    v_exp_f32 v40, v40
    v_mfma_f32_16x16x32_bf16 v[176:179], a[108:111], v[56:59], v[176:179]
    buffer_store_dwordx4 a[148:151], v254, s[16:19], s50 offen offset:1024 sc1
    v_mfma_f32_16x16x32_bf16 v[180:183], a[116:119], v[56:59], v[180:183]
    v_exp_f32 v41, v41
    v_mfma_f32_16x16x32_bf16 v[180:183], a[112:115], v[52:55], v[180:183]
    v_exp_f32 v42, v42
    v_mfma_f32_16x16x32_bf16 v[184:187], a[120:123], v[52:55], v[184:187]
    v_exp_f32 v43, v43
    v_mfma_f32_16x16x32_bf16 v[184:187], a[124:127], v[56:59], v[184:187]
    s_add_u32 m0, s21, 4096
    v_cvt_pk_bf16_f32 v50, v40, v41
    v_cvt_pk_bf16_f32 v51, v42, v43
    v_mfma_f32_16x16x32_bf16 v[28:31], a[0:3], v[108:111], v[24:27]
    ds_read_b128 a[0:3], v2 offset:32768
    v_mfma_f32_16x16x32_bf16 v[28:31], a[4:7], v[112:115], v[28:31]
    ds_read_b128 a[4:7], v3 offset:32768
    v_mfma_f32_16x16x32_bf16 v[28:31], a[8:11], v[116:119], v[28:31]
    ds_read_b128 a[8:11], v2 offset:40960
    v_mfma_f32_16x16x32_bf16 v[28:31], a[12:15], v[120:123], v[28:31]
    ds_read_b128 a[12:15], v3 offset:40960
    v_mfma_f32_16x16x32_bf16 v[32:35], a[28:31], v[120:123], v[24:27]
    ds_read_b128 a[28:31], v3 offset:43008
    v_mfma_f32_16x16x32_bf16 v[32:35], a[24:27], v[116:119], v[32:35]
    ds_read_b128 a[24:27], v2 offset:43008
    v_mfma_f32_16x16x32_bf16 v[32:35], a[20:23], v[112:115], v[32:35]
    buffer_load_dwordx4 v0, s[8:11], s27 offen nt lds
    v_mfma_f32_16x16x32_bf16 v[32:35], a[16:19], v[108:111], v[32:35]
    v_exp_f32 v28, v28
    v_mfma_f32_16x16x32_bf16 v[36:39], a[32:35], v[108:111], v[24:27]
    v_exp_f32 v29, v29
    v_mfma_f32_16x16x32_bf16 v[36:39], a[36:39], v[112:115], v[36:39]
    v_exp_f32 v30, v30
    v_mfma_f32_16x16x32_bf16 v[36:39], a[40:43], v[116:119], v[36:39]
    v_exp_f32 v31, v31
    v_mfma_f32_16x16x32_bf16 v[36:39], a[44:47], v[120:123], v[36:39]
    ds_read_b128 a[20:23], v3 offset:34816
    v_cvt_pk_bf16_f32 v52, v28, v29
    v_mfma_f32_16x16x32_bf16 v[40:43], a[60:63], v[120:123], v[24:27]
    ds_read_b128 a[16:19], v2 offset:34816
    v_cvt_pk_bf16_f32 v53, v30, v31
    v_mfma_f32_16x16x32_bf16 v[40:43], a[56:59], v[116:119], v[40:43]
    v_exp_f32 v32, v32
    v_mfma_f32_16x16x32_bf16 v[40:43], a[52:55], v[112:115], v[40:43]
    v_exp_f32 v33, v33
    v_mfma_f32_16x16x32_bf16 v[40:43], a[48:51], v[108:111], v[40:43]
    v_exp_f32 v34, v34
    v_mfma_f32_16x16x32_bf16 a[204:207], a[192:195], v[44:47], a[204:207]
    s_add_u32 m0, s21, 12160
    v_exp_f32 v35, v35
    v_mfma_f32_16x16x32_bf16 a[204:207], a[192:195], v[48:51], a[204:207]
    ds_read_b128 a[32:35], v2 offset:36864
    v_cvt_pk_bf16_f32 v54, v32, v33
    v_mfma_f32_16x16x32_bf16 v[188:191], a[68:71], v[48:51], v[188:191]
    ds_read_b128 a[36:39], v3 offset:36864
    v_cvt_pk_bf16_f32 v55, v34, v35
    v_mfma_f32_16x16x32_bf16 v[188:191], a[64:67], v[44:47], v[188:191]
    v_exp_f32 v36, v36
    v_mfma_f32_16x16x32_bf16 v[192:195], a[72:75], v[44:47], v[192:195]
    v_exp_f32 v37, v37
    v_mfma_f32_16x16x32_bf16 v[192:195], a[76:79], v[48:51], v[192:195]
    v_exp_f32 v38, v38
    v_mfma_f32_16x16x32_bf16 v[196:199], a[84:87], v[48:51], v[196:199]
    v_exp_f32 v39, v39
    v_mfma_f32_16x16x32_bf16 v[196:199], a[80:83], v[44:47], v[196:199]
    buffer_load_dwordx4 v0, s[8:11], s27 offen offset:128 nt lds
    v_mfma_f32_16x16x32_bf16 v[200:203], a[88:91], v[44:47], v[200:203]
    ds_read_b128 a[40:43], v2 offset:45056
    v_cvt_pk_bf16_f32 v56, v36, v37
    v_mfma_f32_16x16x32_bf16 v[200:203], a[92:95], v[48:51], v[200:203]
    ds_read_b128 a[44:47], v3 offset:45056
    v_cvt_pk_bf16_f32 v57, v38, v39
    v_mfma_f32_16x16x32_bf16 v[204:207], a[100:103], v[48:51], v[204:207]
    v_exp_f32 v40, v40
    v_mfma_f32_16x16x32_bf16 v[204:207], a[96:99], v[44:47], v[204:207]
    v_exp_f32 v41, v41
    v_mfma_f32_16x16x32_bf16 v[208:211], a[104:107], v[44:47], v[208:211]
    v_exp_f32 v42, v42
    v_mfma_f32_16x16x32_bf16 v[208:211], a[108:111], v[48:51], v[208:211]
    v_exp_f32 v43, v43
    v_mfma_f32_16x16x32_bf16 v[212:215], a[116:119], v[48:51], v[212:215]
    ds_read_b128 a[60:63], v3 offset:47104
    v_cvt_pk_bf16_f32 v58, v40, v41
    v_mfma_f32_16x16x32_bf16 v[212:215], a[112:115], v[44:47], v[212:215]
    ds_read_b128 a[56:59], v2 offset:47104
    v_cvt_pk_bf16_f32 v59, v42, v43
    v_mfma_f32_16x16x32_bf16 v[216:219], a[120:123], v[44:47], v[216:219]
    ds_read_b128 a[52:55], v3 offset:38912
    v_mfma_f32_16x16x32_bf16 v[216:219], a[124:127], v[48:51], v[216:219]
    s_waitcnt lgkmcnt(5)
    ds_read_b128 a[48:51], v2 offset:38912
    v_mfma_f32_16x16x32_bf16 v[28:31], a[0:3], v[60:63], v[12:15]
    s_add_u32 m0, s21, 65536
    v_mfma_f32_16x16x32_bf16 v[28:31], a[4:7], v[64:67], v[28:31]
    v_mfma_f32_16x16x32_bf16 v[28:31], a[8:11], v[68:71], v[28:31]
    v_mfma_f32_16x16x32_bf16 v[28:31], a[12:15], v[72:75], v[28:31]
    v_mfma_f32_16x16x32_bf16 v[32:35], a[28:31], v[72:75], v[12:15]
    v_mfma_f32_16x16x32_bf16 v[32:35], a[24:27], v[68:71], v[32:35]
    v_mfma_f32_16x16x32_bf16 v[32:35], a[20:23], v[64:67], v[32:35]
    buffer_load_dwordx4 v0, s[12:15], s26 offen nt lds
    v_mfma_f32_16x16x32_bf16 v[32:35], a[16:19], v[60:63], v[32:35]
    s_nop 2
    v_exp_f32 v28, v28
    v_mfma_f32_16x16x32_bf16 v[36:39], a[32:35], v[60:63], v[12:15]
    v_exp_f32 v29, v29
    v_mfma_f32_16x16x32_bf16 v[36:39], a[36:39], v[64:67], v[36:39]
    s_waitcnt lgkmcnt(0)
    v_exp_f32 v30, v30
    v_mfma_f32_16x16x32_bf16 v[36:39], a[40:43], v[68:71], v[36:39]
    v_exp_f32 v31, v31
    v_mfma_f32_16x16x32_bf16 v[36:39], a[44:47], v[72:75], v[36:39]
    v_exp_f32 v32, v32
    v_mfma_f32_16x16x32_bf16 v[40:43], a[60:63], v[72:75], v[12:15]
    v_exp_f32 v33, v33
    v_mfma_f32_16x16x32_bf16 v[40:43], a[56:59], v[68:71], v[40:43]
    v_exp_f32 v34, v34
    v_mfma_f32_16x16x32_bf16 v[40:43], a[52:55], v[64:67], v[40:43]
    v_exp_f32 v35, v35
    v_mfma_f32_16x16x32_bf16 v[40:43], a[48:51], v[60:63], v[40:43]
    v_exp_f32 v36, v36
    v_mfma_f32_16x16x32_bf16 a[208:211], a[192:195], v[52:55], a[208:211]
    v_exp_f32 v37, v37
    v_mfma_f32_16x16x32_bf16 a[208:211], a[192:195], v[56:59], a[208:211]
    v_exp_f32 v38, v38
    v_mfma_f32_16x16x32_bf16 v[220:223], a[68:71], v[56:59], v[220:223]
    ds_read_b64_tr_b16 a[68:69], v4 offset:36864
    v_cvt_pk_bf16_f32 v44, v28, v29
    v_mfma_f32_16x16x32_bf16 v[220:223], a[64:67], v[52:55], v[220:223]
    ds_read_b64_tr_b16 a[70:71], v4 offset:38912
    v_cvt_pk_bf16_f32 v45, v30, v31
    v_mfma_f32_16x16x32_bf16 v[224:227], a[72:75], v[52:55], v[224:227]
    ds_read_b64_tr_b16 a[64:65], v4 offset:32768
    v_cvt_pk_bf16_f32 v46, v32, v33
    v_mfma_f32_16x16x32_bf16 v[224:227], a[76:79], v[56:59], v[224:227]
    ds_read_b64_tr_b16 a[66:67], v4 offset:34816
    v_cvt_pk_bf16_f32 v47, v34, v35
    v_mfma_f32_16x16x32_bf16 v[228:231], a[84:87], v[56:59], v[228:231]
    buffer_store_dwordx4 a[152:155], v254, s[16:19], s50 offen offset:2048 sc1
    v_mfma_f32_16x16x32_bf16 v[228:231], a[80:83], v[52:55], v[228:231]
    s_add_u32 m0, s21, 73600
    v_exp_f32 v39, v39
    v_mfma_f32_16x16x32_bf16 v[232:235], a[88:91], v[52:55], v[232:235]
    ds_read_b64_tr_b16 a[72:73], v5 offset:32768
    v_cvt_pk_bf16_f32 v48, v36, v37
    v_mfma_f32_16x16x32_bf16 v[232:235], a[92:95], v[56:59], v[232:235]
    ds_read_b64_tr_b16 a[74:75], v5 offset:34816
    v_cvt_pk_bf16_f32 v49, v38, v39
    v_mfma_f32_16x16x32_bf16 v[236:239], a[100:103], v[56:59], v[236:239]
    v_exp_f32 v40, v40
    v_mfma_f32_16x16x32_bf16 v[236:239], a[96:99], v[52:55], v[236:239]
    buffer_load_dwordx4 v0, s[12:15], s26 offen offset:128 nt lds
    v_mfma_f32_16x16x32_bf16 v[240:243], a[104:107], v[52:55], v[240:243]
    v_exp_f32 v41, v41
    v_mfma_f32_16x16x32_bf16 v[240:243], a[108:111], v[56:59], v[240:243]
    v_exp_f32 v42, v42
    v_mfma_f32_16x16x32_bf16 v[244:247], a[116:119], v[56:59], v[244:247]
    v_exp_f32 v43, v43
    v_mfma_f32_16x16x32_bf16 v[244:247], a[112:115], v[52:55], v[244:247]
    ds_read_b64_tr_b16 a[76:77], v5 offset:36864
    v_cvt_pk_bf16_f32 v50, v40, v41
    v_mfma_f32_16x16x32_bf16 v[248:251], a[120:123], v[52:55], v[248:251]
    ds_read_b64_tr_b16 a[78:79], v5 offset:38912
    v_cvt_pk_bf16_f32 v51, v42, v43
    v_mfma_f32_16x16x32_bf16 v[248:251], a[124:127], v[56:59], v[248:251]
    s_add_u32 m0, s21, 69632
    ds_read_b64_tr_b16 a[84:85], v6 offset:36864
    v_mfma_f32_16x16x32_bf16 v[28:31], a[0:3], v[76:79], v[16:19]
    ds_read_b64_tr_b16 a[86:87], v6 offset:38912
    v_mfma_f32_16x16x32_bf16 v[28:31], a[4:7], v[80:83], v[28:31]
    ds_read_b64_tr_b16 a[80:81], v6 offset:32768
    v_mfma_f32_16x16x32_bf16 v[28:31], a[8:11], v[84:87], v[28:31]
    ds_read_b64_tr_b16 a[82:83], v6 offset:34816
    v_mfma_f32_16x16x32_bf16 v[28:31], a[12:15], v[88:91], v[28:31]
    ds_read_b64_tr_b16 a[88:89], v7 offset:32768
    v_mfma_f32_16x16x32_bf16 v[32:35], a[28:31], v[88:91], v[16:19]
    ds_read_b64_tr_b16 a[90:91], v7 offset:34816
    v_mfma_f32_16x16x32_bf16 v[32:35], a[24:27], v[84:87], v[32:35]
    ds_read_b64_tr_b16 a[92:93], v7 offset:36864
    v_mfma_f32_16x16x32_bf16 v[32:35], a[20:23], v[80:83], v[32:35]
    buffer_load_dwordx4 v0, s[12:15], s27 offen nt lds
    v_mfma_f32_16x16x32_bf16 v[32:35], a[16:19], v[76:79], v[32:35]
    ds_read_b64_tr_b16 a[94:95], v7 offset:38912
    v_mfma_f32_16x16x32_bf16 v[36:39], a[32:35], v[76:79], v[16:19]
    ds_read_b64_tr_b16 a[100:101], v4 offset:45056
    v_mfma_f32_16x16x32_bf16 v[36:39], a[36:39], v[80:83], v[36:39]
    ds_read_b64_tr_b16 a[102:103], v4 offset:47104
    v_mfma_f32_16x16x32_bf16 v[36:39], a[40:43], v[84:87], v[36:39]
    ds_read_b64_tr_b16 a[96:97], v4 offset:40960
    v_mfma_f32_16x16x32_bf16 v[36:39], a[44:47], v[88:91], v[36:39]
    ds_read_b64_tr_b16 a[98:99], v4 offset:43008
    v_mfma_f32_16x16x32_bf16 v[40:43], a[60:63], v[88:91], v[16:19]
    ds_read_b64_tr_b16 a[104:105], v5 offset:40960
    v_mfma_f32_16x16x32_bf16 v[40:43], a[56:59], v[84:87], v[40:43]
    ds_read_b64_tr_b16 a[106:107], v5 offset:43008
    v_mfma_f32_16x16x32_bf16 v[40:43], a[52:55], v[80:83], v[40:43]
    ds_read_b64_tr_b16 a[108:109], v5 offset:45056
    v_mfma_f32_16x16x32_bf16 v[40:43], a[48:51], v[76:79], v[40:43]
    ds_read_b64_tr_b16 a[110:111], v5 offset:47104
    v_mfma_f32_16x16x32_bf16 a[196:199], a[192:195], v[44:47], a[196:199]
    s_add_u32 m0, s21, 77696
    ds_read_b64_tr_b16 a[116:117], v6 offset:45056
    v_mfma_f32_16x16x32_bf16 a[196:199], a[192:195], v[48:51], a[196:199]
    s_waitcnt lgkmcnt(9)
    ds_read_b64_tr_b16 a[118:119], v6 offset:47104
    v_mfma_f32_16x16x32_bf16 v[124:127], a[68:71], v[48:51], v[124:127]
    ds_read_b64_tr_b16 a[112:113], v6 offset:40960
    v_mfma_f32_16x16x32_bf16 v[124:127], a[64:67], v[44:47], v[124:127]
    ds_read_b64_tr_b16 a[114:115], v6 offset:43008
    v_mfma_f32_16x16x32_bf16 v[128:131], a[72:75], v[44:47], v[128:131]
    ds_read_b64_tr_b16 a[120:121], v7 offset:40960
    v_mfma_f32_16x16x32_bf16 v[128:131], a[76:79], v[48:51], v[128:131]
    ds_read_b64_tr_b16 a[122:123], v7 offset:43008
    v_mfma_f32_16x16x32_bf16 v[132:135], a[84:87], v[48:51], v[132:135]
    ds_read_b64_tr_b16 a[124:125], v7 offset:45056
    v_mfma_f32_16x16x32_bf16 v[132:135], a[80:83], v[44:47], v[132:135]
    ds_read_b64_tr_b16 a[126:127], v7 offset:47104
    buffer_load_dwordx4 v0, s[12:15], s27 offen offset:128 nt lds
    v_mfma_f32_16x16x32_bf16 v[136:139], a[88:91], v[44:47], v[136:139]
    v_exp_f32 v28, v28
    v_mfma_f32_16x16x32_bf16 v[136:139], a[92:95], v[48:51], v[136:139]
    s_waitcnt lgkmcnt(8)
    v_exp_f32 v29, v29
    v_mfma_f32_16x16x32_bf16 v[140:143], a[100:103], v[48:51], v[140:143]
    v_exp_f32 v30, v30
    v_mfma_f32_16x16x32_bf16 v[140:143], a[96:99], v[44:47], v[140:143]
    v_exp_f32 v31, v31
    v_mfma_f32_16x16x32_bf16 v[144:147], a[104:107], v[44:47], v[144:147]
    v_cvt_pk_bf16_f32 v52, v28, v29
    v_cvt_pk_bf16_f32 v53, v30, v31
    v_mfma_f32_16x16x32_bf16 v[144:147], a[108:111], v[48:51], v[144:147]
    s_waitcnt lgkmcnt(4)
    v_exp_f32 v32, v32
    v_mfma_f32_16x16x32_bf16 v[148:151], a[116:119], v[48:51], v[148:151]
    v_exp_f32 v33, v33
    v_mfma_f32_16x16x32_bf16 v[148:151], a[112:115], v[44:47], v[148:151]
    s_waitcnt lgkmcnt(2)
    v_exp_f32 v34, v34
    v_mfma_f32_16x16x32_bf16 v[152:155], a[120:123], v[44:47], v[152:155]
    s_waitcnt lgkmcnt(0)
    v_exp_f32 v35, v35
    v_mfma_f32_16x16x32_bf16 v[152:155], a[124:127], v[48:51], v[152:155]
    s_add_u32 s26, s23, 81920
    v_cvt_pk_bf16_f32 v54, v32, v33
    v_cvt_pk_bf16_f32 v55, v34, v35
    v_mfma_f32_16x16x32_bf16 v[28:31], a[0:3], v[92:95], v[20:23]
    s_waitcnt vmcnt(10)
    s_barrier
    v_mfma_f32_16x16x32_bf16 v[28:31], a[4:7], v[96:99], v[28:31]
    s_add_u32 s27, s23, 90112
    v_exp_f32 v36, v36
    v_mfma_f32_16x16x32_bf16 v[28:31], a[8:11], v[100:103], v[28:31]
    s_add_u32 m0, s21, 16384
    v_exp_f32 v37, v37
    v_mfma_f32_16x16x32_bf16 v[28:31], a[12:15], v[104:107], v[28:31]
    v_exp_f32 v38, v38
    v_mfma_f32_16x16x32_bf16 v[32:35], a[28:31], v[104:107], v[20:23]
    v_exp_f32 v39, v39
    v_mfma_f32_16x16x32_bf16 v[32:35], a[24:27], v[100:103], v[32:35]
    v_cvt_pk_bf16_f32 v56, v36, v37
    v_cvt_pk_bf16_f32 v57, v38, v39
    v_mfma_f32_16x16x32_bf16 v[32:35], a[20:23], v[96:99], v[32:35]
    buffer_load_dwordx4 v0, s[8:11], s26 offen nt lds
    v_mfma_f32_16x16x32_bf16 v[32:35], a[16:19], v[92:95], v[32:35]
    v_exp_f32 v40, v40
    v_mfma_f32_16x16x32_bf16 v[36:39], a[32:35], v[92:95], v[20:23]
    v_exp_f32 v41, v41
    v_mfma_f32_16x16x32_bf16 v[36:39], a[36:39], v[96:99], v[36:39]
    v_exp_f32 v42, v42
    v_mfma_f32_16x16x32_bf16 v[36:39], a[40:43], v[100:103], v[36:39]
    v_exp_f32 v43, v43
    v_mfma_f32_16x16x32_bf16 v[36:39], a[44:47], v[104:107], v[36:39]
    v_cvt_pk_bf16_f32 v58, v40, v41
    v_cvt_pk_bf16_f32 v59, v42, v43
    v_mfma_f32_16x16x32_bf16 v[40:43], a[60:63], v[104:107], v[20:23]
    v_exp_f32 v28, v28
    v_mfma_f32_16x16x32_bf16 v[40:43], a[56:59], v[100:103], v[40:43]
    v_exp_f32 v29, v29
    v_mfma_f32_16x16x32_bf16 v[40:43], a[52:55], v[96:99], v[40:43]
    buffer_store_dwordx4 a[156:159], v254, s[16:19], s50 offen offset:3072 sc1
    v_mfma_f32_16x16x32_bf16 v[40:43], a[48:51], v[92:95], v[40:43]
    v_exp_f32 v30, v30
    v_mfma_f32_16x16x32_bf16 a[200:203], a[192:195], v[52:55], a[200:203]
    s_add_u32 m0, s21, 24448
    v_exp_f32 v31, v31
    v_mfma_f32_16x16x32_bf16 a[200:203], a[192:195], v[56:59], a[200:203]
    v_cvt_pk_bf16_f32 v44, v28, v29
    v_cvt_pk_bf16_f32 v45, v30, v31
    v_mfma_f32_16x16x32_bf16 v[156:159], a[68:71], v[56:59], v[156:159]
    v_exp_f32 v32, v32
    v_mfma_f32_16x16x32_bf16 v[156:159], a[64:67], v[52:55], v[156:159]
    v_exp_f32 v33, v33
    v_mfma_f32_16x16x32_bf16 v[160:163], a[72:75], v[52:55], v[160:163]
    v_exp_f32 v34, v34
    v_mfma_f32_16x16x32_bf16 v[160:163], a[76:79], v[56:59], v[160:163]
    v_exp_f32 v35, v35
    v_mfma_f32_16x16x32_bf16 v[164:167], a[84:87], v[56:59], v[164:167]
    v_cvt_pk_bf16_f32 v46, v32, v33
    v_cvt_pk_bf16_f32 v47, v34, v35
    v_mfma_f32_16x16x32_bf16 v[164:167], a[80:83], v[52:55], v[164:167]
    buffer_load_dwordx4 v0, s[8:11], s26 offen offset:128 nt lds
    v_mfma_f32_16x16x32_bf16 v[168:171], a[88:91], v[52:55], v[168:171]
    v_exp_f32 v36, v36
    v_mfma_f32_16x16x32_bf16 v[168:171], a[92:95], v[56:59], v[168:171]
    v_exp_f32 v37, v37
    v_mfma_f32_16x16x32_bf16 v[172:175], a[100:103], v[56:59], v[172:175]
    v_exp_f32 v38, v38
    v_mfma_f32_16x16x32_bf16 v[172:175], a[96:99], v[52:55], v[172:175]
    v_exp_f32 v39, v39
    v_mfma_f32_16x16x32_bf16 v[176:179], a[104:107], v[52:55], v[176:179]
    v_cvt_pk_bf16_f32 v48, v36, v37
    v_cvt_pk_bf16_f32 v49, v38, v39
    v_mfma_f32_16x16x32_bf16 v[176:179], a[108:111], v[56:59], v[176:179]
    v_exp_f32 v40, v40
    v_mfma_f32_16x16x32_bf16 v[180:183], a[116:119], v[56:59], v[180:183]
    v_exp_f32 v41, v41
    v_mfma_f32_16x16x32_bf16 v[180:183], a[112:115], v[52:55], v[180:183]
    v_exp_f32 v42, v42
    v_mfma_f32_16x16x32_bf16 v[184:187], a[120:123], v[52:55], v[184:187]
    v_exp_f32 v43, v43
    v_mfma_f32_16x16x32_bf16 v[184:187], a[124:127], v[56:59], v[184:187]
    s_add_u32 m0, s21, 20480
    v_cvt_pk_bf16_f32 v50, v40, v41
    v_cvt_pk_bf16_f32 v51, v42, v43
    v_mfma_f32_16x16x32_bf16 v[28:31], a[0:3], v[108:111], v[24:27]
    ds_read_b128 a[0:3], v2 offset:49152
    v_mfma_f32_16x16x32_bf16 v[28:31], a[4:7], v[112:115], v[28:31]
    ds_read_b128 a[4:7], v3 offset:49152
    v_mfma_f32_16x16x32_bf16 v[28:31], a[8:11], v[116:119], v[28:31]
    ds_read_b128 a[8:11], v2 offset:57344
    v_mfma_f32_16x16x32_bf16 v[28:31], a[12:15], v[120:123], v[28:31]
    ds_read_b128 a[12:15], v3 offset:57344
    v_mfma_f32_16x16x32_bf16 v[32:35], a[28:31], v[120:123], v[24:27]
    ds_read_b128 a[28:31], v3 offset:59392
    v_mfma_f32_16x16x32_bf16 v[32:35], a[24:27], v[116:119], v[32:35]
    ds_read_b128 a[24:27], v2 offset:59392
    v_mfma_f32_16x16x32_bf16 v[32:35], a[20:23], v[112:115], v[32:35]
    buffer_load_dwordx4 v0, s[8:11], s27 offen nt lds
    v_mfma_f32_16x16x32_bf16 v[32:35], a[16:19], v[108:111], v[32:35]
    v_exp_f32 v28, v28
    v_mfma_f32_16x16x32_bf16 v[36:39], a[32:35], v[108:111], v[24:27]
    v_exp_f32 v29, v29
    v_mfma_f32_16x16x32_bf16 v[36:39], a[36:39], v[112:115], v[36:39]
    v_exp_f32 v30, v30
    v_mfma_f32_16x16x32_bf16 v[36:39], a[40:43], v[116:119], v[36:39]
    v_exp_f32 v31, v31
    v_mfma_f32_16x16x32_bf16 v[36:39], a[44:47], v[120:123], v[36:39]
    ds_read_b128 a[20:23], v3 offset:51200
    v_cvt_pk_bf16_f32 v52, v28, v29
    v_mfma_f32_16x16x32_bf16 v[40:43], a[60:63], v[120:123], v[24:27]
    ds_read_b128 a[16:19], v2 offset:51200
    v_cvt_pk_bf16_f32 v53, v30, v31
    v_mfma_f32_16x16x32_bf16 v[40:43], a[56:59], v[116:119], v[40:43]
    v_exp_f32 v32, v32
    v_mfma_f32_16x16x32_bf16 v[40:43], a[52:55], v[112:115], v[40:43]
    v_exp_f32 v33, v33
    v_mfma_f32_16x16x32_bf16 v[40:43], a[48:51], v[108:111], v[40:43]
    v_exp_f32 v34, v34
    v_mfma_f32_16x16x32_bf16 a[204:207], a[192:195], v[44:47], a[204:207]
    s_add_u32 m0, s21, 28544
    v_exp_f32 v35, v35
    v_mfma_f32_16x16x32_bf16 a[204:207], a[192:195], v[48:51], a[204:207]
    ds_read_b128 a[32:35], v2 offset:53248
    v_cvt_pk_bf16_f32 v54, v32, v33
    v_mfma_f32_16x16x32_bf16 v[188:191], a[68:71], v[48:51], v[188:191]
    ds_read_b128 a[36:39], v3 offset:53248
    v_cvt_pk_bf16_f32 v55, v34, v35
    v_mfma_f32_16x16x32_bf16 v[188:191], a[64:67], v[44:47], v[188:191]
    v_exp_f32 v36, v36
    v_mfma_f32_16x16x32_bf16 v[192:195], a[72:75], v[44:47], v[192:195]
    v_exp_f32 v37, v37
    v_mfma_f32_16x16x32_bf16 v[192:195], a[76:79], v[48:51], v[192:195]
    v_exp_f32 v38, v38
    v_mfma_f32_16x16x32_bf16 v[196:199], a[84:87], v[48:51], v[196:199]
    v_exp_f32 v39, v39
    v_mfma_f32_16x16x32_bf16 v[196:199], a[80:83], v[44:47], v[196:199]
    buffer_load_dwordx4 v0, s[8:11], s27 offen offset:128 nt lds
    v_mfma_f32_16x16x32_bf16 v[200:203], a[88:91], v[44:47], v[200:203]
    ds_read_b128 a[40:43], v2 offset:61440
    v_cvt_pk_bf16_f32 v56, v36, v37
    v_mfma_f32_16x16x32_bf16 v[200:203], a[92:95], v[48:51], v[200:203]
    ds_read_b128 a[44:47], v3 offset:61440
    v_cvt_pk_bf16_f32 v57, v38, v39
    v_mfma_f32_16x16x32_bf16 v[204:207], a[100:103], v[48:51], v[204:207]
    v_exp_f32 v40, v40
    v_mfma_f32_16x16x32_bf16 v[204:207], a[96:99], v[44:47], v[204:207]
    v_exp_f32 v41, v41
    v_mfma_f32_16x16x32_bf16 v[208:211], a[104:107], v[44:47], v[208:211]
    v_exp_f32 v42, v42
    v_mfma_f32_16x16x32_bf16 v[208:211], a[108:111], v[48:51], v[208:211]
    v_exp_f32 v43, v43
    v_mfma_f32_16x16x32_bf16 v[212:215], a[116:119], v[48:51], v[212:215]
    ds_read_b128 a[60:63], v3 offset:63488
    v_cvt_pk_bf16_f32 v58, v40, v41
    v_mfma_f32_16x16x32_bf16 v[212:215], a[112:115], v[44:47], v[212:215]
    ds_read_b128 a[56:59], v2 offset:63488
    v_cvt_pk_bf16_f32 v59, v42, v43
    v_mfma_f32_16x16x32_bf16 v[216:219], a[120:123], v[44:47], v[216:219]
    ds_read_b128 a[52:55], v3 offset:55296
    v_mfma_f32_16x16x32_bf16 v[216:219], a[124:127], v[48:51], v[216:219]
    s_waitcnt lgkmcnt(5)
    ds_read_b128 a[48:51], v2 offset:55296
    v_mfma_f32_16x16x32_bf16 v[28:31], a[0:3], v[60:63], v[12:15]
    s_add_u32 m0, s21, 81920
    v_mfma_f32_16x16x32_bf16 v[28:31], a[4:7], v[64:67], v[28:31]
    v_mfma_f32_16x16x32_bf16 v[28:31], a[8:11], v[68:71], v[28:31]
    v_mfma_f32_16x16x32_bf16 v[28:31], a[12:15], v[72:75], v[28:31]
    v_mfma_f32_16x16x32_bf16 v[32:35], a[28:31], v[72:75], v[12:15]
    v_mfma_f32_16x16x32_bf16 v[32:35], a[24:27], v[68:71], v[32:35]
    v_mfma_f32_16x16x32_bf16 v[32:35], a[20:23], v[64:67], v[32:35]
    buffer_load_dwordx4 v0, s[12:15], s26 offen nt lds
    v_mfma_f32_16x16x32_bf16 v[32:35], a[16:19], v[60:63], v[32:35]
    s_add_u32 s50, s24, 8192
    s_nop 1
    v_exp_f32 v28, v28
    v_mfma_f32_16x16x32_bf16 v[36:39], a[32:35], v[60:63], v[12:15]
    v_exp_f32 v29, v29
    v_mfma_f32_16x16x32_bf16 v[36:39], a[36:39], v[64:67], v[36:39]
    s_waitcnt lgkmcnt(0)
    v_exp_f32 v30, v30
    v_mfma_f32_16x16x32_bf16 v[36:39], a[40:43], v[68:71], v[36:39]
    v_exp_f32 v31, v31
    v_mfma_f32_16x16x32_bf16 v[36:39], a[44:47], v[72:75], v[36:39]
    buffer_store_dwordx4 a[160:163], v254, s[16:19], s50 offen sc1
    v_mfma_f32_16x16x32_bf16 v[40:43], a[60:63], v[72:75], v[12:15]
    v_exp_f32 v32, v32
    v_mfma_f32_16x16x32_bf16 v[40:43], a[56:59], v[68:71], v[40:43]
    v_exp_f32 v33, v33
    v_mfma_f32_16x16x32_bf16 v[40:43], a[52:55], v[64:67], v[40:43]
    v_exp_f32 v34, v34
    v_mfma_f32_16x16x32_bf16 v[40:43], a[48:51], v[60:63], v[40:43]
    v_exp_f32 v35, v35
    v_mfma_f32_16x16x32_bf16 a[208:211], a[192:195], v[52:55], a[208:211]
    s_add_u32 m0, s21, 89984
    v_exp_f32 v36, v36
    v_mfma_f32_16x16x32_bf16 a[208:211], a[192:195], v[56:59], a[208:211]
    v_exp_f32 v37, v37
    v_mfma_f32_16x16x32_bf16 v[220:223], a[68:71], v[56:59], v[220:223]
    ds_read_b64_tr_b16 a[68:69], v4 offset:53248
    v_cvt_pk_bf16_f32 v44, v28, v29
    v_mfma_f32_16x16x32_bf16 v[220:223], a[64:67], v[52:55], v[220:223]
    ds_read_b64_tr_b16 a[70:71], v4 offset:55296
    v_cvt_pk_bf16_f32 v45, v30, v31
    v_mfma_f32_16x16x32_bf16 v[224:227], a[72:75], v[52:55], v[224:227]
    ds_read_b64_tr_b16 a[64:65], v4 offset:49152
    v_cvt_pk_bf16_f32 v46, v32, v33
    v_mfma_f32_16x16x32_bf16 v[224:227], a[76:79], v[56:59], v[224:227]
    ds_read_b64_tr_b16 a[66:67], v4 offset:51200
    v_cvt_pk_bf16_f32 v47, v34, v35
    v_mfma_f32_16x16x32_bf16 v[228:231], a[84:87], v[56:59], v[228:231]
    v_exp_f32 v38, v38
    v_mfma_f32_16x16x32_bf16 v[228:231], a[80:83], v[52:55], v[228:231]
    buffer_load_dwordx4 v0, s[12:15], s26 offen offset:128 nt lds
    v_mfma_f32_16x16x32_bf16 v[232:235], a[88:91], v[52:55], v[232:235]
    v_exp_f32 v39, v39
    v_mfma_f32_16x16x32_bf16 v[232:235], a[92:95], v[56:59], v[232:235]
    ds_read_b64_tr_b16 a[72:73], v5 offset:49152
    v_cvt_pk_bf16_f32 v48, v36, v37
    v_mfma_f32_16x16x32_bf16 v[236:239], a[100:103], v[56:59], v[236:239]
    ds_read_b64_tr_b16 a[74:75], v5 offset:51200
    v_cvt_pk_bf16_f32 v49, v38, v39
    v_mfma_f32_16x16x32_bf16 v[236:239], a[96:99], v[52:55], v[236:239]
    v_exp_f32 v40, v40
    v_mfma_f32_16x16x32_bf16 v[240:243], a[104:107], v[52:55], v[240:243]
    v_exp_f32 v41, v41
    v_mfma_f32_16x16x32_bf16 v[240:243], a[108:111], v[56:59], v[240:243]
    v_exp_f32 v42, v42
    v_mfma_f32_16x16x32_bf16 v[244:247], a[116:119], v[56:59], v[244:247]
    v_exp_f32 v43, v43
    v_mfma_f32_16x16x32_bf16 v[244:247], a[112:115], v[52:55], v[244:247]
    ds_read_b64_tr_b16 a[76:77], v5 offset:53248
    v_cvt_pk_bf16_f32 v50, v40, v41
    v_mfma_f32_16x16x32_bf16 v[248:251], a[120:123], v[52:55], v[248:251]
    ds_read_b64_tr_b16 a[78:79], v5 offset:55296
    v_cvt_pk_bf16_f32 v51, v42, v43
    v_mfma_f32_16x16x32_bf16 v[248:251], a[124:127], v[56:59], v[248:251]
    s_add_u32 m0, s21, 86016
    ds_read_b64_tr_b16 a[84:85], v6 offset:53248
    v_mfma_f32_16x16x32_bf16 v[28:31], a[0:3], v[76:79], v[16:19]
    ds_read_b64_tr_b16 a[86:87], v6 offset:55296
    v_mfma_f32_16x16x32_bf16 v[28:31], a[4:7], v[80:83], v[28:31]
    ds_read_b64_tr_b16 a[80:81], v6 offset:49152
    v_mfma_f32_16x16x32_bf16 v[28:31], a[8:11], v[84:87], v[28:31]
L_pad7:
    s_cbranch_vccnz L_touched1
    ds_read_b64_tr_b16 a[82:83], v6 offset:51200
    v_mfma_f32_16x16x32_bf16 v[28:31], a[12:15], v[88:91], v[28:31]
    ds_read_b64_tr_b16 a[88:89], v7 offset:49152
    v_mfma_f32_16x16x32_bf16 v[32:35], a[28:31], v[88:91], v[16:19]
    ds_read_b64_tr_b16 a[90:91], v7 offset:51200
    v_mfma_f32_16x16x32_bf16 v[32:35], a[24:27], v[84:87], v[32:35]
    ds_read_b64_tr_b16 a[92:93], v7 offset:53248
    v_mfma_f32_16x16x32_bf16 v[32:35], a[20:23], v[80:83], v[32:35]
    buffer_load_dwordx4 v0, s[12:15], s27 offen nt lds
    v_mfma_f32_16x16x32_bf16 v[32:35], a[16:19], v[76:79], v[32:35]
    ds_read_b64_tr_b16 a[94:95], v7 offset:55296
    v_mfma_f32_16x16x32_bf16 v[36:39], a[32:35], v[76:79], v[16:19]
    ds_read_b64_tr_b16 a[100:101], v4 offset:61440
    v_mfma_f32_16x16x32_bf16 v[36:39], a[36:39], v[80:83], v[36:39]
    ds_read_b64_tr_b16 a[102:103], v4 offset:63488
    v_mfma_f32_16x16x32_bf16 v[36:39], a[40:43], v[84:87], v[36:39]
    ds_read_b64_tr_b16 a[96:97], v4 offset:57344
    v_mfma_f32_16x16x32_bf16 v[36:39], a[44:47], v[88:91], v[36:39]
    ds_read_b64_tr_b16 a[98:99], v4 offset:59392
    v_mfma_f32_16x16x32_bf16 v[40:43], a[60:63], v[88:91], v[16:19]
    ds_read_b64_tr_b16 a[104:105], v5 offset:57344
    v_mfma_f32_16x16x32_bf16 v[40:43], a[56:59], v[84:87], v[40:43]
    ds_read_b64_tr_b16 a[106:107], v5 offset:59392
    v_mfma_f32_16x16x32_bf16 v[40:43], a[52:55], v[80:83], v[40:43]
    ds_read_b64_tr_b16 a[108:109], v5 offset:61440
    v_mfma_f32_16x16x32_bf16 v[40:43], a[48:51], v[76:79], v[40:43]
    ds_read_b64_tr_b16 a[110:111], v5 offset:63488
    v_mfma_f32_16x16x32_bf16 a[196:199], a[192:195], v[44:47], a[196:199]
    s_add_u32 m0, s21, 94080
    ds_read_b64_tr_b16 a[116:117], v6 offset:61440
    v_mfma_f32_16x16x32_bf16 a[196:199], a[192:195], v[48:51], a[196:199]
    s_waitcnt lgkmcnt(9)
    ds_read_b64_tr_b16 a[118:119], v6 offset:63488
    v_mfma_f32_16x16x32_bf16 v[124:127], a[68:71], v[48:51], v[124:127]
    ds_read_b64_tr_b16 a[112:113], v6 offset:57344
    v_mfma_f32_16x16x32_bf16 v[124:127], a[64:67], v[44:47], v[124:127]
    ds_read_b64_tr_b16 a[114:115], v6 offset:59392
    v_mfma_f32_16x16x32_bf16 v[128:131], a[72:75], v[44:47], v[128:131]
    ds_read_b64_tr_b16 a[120:121], v7 offset:57344
    v_mfma_f32_16x16x32_bf16 v[128:131], a[76:79], v[48:51], v[128:131]
    ds_read_b64_tr_b16 a[122:123], v7 offset:59392
    v_mfma_f32_16x16x32_bf16 v[132:135], a[84:87], v[48:51], v[132:135]
    ds_read_b64_tr_b16 a[124:125], v7 offset:61440
    v_exp_f32 v28, v28
    v_mfma_f32_16x16x32_bf16 v[132:135], a[80:83], v[44:47], v[132:135]
    ds_read_b64_tr_b16 a[126:127], v7 offset:63488
    buffer_load_dwordx4 v0, s[12:15], s27 offen offset:128 nt lds
    v_mfma_f32_16x16x32_bf16 v[136:139], a[88:91], v[44:47], v[136:139]
    v_exp_f32 v29, v29
    v_mfma_f32_16x16x32_bf16 v[136:139], a[92:95], v[48:51], v[136:139]
    s_waitcnt lgkmcnt(8)
    v_exp_f32 v30, v30
    v_mfma_f32_16x16x32_bf16 v[140:143], a[100:103], v[48:51], v[140:143]
    v_exp_f32 v31, v31
    v_mfma_f32_16x16x32_bf16 v[140:143], a[96:99], v[44:47], v[140:143]
    v_exp_f32 v32, v32
    v_mfma_f32_16x16x32_bf16 v[144:147], a[104:107], v[44:47], v[144:147]
    v_cvt_pk_bf16_f32 v52, v28, v29
    v_cvt_pk_bf16_f32 v53, v30, v31
    v_mfma_f32_16x16x32_bf16 v[144:147], a[108:111], v[48:51], v[144:147]
    s_waitcnt lgkmcnt(4)
    v_exp_f32 v33, v33
    v_mfma_f32_16x16x32_bf16 v[148:151], a[116:119], v[48:51], v[148:151]
    v_exp_f32 v34, v34
    v_mfma_f32_16x16x32_bf16 v[148:151], a[112:115], v[44:47], v[148:151]
    s_waitcnt lgkmcnt(2)
    v_exp_f32 v35, v35
    v_mfma_f32_16x16x32_bf16 v[152:155], a[120:123], v[44:47], v[152:155]
    s_waitcnt lgkmcnt(0)
    buffer_store_dwordx4 a[164:167], v254, s[16:19], s50 offen offset:1024 sc1
    v_mfma_f32_16x16x32_bf16 v[152:155], a[124:127], v[48:51], v[152:155]
    s_add_u32 s26, s23, 98304
    v_cvt_pk_bf16_f32 v54, v32, v33
    v_cvt_pk_bf16_f32 v55, v34, v35
    v_mfma_f32_16x16x32_bf16 v[28:31], a[0:3], v[92:95], v[20:23]
    s_waitcnt vmcnt(11)
    s_barrier
    v_mfma_f32_16x16x32_bf16 v[28:31], a[4:7], v[96:99], v[28:31]
    s_add_u32 s27, s23, 106496
    v_exp_f32 v36, v36
    v_mfma_f32_16x16x32_bf16 v[28:31], a[8:11], v[100:103], v[28:31]
    s_add_u32 m0, s21, 32768
    v_exp_f32 v37, v37
    v_mfma_f32_16x16x32_bf16 v[28:31], a[12:15], v[104:107], v[28:31]
    v_exp_f32 v38, v38
    v_mfma_f32_16x16x32_bf16 v[32:35], a[28:31], v[104:107], v[20:23]
    v_exp_f32 v39, v39
    v_mfma_f32_16x16x32_bf16 v[32:35], a[24:27], v[100:103], v[32:35]
    v_cvt_pk_bf16_f32 v56, v36, v37
    v_cvt_pk_bf16_f32 v57, v38, v39
    v_mfma_f32_16x16x32_bf16 v[32:35], a[20:23], v[96:99], v[32:35]
    buffer_load_dwordx4 v0, s[8:11], s26 offen nt lds
    v_mfma_f32_16x16x32_bf16 v[32:35], a[16:19], v[92:95], v[32:35]
    v_exp_f32 v40, v40
    v_mfma_f32_16x16x32_bf16 v[36:39], a[32:35], v[92:95], v[20:23]
    v_exp_f32 v41, v41
    v_mfma_f32_16x16x32_bf16 v[36:39], a[36:39], v[96:99], v[36:39]
    v_exp_f32 v42, v42
    v_mfma_f32_16x16x32_bf16 v[36:39], a[40:43], v[100:103], v[36:39]
    v_exp_f32 v43, v43
    v_mfma_f32_16x16x32_bf16 v[36:39], a[44:47], v[104:107], v[36:39]
    v_cvt_pk_bf16_f32 v58, v40, v41
    v_cvt_pk_bf16_f32 v59, v42, v43
    v_mfma_f32_16x16x32_bf16 v[40:43], a[60:63], v[104:107], v[20:23]
    v_exp_f32 v28, v28
    v_mfma_f32_16x16x32_bf16 v[40:43], a[56:59], v[100:103], v[40:43]
    v_exp_f32 v29, v29
    v_mfma_f32_16x16x32_bf16 v[40:43], a[52:55], v[96:99], v[40:43]
    v_exp_f32 v30, v30
    v_mfma_f32_16x16x32_bf16 v[40:43], a[48:51], v[92:95], v[40:43]
    v_exp_f32 v31, v31
    v_mfma_f32_16x16x32_bf16 a[200:203], a[192:195], v[52:55], a[200:203]
    s_add_u32 m0, s21, 40832
    v_cvt_pk_bf16_f32 v44, v28, v29
    v_cvt_pk_bf16_f32 v45, v30, v31
    v_mfma_f32_16x16x32_bf16 a[200:203], a[192:195], v[56:59], a[200:203]
    v_exp_f32 v32, v32
    v_mfma_f32_16x16x32_bf16 v[156:159], a[68:71], v[56:59], v[156:159]
    v_exp_f32 v33, v33
    v_mfma_f32_16x16x32_bf16 v[156:159], a[64:67], v[52:55], v[156:159]
    v_exp_f32 v34, v34
    v_mfma_f32_16x16x32_bf16 v[160:163], a[72:75], v[52:55], v[160:163]
    v_exp_f32 v35, v35
    v_mfma_f32_16x16x32_bf16 v[160:163], a[76:79], v[56:59], v[160:163]
    v_cvt_pk_bf16_f32 v46, v32, v33
    v_cvt_pk_bf16_f32 v47, v34, v35
    v_mfma_f32_16x16x32_bf16 v[164:167], a[84:87], v[56:59], v[164:167]
    v_exp_f32 v36, v36
    v_mfma_f32_16x16x32_bf16 v[164:167], a[80:83], v[52:55], v[164:167]
    buffer_load_dwordx4 v0, s[8:11], s26 offen offset:128 nt lds
    v_mfma_f32_16x16x32_bf16 v[168:171], a[88:91], v[52:55], v[168:171]
    v_exp_f32 v37, v37
    v_mfma_f32_16x16x32_bf16 v[168:171], a[92:95], v[56:59], v[168:171]
    v_exp_f32 v38, v38
    v_mfma_f32_16x16x32_bf16 v[172:175], a[100:103], v[56:59], v[172:175]
    v_exp_f32 v39, v39
    v_mfma_f32_16x16x32_bf16 v[172:175], a[96:99], v[52:55], v[172:175]
    v_cvt_pk_bf16_f32 v48, v36, v37
    v_cvt_pk_bf16_f32 v49, v38, v39
    v_mfma_f32_16x16x32_bf16 v[176:179], a[104:107], v[52:55], v[176:179]
    v_exp_f32 v40, v40
    v_mfma_f32_16x16x32_bf16 v[176:179], a[108:111], v[56:59], v[176:179]
    v_exp_f32 v41, v41
    v_mfma_f32_16x16x32_bf16 v[180:183], a[116:119], v[56:59], v[180:183]
    v_exp_f32 v42, v42
    v_mfma_f32_16x16x32_bf16 v[180:183], a[112:115], v[52:55], v[180:183]
    v_exp_f32 v43, v43
    v_mfma_f32_16x16x32_bf16 v[184:187], a[120:123], v[52:55], v[184:187]
    v_cvt_pk_bf16_f32 v50, v40, v41
    v_cvt_pk_bf16_f32 v51, v42, v43
    v_mfma_f32_16x16x32_bf16 v[184:187], a[124:127], v[56:59], v[184:187]
    s_add_u32 m0, s21, 36864
    v_mfma_f32_16x16x32_bf16 v[28:31], a[0:3], v[108:111], v[24:27]
    ds_read_b128 a[0:3], v2 offset:0
    v_mfma_f32_16x16x32_bf16 v[28:31], a[4:7], v[112:115], v[28:31]
    ds_read_b128 a[4:7], v3 offset:0
    v_mfma_f32_16x16x32_bf16 v[28:31], a[8:11], v[116:119], v[28:31]
    ds_read_b128 a[8:11], v2 offset:8192
    v_mfma_f32_16x16x32_bf16 v[28:31], a[12:15], v[120:123], v[28:31]
    ds_read_b128 a[12:15], v3 offset:8192
    v_mfma_f32_16x16x32_bf16 v[32:35], a[28:31], v[120:123], v[24:27]
    ds_read_b128 a[28:31], v3 offset:10240
    v_mfma_f32_16x16x32_bf16 v[32:35], a[24:27], v[116:119], v[32:35]
    ds_read_b128 a[24:27], v2 offset:10240
    v_mfma_f32_16x16x32_bf16 v[32:35], a[20:23], v[112:115], v[32:35]
    buffer_load_dwordx4 v0, s[8:11], s27 offen nt lds
    v_mfma_f32_16x16x32_bf16 v[32:35], a[16:19], v[108:111], v[32:35]
    v_exp_f32 v28, v28
    v_mfma_f32_16x16x32_bf16 v[36:39], a[32:35], v[108:111], v[24:27]
    v_exp_f32 v29, v29
    v_mfma_f32_16x16x32_bf16 v[36:39], a[36:39], v[112:115], v[36:39]
    v_exp_f32 v30, v30
    v_mfma_f32_16x16x32_bf16 v[36:39], a[40:43], v[116:119], v[36:39]
    v_exp_f32 v31, v31
    v_mfma_f32_16x16x32_bf16 v[36:39], a[44:47], v[120:123], v[36:39]
    ds_read_b128 a[20:23], v3 offset:2048
    v_cvt_pk_bf16_f32 v52, v28, v29
    v_mfma_f32_16x16x32_bf16 v[40:43], a[60:63], v[120:123], v[24:27]
    ds_read_b128 a[16:19], v2 offset:2048
    v_cvt_pk_bf16_f32 v53, v30, v31
    v_mfma_f32_16x16x32_bf16 v[40:43], a[56:59], v[116:119], v[40:43]
    v_exp_f32 v32, v32
    v_mfma_f32_16x16x32_bf16 v[40:43], a[52:55], v[112:115], v[40:43]
    v_exp_f32 v33, v33
    v_mfma_f32_16x16x32_bf16 v[40:43], a[48:51], v[108:111], v[40:43]
    v_exp_f32 v34, v34
    v_mfma_f32_16x16x32_bf16 a[204:207], a[192:195], v[44:47], a[204:207]
    s_add_u32 m0, s21, 44928
    v_exp_f32 v35, v35
    v_mfma_f32_16x16x32_bf16 a[204:207], a[192:195], v[48:51], a[204:207]
    ds_read_b128 a[32:35], v2 offset:4096
    v_cvt_pk_bf16_f32 v54, v32, v33
    v_mfma_f32_16x16x32_bf16 v[188:191], a[68:71], v[48:51], v[188:191]
    ds_read_b128 a[36:39], v3 offset:4096
    v_cvt_pk_bf16_f32 v55, v34, v35
    v_mfma_f32_16x16x32_bf16 v[188:191], a[64:67], v[44:47], v[188:191]
    v_exp_f32 v36, v36
    v_mfma_f32_16x16x32_bf16 v[192:195], a[72:75], v[44:47], v[192:195]
    v_exp_f32 v37, v37
    v_mfma_f32_16x16x32_bf16 v[192:195], a[76:79], v[48:51], v[192:195]
    v_exp_f32 v38, v38
    v_mfma_f32_16x16x32_bf16 v[196:199], a[84:87], v[48:51], v[196:199]
    v_exp_f32 v39, v39
    v_mfma_f32_16x16x32_bf16 v[196:199], a[80:83], v[44:47], v[196:199]
    buffer_load_dwordx4 v0, s[8:11], s27 offen offset:128 nt lds
    v_mfma_f32_16x16x32_bf16 v[200:203], a[88:91], v[44:47], v[200:203]
    ds_read_b128 a[40:43], v2 offset:12288
    v_cvt_pk_bf16_f32 v56, v36, v37
    v_mfma_f32_16x16x32_bf16 v[200:203], a[92:95], v[48:51], v[200:203]
    ds_read_b128 a[44:47], v3 offset:12288
    v_cvt_pk_bf16_f32 v57, v38, v39
    v_mfma_f32_16x16x32_bf16 v[204:207], a[100:103], v[48:51], v[204:207]
    v_exp_f32 v40, v40
    v_mfma_f32_16x16x32_bf16 v[204:207], a[96:99], v[44:47], v[204:207]
    v_exp_f32 v41, v41
    v_mfma_f32_16x16x32_bf16 v[208:211], a[104:107], v[44:47], v[208:211]
    buffer_store_dwordx4 a[168:171], v254, s[16:19], s50 offen offset:2048 sc1
    v_mfma_f32_16x16x32_bf16 v[208:211], a[108:111], v[48:51], v[208:211]
    v_exp_f32 v42, v42
    v_mfma_f32_16x16x32_bf16 v[212:215], a[116:119], v[48:51], v[212:215]
    v_exp_f32 v43, v43
    v_mfma_f32_16x16x32_bf16 v[212:215], a[112:115], v[44:47], v[212:215]
    ds_read_b128 a[60:63], v3 offset:14336
    v_cvt_pk_bf16_f32 v58, v40, v41
    v_mfma_f32_16x16x32_bf16 v[216:219], a[120:123], v[44:47], v[216:219]
    ds_read_b128 a[56:59], v2 offset:14336
    v_cvt_pk_bf16_f32 v59, v42, v43
    v_mfma_f32_16x16x32_bf16 v[216:219], a[124:127], v[48:51], v[216:219]
    s_waitcnt lgkmcnt(4)
    ds_read_b128 a[52:55], v3 offset:6144
    v_mfma_f32_16x16x32_bf16 v[28:31], a[0:3], v[60:63], v[12:15]
    s_add_u32 m0, s21, 98304
    ds_read_b128 a[48:51], v2 offset:6144
    v_mfma_f32_16x16x32_bf16 v[28:31], a[4:7], v[64:67], v[28:31]
    v_mfma_f32_16x16x32_bf16 v[28:31], a[8:11], v[68:71], v[28:31]
    v_mfma_f32_16x16x32_bf16 v[28:31], a[12:15], v[72:75], v[28:31]
    v_mfma_f32_16x16x32_bf16 v[32:35], a[28:31], v[72:75], v[12:15]
    v_mfma_f32_16x16x32_bf16 v[32:35], a[24:27], v[68:71], v[32:35]
    v_mfma_f32_16x16x32_bf16 v[32:35], a[20:23], v[64:67], v[32:35]
    buffer_load_dwordx4 v0, s[12:15], s26 offen nt lds
    v_mfma_f32_16x16x32_bf16 v[32:35], a[16:19], v[60:63], v[32:35]
    s_nop 2
    v_exp_f32 v28, v28
    v_mfma_f32_16x16x32_bf16 v[36:39], a[32:35], v[60:63], v[12:15]
    v_exp_f32 v29, v29
    v_mfma_f32_16x16x32_bf16 v[36:39], a[36:39], v[64:67], v[36:39]
    s_waitcnt lgkmcnt(1)
    v_exp_f32 v30, v30
    v_mfma_f32_16x16x32_bf16 v[36:39], a[40:43], v[68:71], v[36:39]
    v_exp_f32 v31, v31
    v_mfma_f32_16x16x32_bf16 v[36:39], a[44:47], v[72:75], v[36:39]
    v_exp_f32 v32, v32
    v_mfma_f32_16x16x32_bf16 v[40:43], a[60:63], v[72:75], v[12:15]
    v_exp_f32 v33, v33
    v_mfma_f32_16x16x32_bf16 v[40:43], a[56:59], v[68:71], v[40:43]
    v_exp_f32 v34, v34
    v_mfma_f32_16x16x32_bf16 v[40:43], a[52:55], v[64:67], v[40:43]
    s_waitcnt lgkmcnt(0)
    v_exp_f32 v35, v35
    v_mfma_f32_16x16x32_bf16 v[40:43], a[48:51], v[60:63], v[40:43]
    v_exp_f32 v36, v36
    v_mfma_f32_16x16x32_bf16 a[208:211], a[192:195], v[52:55], a[208:211]
    s_add_u32 m0, s21, 106368
    v_exp_f32 v37, v37
    v_mfma_f32_16x16x32_bf16 a[208:211], a[192:195], v[56:59], a[208:211]
    v_exp_f32 v38, v38
    v_mfma_f32_16x16x32_bf16 v[220:223], a[68:71], v[56:59], v[220:223]
    ds_read_b64_tr_b16 a[68:69], v4 offset:4096
    v_cvt_pk_bf16_f32 v44, v28, v29
    v_mfma_f32_16x16x32_bf16 v[220:223], a[64:67], v[52:55], v[220:223]
    ds_read_b64_tr_b16 a[70:71], v4 offset:6144
    v_cvt_pk_bf16_f32 v45, v30, v31
    v_mfma_f32_16x16x32_bf16 v[224:227], a[72:75], v[52:55], v[224:227]
    ds_read_b64_tr_b16 a[64:65], v4 offset:0
    v_cvt_pk_bf16_f32 v46, v32, v33
    v_mfma_f32_16x16x32_bf16 v[224:227], a[76:79], v[56:59], v[224:227]
    ds_read_b64_tr_b16 a[66:67], v4 offset:2048
    v_cvt_pk_bf16_f32 v47, v34, v35
    v_mfma_f32_16x16x32_bf16 v[228:231], a[84:87], v[56:59], v[228:231]
    v_exp_f32 v39, v39
    v_mfma_f32_16x16x32_bf16 v[228:231], a[80:83], v[52:55], v[228:231]
    buffer_load_dwordx4 v0, s[12:15], s26 offen offset:128 nt lds
    v_mfma_f32_16x16x32_bf16 v[232:235], a[88:91], v[52:55], v[232:235]
    ds_read_b64_tr_b16 a[72:73], v5 offset:0
    v_cvt_pk_bf16_f32 v48, v36, v37
    v_mfma_f32_16x16x32_bf16 v[232:235], a[92:95], v[56:59], v[232:235]
    ds_read_b64_tr_b16 a[74:75], v5 offset:2048
    v_cvt_pk_bf16_f32 v49, v38, v39
    v_mfma_f32_16x16x32_bf16 v[236:239], a[100:103], v[56:59], v[236:239]
    v_exp_f32 v40, v40
    v_mfma_f32_16x16x32_bf16 v[236:239], a[96:99], v[52:55], v[236:239]
    v_exp_f32 v41, v41
    v_mfma_f32_16x16x32_bf16 v[240:243], a[104:107], v[52:55], v[240:243]
    v_exp_f32 v42, v42
    v_mfma_f32_16x16x32_bf16 v[240:243], a[108:111], v[56:59], v[240:243]
    v_exp_f32 v43, v43
    v_mfma_f32_16x16x32_bf16 v[244:247], a[116:119], v[56:59], v[244:247]
    ds_read_b64_tr_b16 a[76:77], v5 offset:4096
    v_cvt_pk_bf16_f32 v50, v40, v41
    v_mfma_f32_16x16x32_bf16 v[244:247], a[112:115], v[52:55], v[244:247]
    ds_read_b64_tr_b16 a[78:79], v5 offset:6144
    v_cvt_pk_bf16_f32 v51, v42, v43
    v_mfma_f32_16x16x32_bf16 v[248:251], a[120:123], v[52:55], v[248:251]
    ds_read_b64_tr_b16 a[84:85], v6 offset:4096
    v_mfma_f32_16x16x32_bf16 v[248:251], a[124:127], v[56:59], v[248:251]
    s_add_u32 m0, s21, 102400
    ds_read_b64_tr_b16 a[86:87], v6 offset:6144
    v_mfma_f32_16x16x32_bf16 v[28:31], a[0:3], v[76:79], v[16:19]
    ds_read_b64_tr_b16 a[80:81], v6 offset:0
    v_mfma_f32_16x16x32_bf16 v[28:31], a[4:7], v[80:83], v[28:31]
    ds_read_b64_tr_b16 a[82:83], v6 offset:2048
    v_mfma_f32_16x16x32_bf16 v[28:31], a[8:11], v[84:87], v[28:31]
    ds_read_b64_tr_b16 a[88:89], v7 offset:0
    v_mfma_f32_16x16x32_bf16 v[28:31], a[12:15], v[88:91], v[28:31]
    ds_read_b64_tr_b16 a[90:91], v7 offset:2048
    v_mfma_f32_16x16x32_bf16 v[32:35], a[28:31], v[88:91], v[16:19]
    ds_read_b64_tr_b16 a[92:93], v7 offset:4096
    v_mfma_f32_16x16x32_bf16 v[32:35], a[24:27], v[84:87], v[32:35]
    ds_read_b64_tr_b16 a[94:95], v7 offset:6144
    v_mfma_f32_16x16x32_bf16 v[32:35], a[20:23], v[80:83], v[32:35]
    buffer_load_dwordx4 v0, s[12:15], s27 offen nt lds
    v_mfma_f32_16x16x32_bf16 v[32:35], a[16:19], v[76:79], v[32:35]
    ds_read_b64_tr_b16 a[100:101], v4 offset:12288
    v_mfma_f32_16x16x32_bf16 v[36:39], a[32:35], v[76:79], v[16:19]
    ds_read_b64_tr_b16 a[102:103], v4 offset:14336
    v_mfma_f32_16x16x32_bf16 v[36:39], a[36:39], v[80:83], v[36:39]
    ds_read_b64_tr_b16 a[96:97], v4 offset:8192
    v_mfma_f32_16x16x32_bf16 v[36:39], a[40:43], v[84:87], v[36:39]
    ds_read_b64_tr_b16 a[98:99], v4 offset:10240
    v_mfma_f32_16x16x32_bf16 v[36:39], a[44:47], v[88:91], v[36:39]
    ds_read_b64_tr_b16 a[104:105], v5 offset:8192
    v_mfma_f32_16x16x32_bf16 v[40:43], a[60:63], v[88:91], v[16:19]
    ds_read_b64_tr_b16 a[106:107], v5 offset:10240
    v_mfma_f32_16x16x32_bf16 v[40:43], a[56:59], v[84:87], v[40:43]
    ds_read_b64_tr_b16 a[108:109], v5 offset:12288
    v_mfma_f32_16x16x32_bf16 v[40:43], a[52:55], v[80:83], v[40:43]
    ds_read_b64_tr_b16 a[110:111], v5 offset:14336
    v_mfma_f32_16x16x32_bf16 v[40:43], a[48:51], v[76:79], v[40:43]
    ds_read_b64_tr_b16 a[116:117], v6 offset:12288
    v_mfma_f32_16x16x32_bf16 a[196:199], a[192:195], v[44:47], a[196:199]
    ds_read_b64_tr_b16 a[118:119], v6 offset:14336
    v_mfma_f32_16x16x32_bf16 a[196:199], a[192:195], v[48:51], a[196:199]
    s_waitcnt lgkmcnt(9)
    buffer_store_dwordx4 a[172:175], v254, s[16:19], s50 offen offset:3072 sc1
    v_mfma_f32_16x16x32_bf16 v[124:127], a[68:71], v[48:51], v[124:127]
    s_add_u32 m0, s21, 110464
    ds_read_b64_tr_b16 a[112:113], v6 offset:8192
    v_mfma_f32_16x16x32_bf16 v[124:127], a[64:67], v[44:47], v[124:127]
    ds_read_b64_tr_b16 a[114:115], v6 offset:10240
    v_mfma_f32_16x16x32_bf16 v[128:131], a[72:75], v[44:47], v[128:131]
    ds_read_b64_tr_b16 a[120:121], v7 offset:8192
    v_mfma_f32_16x16x32_bf16 v[128:131], a[76:79], v[48:51], v[128:131]
    ds_read_b64_tr_b16 a[122:123], v7 offset:10240
    v_mfma_f32_16x16x32_bf16 v[132:135], a[84:87], v[48:51], v[132:135]
    ds_read_b64_tr_b16 a[124:125], v7 offset:12288
    v_mfma_f32_16x16x32_bf16 v[132:135], a[80:83], v[44:47], v[132:135]
    ds_read_b64_tr_b16 a[126:127], v7 offset:14336
    buffer_load_dwordx4 v0, s[12:15], s27 offen offset:128 nt lds
    v_mfma_f32_16x16x32_bf16 v[136:139], a[88:91], v[44:47], v[136:139]
    v_exp_f32 v28, v28
    v_mfma_f32_16x16x32_bf16 v[136:139], a[92:95], v[48:51], v[136:139]
    s_waitcnt lgkmcnt(7)
    v_exp_f32 v29, v29
    v_mfma_f32_16x16x32_bf16 v[140:143], a[100:103], v[48:51], v[140:143]
    v_exp_f32 v30, v30
    v_mfma_f32_16x16x32_bf16 v[140:143], a[96:99], v[44:47], v[140:143]
    v_exp_f32 v31, v31
    v_mfma_f32_16x16x32_bf16 v[144:147], a[104:107], v[44:47], v[144:147]
    v_cvt_pk_bf16_f32 v52, v28, v29
    v_cvt_pk_bf16_f32 v53, v30, v31
    v_mfma_f32_16x16x32_bf16 v[144:147], a[108:111], v[48:51], v[144:147]
    s_waitcnt lgkmcnt(4)
    v_exp_f32 v32, v32
    v_mfma_f32_16x16x32_bf16 v[148:151], a[116:119], v[48:51], v[148:151]
    v_exp_f32 v33, v33
    v_mfma_f32_16x16x32_bf16 v[148:151], a[112:115], v[44:47], v[148:151]
    s_waitcnt lgkmcnt(2)
    v_exp_f32 v34, v34
    v_mfma_f32_16x16x32_bf16 v[152:155], a[120:123], v[44:47], v[152:155]
    s_waitcnt lgkmcnt(0)
    v_exp_f32 v35, v35
    v_mfma_f32_16x16x32_bf16 v[152:155], a[124:127], v[48:51], v[152:155]
    s_add_u32 s26, s23, 114688
    v_cvt_pk_bf16_f32 v54, v32, v33
    v_cvt_pk_bf16_f32 v55, v34, v35
    v_mfma_f32_16x16x32_bf16 v[28:31], a[0:3], v[92:95], v[20:23]
    s_waitcnt vmcnt(11)
    s_barrier
    v_mfma_f32_16x16x32_bf16 v[28:31], a[4:7], v[96:99], v[28:31]
    s_add_u32 s27, s23, 122880
    v_exp_f32 v36, v36
    v_mfma_f32_16x16x32_bf16 v[28:31], a[8:11], v[100:103], v[28:31]
    s_add_u32 m0, s21, 49152
    v_exp_f32 v37, v37
    v_mfma_f32_16x16x32_bf16 v[28:31], a[12:15], v[104:107], v[28:31]
    v_exp_f32 v38, v38
    v_mfma_f32_16x16x32_bf16 v[32:35], a[28:31], v[104:107], v[20:23]
    v_exp_f32 v39, v39
    v_mfma_f32_16x16x32_bf16 v[32:35], a[24:27], v[100:103], v[32:35]
    v_cvt_pk_bf16_f32 v56, v36, v37
    v_cvt_pk_bf16_f32 v57, v38, v39
    v_mfma_f32_16x16x32_bf16 v[32:35], a[20:23], v[96:99], v[32:35]
    buffer_load_dwordx4 v0, s[8:11], s26 offen nt lds
    v_mfma_f32_16x16x32_bf16 v[32:35], a[16:19], v[92:95], v[32:35]
    v_exp_f32 v40, v40
    v_mfma_f32_16x16x32_bf16 v[36:39], a[32:35], v[92:95], v[20:23]
    v_exp_f32 v41, v41
    v_mfma_f32_16x16x32_bf16 v[36:39], a[36:39], v[96:99], v[36:39]
    v_exp_f32 v42, v42
    v_mfma_f32_16x16x32_bf16 v[36:39], a[40:43], v[100:103], v[36:39]
    v_exp_f32 v43, v43
    v_mfma_f32_16x16x32_bf16 v[36:39], a[44:47], v[104:107], v[36:39]
    s_add_u32 m0, s21, 57216
    v_cvt_pk_bf16_f32 v58, v40, v41
    v_cvt_pk_bf16_f32 v59, v42, v43
    v_mfma_f32_16x16x32_bf16 v[40:43], a[60:63], v[104:107], v[20:23]
    v_exp_f32 v28, v28
    v_mfma_f32_16x16x32_bf16 v[40:43], a[56:59], v[100:103], v[40:43]
    v_exp_f32 v29, v29
    v_mfma_f32_16x16x32_bf16 v[40:43], a[52:55], v[96:99], v[40:43]
    v_exp_f32 v30, v30
    v_mfma_f32_16x16x32_bf16 v[40:43], a[48:51], v[92:95], v[40:43]
    v_exp_f32 v31, v31
    v_mfma_f32_16x16x32_bf16 a[200:203], a[192:195], v[52:55], a[200:203]
    v_cvt_pk_bf16_f32 v44, v28, v29
    v_cvt_pk_bf16_f32 v45, v30, v31
    v_mfma_f32_16x16x32_bf16 a[200:203], a[192:195], v[56:59], a[200:203]
    v_exp_f32 v32, v32
    v_mfma_f32_16x16x32_bf16 v[156:159], a[68:71], v[56:59], v[156:159]
    buffer_load_dwordx4 v0, s[8:11], s26 offen offset:128 nt lds
    v_mfma_f32_16x16x32_bf16 v[156:159], a[64:67], v[52:55], v[156:159]
    v_exp_f32 v33, v33
    v_mfma_f32_16x16x32_bf16 v[160:163], a[72:75], v[52:55], v[160:163]
    v_exp_f32 v34, v34
    v_mfma_f32_16x16x32_bf16 v[160:163], a[76:79], v[56:59], v[160:163]
    v_exp_f32 v35, v35
    v_mfma_f32_16x16x32_bf16 v[164:167], a[84:87], v[56:59], v[164:167]
    v_cvt_pk_bf16_f32 v46, v32, v33
    v_cvt_pk_bf16_f32 v47, v34, v35
    v_mfma_f32_16x16x32_bf16 v[164:167], a[80:83], v[52:55], v[164:167]
    s_add_u32 m0, s21, 53248
    v_exp_f32 v36, v36
    v_mfma_f32_16x16x32_bf16 v[168:171], a[88:91], v[52:55], v[168:171]
    v_exp_f32 v37, v37
    v_mfma_f32_16x16x32_bf16 v[168:171], a[92:95], v[56:59], v[168:171]
    v_exp_f32 v38, v38
    v_mfma_f32_16x16x32_bf16 v[172:175], a[100:103], v[56:59], v[172:175]
    v_exp_f32 v39, v39
    v_mfma_f32_16x16x32_bf16 v[172:175], a[96:99], v[52:55], v[172:175]
    v_cvt_pk_bf16_f32 v48, v36, v37
    v_cvt_pk_bf16_f32 v49, v38, v39
    v_mfma_f32_16x16x32_bf16 v[176:179], a[104:107], v[52:55], v[176:179]
    v_exp_f32 v40, v40
    v_mfma_f32_16x16x32_bf16 v[176:179], a[108:111], v[56:59], v[176:179]
    v_exp_f32 v41, v41
    v_mfma_f32_16x16x32_bf16 v[180:183], a[116:119], v[56:59], v[180:183]
    buffer_load_dwordx4 v0, s[8:11], s27 offen nt lds
    v_mfma_f32_16x16x32_bf16 v[180:183], a[112:115], v[52:55], v[180:183]
    v_exp_f32 v42, v42
    v_mfma_f32_16x16x32_bf16 v[184:187], a[120:123], v[52:55], v[184:187]
    v_exp_f32 v43, v43
    v_mfma_f32_16x16x32_bf16 v[184:187], a[124:127], v[56:59], v[184:187]
    v_cvt_pk_bf16_f32 v50, v40, v41
    v_cvt_pk_bf16_f32 v51, v42, v43
    v_mfma_f32_16x16x32_bf16 v[28:31], a[0:3], v[108:111], v[24:27]
    ds_read_b128 a[0:3], v2 offset:16384
    v_mfma_f32_16x16x32_bf16 v[28:31], a[4:7], v[112:115], v[28:31]
    ds_read_b128 a[4:7], v3 offset:16384
    v_mfma_f32_16x16x32_bf16 v[28:31], a[8:11], v[116:119], v[28:31]
    s_add_u32 m0, s21, 61312
    ds_read_b128 a[8:11], v2 offset:24576
    v_mfma_f32_16x16x32_bf16 v[28:31], a[12:15], v[120:123], v[28:31]
    ds_read_b128 a[12:15], v3 offset:24576
    v_mfma_f32_16x16x32_bf16 v[32:35], a[28:31], v[120:123], v[24:27]
    ds_read_b128 a[28:31], v3 offset:26624
    v_mfma_f32_16x16x32_bf16 v[32:35], a[24:27], v[116:119], v[32:35]
    ds_read_b128 a[24:27], v2 offset:26624
    v_mfma_f32_16x16x32_bf16 v[32:35], a[20:23], v[112:115], v[32:35]
    ds_read_b128 a[20:23], v3 offset:18432
    v_mfma_f32_16x16x32_bf16 v[32:35], a[16:19], v[108:111], v[32:35]
    v_exp_f32 v28, v28
    v_mfma_f32_16x16x32_bf16 v[36:39], a[32:35], v[108:111], v[24:27]
    v_exp_f32 v29, v29
    v_mfma_f32_16x16x32_bf16 v[36:39], a[36:39], v[112:115], v[36:39]
    buffer_load_dwordx4 v0, s[8:11], s27 offen offset:128 nt lds
    v_mfma_f32_16x16x32_bf16 v[36:39], a[40:43], v[116:119], v[36:39]
    s_add_u32 s50, s24, 12288
    v_exp_f32 v30, v30
    v_mfma_f32_16x16x32_bf16 v[36:39], a[44:47], v[120:123], v[36:39]
    v_exp_f32 v31, v31
    v_mfma_f32_16x16x32_bf16 v[40:43], a[60:63], v[120:123], v[24:27]
    ds_read_b128 a[16:19], v2 offset:18432
    v_cvt_pk_bf16_f32 v52, v28, v29
    v_mfma_f32_16x16x32_bf16 v[40:43], a[56:59], v[116:119], v[40:43]
    ds_read_b128 a[32:35], v2 offset:20480
    v_cvt_pk_bf16_f32 v53, v30, v31
    v_mfma_f32_16x16x32_bf16 v[40:43], a[52:55], v[112:115], v[40:43]
    buffer_store_dwordx4 a[176:179], v254, s[16:19], s50 offen sc1
    v_mfma_f32_16x16x32_bf16 v[40:43], a[48:51], v[108:111], v[40:43]
    s_add_u32 m0, s21, 114688
    v_exp_f32 v32, v32
    v_mfma_f32_16x16x32_bf16 a[204:207], a[192:195], v[44:47], a[204:207]
    v_exp_f32 v33, v33
    v_mfma_f32_16x16x32_bf16 a[204:207], a[192:195], v[48:51], a[204:207]
    v_exp_f32 v34, v34
    v_mfma_f32_16x16x32_bf16 v[188:191], a[68:71], v[48:51], v[188:191]
    v_exp_f32 v35, v35
    v_mfma_f32_16x16x32_bf16 v[188:191], a[64:67], v[44:47], v[188:191]
    ds_read_b128 a[36:39], v3 offset:20480
    v_cvt_pk_bf16_f32 v54, v32, v33
    v_mfma_f32_16x16x32_bf16 v[192:195], a[72:75], v[44:47], v[192:195]
    ds_read_b128 a[40:43], v2 offset:28672
    v_cvt_pk_bf16_f32 v55, v34, v35
    v_mfma_f32_16x16x32_bf16 v[192:195], a[76:79], v[48:51], v[192:195]
    buffer_load_dwordx4 v0, s[12:15], s26 offen nt lds
    v_mfma_f32_16x16x32_bf16 v[196:199], a[84:87], v[48:51], v[196:199]
    v_exp_f32 v36, v36
    v_mfma_f32_16x16x32_bf16 v[196:199], a[80:83], v[44:47], v[196:199]
    v_exp_f32 v37, v37
    v_mfma_f32_16x16x32_bf16 v[200:203], a[88:91], v[44:47], v[200:203]
    v_exp_f32 v38, v38
    v_mfma_f32_16x16x32_bf16 v[200:203], a[92:95], v[48:51], v[200:203]
    v_exp_f32 v39, v39
    v_mfma_f32_16x16x32_bf16 v[204:207], a[100:103], v[48:51], v[204:207]
    s_add_u32 m0, s21, 122752
    ds_read_b128 a[44:47], v3 offset:28672
    v_cvt_pk_bf16_f32 v56, v36, v37
    v_mfma_f32_16x16x32_bf16 v[204:207], a[96:99], v[44:47], v[204:207]
    ds_read_b128 a[60:63], v3 offset:30720
    v_cvt_pk_bf16_f32 v57, v38, v39
    v_mfma_f32_16x16x32_bf16 v[208:211], a[104:107], v[44:47], v[208:211]
    v_exp_f32 v40, v40
    v_mfma_f32_16x16x32_bf16 v[208:211], a[108:111], v[48:51], v[208:211]
    v_exp_f32 v41, v41
    v_mfma_f32_16x16x32_bf16 v[212:215], a[116:119], v[48:51], v[212:215]
    v_exp_f32 v42, v42
    v_mfma_f32_16x16x32_bf16 v[212:215], a[112:115], v[44:47], v[212:215]
    v_exp_f32 v43, v43
    v_mfma_f32_16x16x32_bf16 v[216:219], a[120:123], v[44:47], v[216:219]
    ds_read_b128 a[56:59], v2 offset:30720
    v_cvt_pk_bf16_f32 v58, v40, v41
    v_mfma_f32_16x16x32_bf16 v[216:219], a[124:127], v[48:51], v[216:219]
    s_waitcnt lgkmcnt(3)
    buffer_load_dwordx4 v0, s[12:15], s26 offen offset:128 nt lds
    v_mfma_f32_16x16x32_bf16 v[28:31], a[0:3], v[60:63], v[12:15]
    ds_read_b128 a[52:55], v3 offset:22528
    v_cvt_pk_bf16_f32 v59, v42, v43
    v_mfma_f32_16x16x32_bf16 v[28:31], a[4:7], v[64:67], v[28:31]
    ds_read_b128 a[48:51], v2 offset:22528
    v_mfma_f32_16x16x32_bf16 v[28:31], a[8:11], v[68:71], v[28:31]
    v_mfma_f32_16x16x32_bf16 v[28:31], a[12:15], v[72:75], v[28:31]
    v_mfma_f32_16x16x32_bf16 v[32:35], a[28:31], v[72:75], v[12:15]
    v_mfma_f32_16x16x32_bf16 v[32:35], a[24:27], v[68:71], v[32:35]
    s_add_u32 m0, s21, 118784
    v_mfma_f32_16x16x32_bf16 v[32:35], a[20:23], v[64:67], v[32:35]
    v_mfma_f32_16x16x32_bf16 v[32:35], a[16:19], v[60:63], v[32:35]
    s_nop 2
    v_exp_f32 v28, v28
    v_mfma_f32_16x16x32_bf16 v[36:39], a[32:35], v[60:63], v[12:15]
    v_exp_f32 v29, v29
    v_mfma_f32_16x16x32_bf16 v[36:39], a[36:39], v[64:67], v[36:39]
    v_exp_f32 v30, v30
    v_mfma_f32_16x16x32_bf16 v[36:39], a[40:43], v[68:71], v[36:39]
    s_waitcnt lgkmcnt(1)
    v_exp_f32 v31, v31
    v_mfma_f32_16x16x32_bf16 v[36:39], a[44:47], v[72:75], v[36:39]
    v_exp_f32 v32, v32
    v_mfma_f32_16x16x32_bf16 v[40:43], a[60:63], v[72:75], v[12:15]
    buffer_load_dwordx4 v0, s[12:15], s27 offen nt lds
    v_mfma_f32_16x16x32_bf16 v[40:43], a[56:59], v[68:71], v[40:43]
    v_exp_f32 v33, v33
    v_mfma_f32_16x16x32_bf16 v[40:43], a[52:55], v[64:67], v[40:43]
    s_waitcnt lgkmcnt(0)
    v_exp_f32 v34, v34
    v_mfma_f32_16x16x32_bf16 v[40:43], a[48:51], v[60:63], v[40:43]
    v_exp_f32 v35, v35
    v_mfma_f32_16x16x32_bf16 a[208:211], a[192:195], v[52:55], a[208:211]
    v_exp_f32 v36, v36
    v_mfma_f32_16x16x32_bf16 a[208:211], a[192:195], v[56:59], a[208:211]
    s_add_u32 m0, s21, 126848
    v_exp_f32 v37, v37
    v_mfma_f32_16x16x32_bf16 v[220:223], a[68:71], v[56:59], v[220:223]
    ds_read_b64_tr_b16 a[68:69], v4 offset:20480
    v_cvt_pk_bf16_f32 v44, v28, v29
    v_mfma_f32_16x16x32_bf16 v[220:223], a[64:67], v[52:55], v[220:223]
L_pad8:
    s_cbranch_vccnz L_touched2
    ds_read_b64_tr_b16 a[70:71], v4 offset:22528
    v_cvt_pk_bf16_f32 v45, v30, v31
    v_mfma_f32_16x16x32_bf16 v[224:227], a[72:75], v[52:55], v[224:227]
    ds_read_b64_tr_b16 a[64:65], v4 offset:16384
    v_cvt_pk_bf16_f32 v46, v32, v33
    v_mfma_f32_16x16x32_bf16 v[224:227], a[76:79], v[56:59], v[224:227]
    ds_read_b64_tr_b16 a[66:67], v4 offset:18432
    v_cvt_pk_bf16_f32 v47, v34, v35
    v_mfma_f32_16x16x32_bf16 v[228:231], a[84:87], v[56:59], v[228:231]
    v_exp_f32 v38, v38
    v_mfma_f32_16x16x32_bf16 v[228:231], a[80:83], v[52:55], v[228:231]
    v_exp_f32 v39, v39
    v_mfma_f32_16x16x32_bf16 v[232:235], a[88:91], v[52:55], v[232:235]
    buffer_load_dwordx4 v0, s[12:15], s27 offen offset:128 nt lds
    v_mfma_f32_16x16x32_bf16 v[232:235], a[92:95], v[56:59], v[232:235]
    ds_read_b64_tr_b16 a[72:73], v5 offset:16384
    v_cvt_pk_bf16_f32 v48, v36, v37
    v_mfma_f32_16x16x32_bf16 v[236:239], a[100:103], v[56:59], v[236:239]
    ds_read_b64_tr_b16 a[74:75], v5 offset:18432
    v_cvt_pk_bf16_f32 v49, v38, v39
    v_mfma_f32_16x16x32_bf16 v[236:239], a[96:99], v[52:55], v[236:239]
    v_exp_f32 v40, v40
    v_mfma_f32_16x16x32_bf16 v[240:243], a[104:107], v[52:55], v[240:243]
    v_exp_f32 v41, v41
    v_mfma_f32_16x16x32_bf16 v[240:243], a[108:111], v[56:59], v[240:243]
    v_exp_f32 v42, v42
    v_mfma_f32_16x16x32_bf16 v[244:247], a[116:119], v[56:59], v[244:247]
    v_exp_f32 v43, v43
    v_mfma_f32_16x16x32_bf16 v[244:247], a[112:115], v[52:55], v[244:247]
    ds_read_b64_tr_b16 a[76:77], v5 offset:20480
    v_cvt_pk_bf16_f32 v50, v40, v41
    v_mfma_f32_16x16x32_bf16 v[248:251], a[120:123], v[52:55], v[248:251]
    ds_read_b64_tr_b16 a[78:79], v5 offset:22528
    v_cvt_pk_bf16_f32 v51, v42, v43
    v_mfma_f32_16x16x32_bf16 v[248:251], a[124:127], v[56:59], v[248:251]
    ds_read_b64_tr_b16 a[84:85], v6 offset:20480
    v_mfma_f32_16x16x32_bf16 v[28:31], a[0:3], v[76:79], v[16:19]
    ds_read_b64_tr_b16 a[86:87], v6 offset:22528
    v_mfma_f32_16x16x32_bf16 v[28:31], a[4:7], v[80:83], v[28:31]
    ds_read_b64_tr_b16 a[80:81], v6 offset:16384
    v_mfma_f32_16x16x32_bf16 v[28:31], a[8:11], v[84:87], v[28:31]
    buffer_store_dwordx4 a[180:183], v254, s[16:19], s50 offen offset:1024 sc1
    v_mfma_f32_16x16x32_bf16 v[28:31], a[12:15], v[88:91], v[28:31]
    ds_read_b64_tr_b16 a[82:83], v6 offset:18432
    v_mfma_f32_16x16x32_bf16 v[32:35], a[28:31], v[88:91], v[16:19]
    ds_read_b64_tr_b16 a[88:89], v7 offset:16384
    v_mfma_f32_16x16x32_bf16 v[32:35], a[24:27], v[84:87], v[32:35]
    ds_read_b64_tr_b16 a[90:91], v7 offset:18432
    v_mfma_f32_16x16x32_bf16 v[32:35], a[20:23], v[80:83], v[32:35]
    ds_read_b64_tr_b16 a[92:93], v7 offset:20480
    v_mfma_f32_16x16x32_bf16 v[32:35], a[16:19], v[76:79], v[32:35]
    ds_read_b64_tr_b16 a[94:95], v7 offset:22528
    v_mfma_f32_16x16x32_bf16 v[36:39], a[32:35], v[76:79], v[16:19]
    ds_read_b64_tr_b16 a[100:101], v4 offset:28672
    v_mfma_f32_16x16x32_bf16 v[36:39], a[36:39], v[80:83], v[36:39]
    ds_read_b64_tr_b16 a[102:103], v4 offset:30720
    v_mfma_f32_16x16x32_bf16 v[36:39], a[40:43], v[84:87], v[36:39]
    ds_read_b64_tr_b16 a[96:97], v4 offset:24576
    v_mfma_f32_16x16x32_bf16 v[36:39], a[44:47], v[88:91], v[36:39]
    ds_read_b64_tr_b16 a[98:99], v4 offset:26624
    v_mfma_f32_16x16x32_bf16 v[40:43], a[60:63], v[88:91], v[16:19]
    ds_read_b64_tr_b16 a[104:105], v5 offset:24576
    v_mfma_f32_16x16x32_bf16 v[40:43], a[56:59], v[84:87], v[40:43]
    ds_read_b64_tr_b16 a[106:107], v5 offset:26624
    v_mfma_f32_16x16x32_bf16 v[40:43], a[52:55], v[80:83], v[40:43]
    ds_read_b64_tr_b16 a[108:109], v5 offset:28672
    v_mfma_f32_16x16x32_bf16 v[40:43], a[48:51], v[76:79], v[40:43]
    ds_read_b64_tr_b16 a[110:111], v5 offset:30720
    v_mfma_f32_16x16x32_bf16 a[196:199], a[192:195], v[44:47], a[196:199]
    ds_read_b64_tr_b16 a[116:117], v6 offset:28672
    v_mfma_f32_16x16x32_bf16 a[196:199], a[192:195], v[48:51], a[196:199]
    s_waitcnt lgkmcnt(9)
    ds_read_b64_tr_b16 a[118:119], v6 offset:30720
    v_mfma_f32_16x16x32_bf16 v[124:127], a[68:71], v[48:51], v[124:127]
    ds_read_b64_tr_b16 a[112:113], v6 offset:24576
    v_mfma_f32_16x16x32_bf16 v[124:127], a[64:67], v[44:47], v[124:127]
    ds_read_b64_tr_b16 a[114:115], v6 offset:26624
    v_mfma_f32_16x16x32_bf16 v[128:131], a[72:75], v[44:47], v[128:131]
    ds_read_b64_tr_b16 a[120:121], v7 offset:24576
    v_mfma_f32_16x16x32_bf16 v[128:131], a[76:79], v[48:51], v[128:131]
    ds_read_b64_tr_b16 a[122:123], v7 offset:26624
    v_mfma_f32_16x16x32_bf16 v[132:135], a[84:87], v[48:51], v[132:135]
    ds_read_b64_tr_b16 a[124:125], v7 offset:28672
    v_mfma_f32_16x16x32_bf16 v[132:135], a[80:83], v[44:47], v[132:135]
    ds_read_b64_tr_b16 a[126:127], v7 offset:30720
    v_mfma_f32_16x16x32_bf16 v[136:139], a[88:91], v[44:47], v[136:139]
    v_exp_f32 v28, v28
    v_mfma_f32_16x16x32_bf16 v[136:139], a[92:95], v[48:51], v[136:139]
    s_waitcnt lgkmcnt(8)
    v_exp_f32 v29, v29
    v_mfma_f32_16x16x32_bf16 v[140:143], a[100:103], v[48:51], v[140:143]
    v_exp_f32 v30, v30
    v_mfma_f32_16x16x32_bf16 v[140:143], a[96:99], v[44:47], v[140:143]
    v_exp_f32 v31, v31
    v_mfma_f32_16x16x32_bf16 v[144:147], a[104:107], v[44:47], v[144:147]
    v_cvt_pk_bf16_f32 v52, v28, v29
    v_cvt_pk_bf16_f32 v53, v30, v31
    v_mfma_f32_16x16x32_bf16 v[144:147], a[108:111], v[48:51], v[144:147]
    s_waitcnt lgkmcnt(4)
    v_exp_f32 v32, v32
    v_mfma_f32_16x16x32_bf16 v[148:151], a[116:119], v[48:51], v[148:151]
    v_exp_f32 v33, v33
    v_mfma_f32_16x16x32_bf16 v[148:151], a[112:115], v[44:47], v[148:151]
    s_waitcnt lgkmcnt(2)
    v_exp_f32 v34, v34
    v_mfma_f32_16x16x32_bf16 v[152:155], a[120:123], v[44:47], v[152:155]
    s_waitcnt lgkmcnt(0)
    v_exp_f32 v35, v35
    v_mfma_f32_16x16x32_bf16 v[152:155], a[124:127], v[48:51], v[152:155]
    v_cvt_pk_bf16_f32 v54, v32, v33
    v_cvt_pk_bf16_f32 v55, v34, v35
    v_mfma_f32_16x16x32_bf16 v[28:31], a[0:3], v[92:95], v[20:23]
    s_waitcnt vmcnt(10)
    s_barrier
    v_mfma_f32_16x16x32_bf16 v[28:31], a[4:7], v[96:99], v[28:31]
    v_exp_f32 v36, v36
    v_mfma_f32_16x16x32_bf16 v[28:31], a[8:11], v[100:103], v[28:31]
    v_exp_f32 v37, v37
    v_mfma_f32_16x16x32_bf16 v[28:31], a[12:15], v[104:107], v[28:31]
    v_exp_f32 v38, v38
    v_mfma_f32_16x16x32_bf16 v[32:35], a[28:31], v[104:107], v[20:23]
    v_exp_f32 v39, v39
    v_mfma_f32_16x16x32_bf16 v[32:35], a[24:27], v[100:103], v[32:35]
    v_cvt_pk_bf16_f32 v56, v36, v37
    v_cvt_pk_bf16_f32 v57, v38, v39
    v_mfma_f32_16x16x32_bf16 v[32:35], a[20:23], v[96:99], v[32:35]
    v_exp_f32 v40, v40
    v_mfma_f32_16x16x32_bf16 v[32:35], a[16:19], v[92:95], v[32:35]
    v_exp_f32 v41, v41
    v_mfma_f32_16x16x32_bf16 v[36:39], a[32:35], v[92:95], v[20:23]
    v_exp_f32 v42, v42
    v_mfma_f32_16x16x32_bf16 v[36:39], a[36:39], v[96:99], v[36:39]
    v_exp_f32 v43, v43
    v_mfma_f32_16x16x32_bf16 v[36:39], a[40:43], v[100:103], v[36:39]
    v_cvt_pk_bf16_f32 v58, v40, v41
    v_cvt_pk_bf16_f32 v59, v42, v43
    v_mfma_f32_16x16x32_bf16 v[36:39], a[44:47], v[104:107], v[36:39]
    v_exp_f32 v28, v28
    v_mfma_f32_16x16x32_bf16 v[40:43], a[60:63], v[104:107], v[20:23]
    v_exp_f32 v29, v29
    v_mfma_f32_16x16x32_bf16 v[40:43], a[56:59], v[100:103], v[40:43]
    v_exp_f32 v30, v30
    v_mfma_f32_16x16x32_bf16 v[40:43], a[52:55], v[96:99], v[40:43]
    v_exp_f32 v31, v31
    v_mfma_f32_16x16x32_bf16 v[40:43], a[48:51], v[92:95], v[40:43]
    v_cvt_pk_bf16_f32 v44, v28, v29
    v_cvt_pk_bf16_f32 v45, v30, v31
    v_mfma_f32_16x16x32_bf16 a[200:203], a[192:195], v[52:55], a[200:203]
    v_exp_f32 v32, v32
    v_mfma_f32_16x16x32_bf16 a[200:203], a[192:195], v[56:59], a[200:203]
    v_exp_f32 v33, v33
    v_mfma_f32_16x16x32_bf16 v[156:159], a[68:71], v[56:59], v[156:159]
    v_exp_f32 v34, v34
    v_mfma_f32_16x16x32_bf16 v[156:159], a[64:67], v[52:55], v[156:159]
    v_exp_f32 v35, v35
    v_mfma_f32_16x16x32_bf16 v[160:163], a[72:75], v[52:55], v[160:163]
    v_cvt_pk_bf16_f32 v46, v32, v33
    v_cvt_pk_bf16_f32 v47, v34, v35
    v_mfma_f32_16x16x32_bf16 v[160:163], a[76:79], v[56:59], v[160:163]
    v_exp_f32 v36, v36
    v_mfma_f32_16x16x32_bf16 v[164:167], a[84:87], v[56:59], v[164:167]
    v_exp_f32 v37, v37
    v_mfma_f32_16x16x32_bf16 v[164:167], a[80:83], v[52:55], v[164:167]
    v_exp_f32 v38, v38
    v_mfma_f32_16x16x32_bf16 v[168:171], a[88:91], v[52:55], v[168:171]
    v_exp_f32 v39, v39
    v_mfma_f32_16x16x32_bf16 v[168:171], a[92:95], v[56:59], v[168:171]
    v_cvt_pk_bf16_f32 v48, v36, v37
    v_cvt_pk_bf16_f32 v49, v38, v39
    v_mfma_f32_16x16x32_bf16 v[172:175], a[100:103], v[56:59], v[172:175]
    v_exp_f32 v40, v40
    v_mfma_f32_16x16x32_bf16 v[172:175], a[96:99], v[52:55], v[172:175]
    v_exp_f32 v41, v41
    v_mfma_f32_16x16x32_bf16 v[176:179], a[104:107], v[52:55], v[176:179]
    buffer_store_dwordx4 a[184:187], v254, s[16:19], s50 offen offset:2048 sc1
    v_mfma_f32_16x16x32_bf16 v[176:179], a[108:111], v[56:59], v[176:179]
    v_exp_f32 v42, v42
    v_mfma_f32_16x16x32_bf16 v[180:183], a[116:119], v[56:59], v[180:183]
    v_exp_f32 v43, v43
    v_mfma_f32_16x16x32_bf16 v[180:183], a[112:115], v[52:55], v[180:183]
    v_cvt_pk_bf16_f32 v50, v40, v41
    v_cvt_pk_bf16_f32 v51, v42, v43
    v_mfma_f32_16x16x32_bf16 v[184:187], a[120:123], v[52:55], v[184:187]
    v_mfma_f32_16x16x32_bf16 v[184:187], a[124:127], v[56:59], v[184:187]
    v_mfma_f32_16x16x32_bf16 v[28:31], a[0:3], v[108:111], v[24:27]
    ds_read_b128 a[0:3], v2 offset:32768
    v_mfma_f32_16x16x32_bf16 v[28:31], a[4:7], v[112:115], v[28:31]
    ds_read_b128 a[4:7], v3 offset:32768
    v_mfma_f32_16x16x32_bf16 v[28:31], a[8:11], v[116:119], v[28:31]
    ds_read_b128 a[8:11], v2 offset:40960
    v_mfma_f32_16x16x32_bf16 v[28:31], a[12:15], v[120:123], v[28:31]
    ds_read_b128 a[12:15], v3 offset:40960
    v_mfma_f32_16x16x32_bf16 v[32:35], a[28:31], v[120:123], v[24:27]
    ds_read_b128 a[28:31], v3 offset:43008
    v_mfma_f32_16x16x32_bf16 v[32:35], a[24:27], v[116:119], v[32:35]
    ds_read_b128 a[24:27], v2 offset:43008
    v_mfma_f32_16x16x32_bf16 v[32:35], a[20:23], v[112:115], v[32:35]
    ds_read_b128 a[20:23], v3 offset:34816
    v_mfma_f32_16x16x32_bf16 v[32:35], a[16:19], v[108:111], v[32:35]
    v_exp_f32 v28, v28
    v_mfma_f32_16x16x32_bf16 v[36:39], a[32:35], v[108:111], v[24:27]
    v_exp_f32 v29, v29
    v_mfma_f32_16x16x32_bf16 v[36:39], a[36:39], v[112:115], v[36:39]
    v_exp_f32 v30, v30
    v_mfma_f32_16x16x32_bf16 v[36:39], a[40:43], v[116:119], v[36:39]
    v_exp_f32 v31, v31
    v_mfma_f32_16x16x32_bf16 v[36:39], a[44:47], v[120:123], v[36:39]
    ds_read_b128 a[16:19], v2 offset:34816
    v_cvt_pk_bf16_f32 v52, v28, v29
    v_mfma_f32_16x16x32_bf16 v[40:43], a[60:63], v[120:123], v[24:27]
    ds_read_b128 a[32:35], v2 offset:36864
    v_cvt_pk_bf16_f32 v53, v30, v31
    v_mfma_f32_16x16x32_bf16 v[40:43], a[56:59], v[116:119], v[40:43]
    v_exp_f32 v32, v32
    v_mfma_f32_16x16x32_bf16 v[40:43], a[52:55], v[112:115], v[40:43]
    v_exp_f32 v33, v33
    v_mfma_f32_16x16x32_bf16 v[40:43], a[48:51], v[108:111], v[40:43]
    v_exp_f32 v34, v34
    v_mfma_f32_16x16x32_bf16 a[204:207], a[192:195], v[44:47], a[204:207]
    v_exp_f32 v35, v35
    v_mfma_f32_16x16x32_bf16 a[204:207], a[192:195], v[48:51], a[204:207]
    ds_read_b128 a[36:39], v3 offset:36864
    v_cvt_pk_bf16_f32 v54, v32, v33
    v_mfma_f32_16x16x32_bf16 v[188:191], a[68:71], v[48:51], v[188:191]
    ds_read_b128 a[40:43], v2 offset:45056
    v_cvt_pk_bf16_f32 v55, v34, v35
    v_mfma_f32_16x16x32_bf16 v[188:191], a[64:67], v[44:47], v[188:191]
    v_exp_f32 v36, v36
    v_mfma_f32_16x16x32_bf16 v[192:195], a[72:75], v[44:47], v[192:195]
    v_exp_f32 v37, v37
    v_mfma_f32_16x16x32_bf16 v[192:195], a[76:79], v[48:51], v[192:195]
    v_exp_f32 v38, v38
    v_mfma_f32_16x16x32_bf16 v[196:199], a[84:87], v[48:51], v[196:199]
    v_exp_f32 v39, v39
    v_mfma_f32_16x16x32_bf16 v[196:199], a[80:83], v[44:47], v[196:199]
    ds_read_b128 a[44:47], v3 offset:45056
    v_cvt_pk_bf16_f32 v56, v36, v37
    v_mfma_f32_16x16x32_bf16 v[200:203], a[88:91], v[44:47], v[200:203]
    ds_read_b128 a[60:63], v3 offset:47104
    v_cvt_pk_bf16_f32 v57, v38, v39
    v_mfma_f32_16x16x32_bf16 v[200:203], a[92:95], v[48:51], v[200:203]
    v_exp_f32 v40, v40
    v_mfma_f32_16x16x32_bf16 v[204:207], a[100:103], v[48:51], v[204:207]
    v_exp_f32 v41, v41
    v_mfma_f32_16x16x32_bf16 v[204:207], a[96:99], v[44:47], v[204:207]
    v_exp_f32 v42, v42
    v_mfma_f32_16x16x32_bf16 v[208:211], a[104:107], v[44:47], v[208:211]
    v_exp_f32 v43, v43
    v_mfma_f32_16x16x32_bf16 v[208:211], a[108:111], v[48:51], v[208:211]
    ds_read_b128 a[56:59], v2 offset:47104
    v_cvt_pk_bf16_f32 v58, v40, v41
    v_mfma_f32_16x16x32_bf16 v[212:215], a[116:119], v[48:51], v[212:215]
    ds_read_b128 a[52:55], v3 offset:38912
    v_cvt_pk_bf16_f32 v59, v42, v43
    v_mfma_f32_16x16x32_bf16 v[212:215], a[112:115], v[44:47], v[212:215]
    ds_read_b128 a[48:51], v2 offset:38912
    v_mfma_f32_16x16x32_bf16 v[216:219], a[120:123], v[44:47], v[216:219]
    v_mfma_f32_16x16x32_bf16 v[216:219], a[124:127], v[48:51], v[216:219]
    s_waitcnt lgkmcnt(4)
    v_mfma_f32_16x16x32_bf16 v[28:31], a[0:3], v[60:63], v[12:15]
    v_mfma_f32_16x16x32_bf16 v[28:31], a[4:7], v[64:67], v[28:31]
    v_mfma_f32_16x16x32_bf16 v[28:31], a[8:11], v[68:71], v[28:31]
    v_mfma_f32_16x16x32_bf16 v[28:31], a[12:15], v[72:75], v[28:31]
    v_mfma_f32_16x16x32_bf16 v[32:35], a[28:31], v[72:75], v[12:15]
    v_mfma_f32_16x16x32_bf16 v[32:35], a[24:27], v[68:71], v[32:35]
    v_mfma_f32_16x16x32_bf16 v[32:35], a[20:23], v[64:67], v[32:35]
    v_mfma_f32_16x16x32_bf16 v[32:35], a[16:19], v[60:63], v[32:35]
    s_nop 3
    v_exp_f32 v28, v28
    v_mfma_f32_16x16x32_bf16 v[36:39], a[32:35], v[60:63], v[12:15]
    v_exp_f32 v29, v29
    v_mfma_f32_16x16x32_bf16 v[36:39], a[36:39], v[64:67], v[36:39]
    v_exp_f32 v30, v30
    v_mfma_f32_16x16x32_bf16 v[36:39], a[40:43], v[68:71], v[36:39]
    v_exp_f32 v31, v31
    v_mfma_f32_16x16x32_bf16 v[36:39], a[44:47], v[72:75], v[36:39]
    s_waitcnt lgkmcnt(0)
    v_exp_f32 v32, v32
    v_mfma_f32_16x16x32_bf16 v[40:43], a[60:63], v[72:75], v[12:15]
    v_exp_f32 v33, v33
    v_mfma_f32_16x16x32_bf16 v[40:43], a[56:59], v[68:71], v[40:43]
    v_exp_f32 v34, v34
    v_mfma_f32_16x16x32_bf16 v[40:43], a[52:55], v[64:67], v[40:43]
    v_exp_f32 v35, v35
    v_mfma_f32_16x16x32_bf16 v[40:43], a[48:51], v[60:63], v[40:43]
    v_exp_f32 v36, v36
    v_mfma_f32_16x16x32_bf16 a[208:211], a[192:195], v[52:55], a[208:211]
    v_exp_f32 v37, v37
    v_mfma_f32_16x16x32_bf16 a[208:211], a[192:195], v[56:59], a[208:211]
    v_exp_f32 v38, v38
    v_mfma_f32_16x16x32_bf16 v[220:223], a[68:71], v[56:59], v[220:223]
    ds_read_b64_tr_b16 a[68:69], v4 offset:36864
    v_cvt_pk_bf16_f32 v44, v28, v29
    v_mfma_f32_16x16x32_bf16 v[220:223], a[64:67], v[52:55], v[220:223]
    ds_read_b64_tr_b16 a[70:71], v4 offset:38912
    v_cvt_pk_bf16_f32 v45, v30, v31
    v_mfma_f32_16x16x32_bf16 v[224:227], a[72:75], v[52:55], v[224:227]
    buffer_store_dwordx4 a[188:191], v254, s[16:19], s50 offen offset:3072 sc1
    v_mfma_f32_16x16x32_bf16 v[224:227], a[76:79], v[56:59], v[224:227]
    ds_read_b64_tr_b16 a[64:65], v4 offset:32768
    v_cvt_pk_bf16_f32 v46, v32, v33
    v_mfma_f32_16x16x32_bf16 v[228:231], a[84:87], v[56:59], v[228:231]
    ds_read_b64_tr_b16 a[66:67], v4 offset:34816
    v_cvt_pk_bf16_f32 v47, v34, v35
    v_mfma_f32_16x16x32_bf16 v[228:231], a[80:83], v[52:55], v[228:231]
    v_exp_f32 v39, v39
    v_mfma_f32_16x16x32_bf16 v[232:235], a[88:91], v[52:55], v[232:235]
    ds_read_b64_tr_b16 a[72:73], v5 offset:32768
    v_cvt_pk_bf16_f32 v48, v36, v37
    v_mfma_f32_16x16x32_bf16 v[232:235], a[92:95], v[56:59], v[232:235]
    ds_read_b64_tr_b16 a[74:75], v5 offset:34816
    v_cvt_pk_bf16_f32 v49, v38, v39
    v_mfma_f32_16x16x32_bf16 v[236:239], a[100:103], v[56:59], v[236:239]
    v_exp_f32 v40, v40
    v_mfma_f32_16x16x32_bf16 v[236:239], a[96:99], v[52:55], v[236:239]
    v_exp_f32 v41, v41
    v_mfma_f32_16x16x32_bf16 v[240:243], a[104:107], v[52:55], v[240:243]
    v_exp_f32 v42, v42
    v_mfma_f32_16x16x32_bf16 v[240:243], a[108:111], v[56:59], v[240:243]
    v_exp_f32 v43, v43
    v_mfma_f32_16x16x32_bf16 v[244:247], a[116:119], v[56:59], v[244:247]
    ds_read_b64_tr_b16 a[76:77], v5 offset:36864
    v_cvt_pk_bf16_f32 v50, v40, v41
    v_mfma_f32_16x16x32_bf16 v[244:247], a[112:115], v[52:55], v[244:247]
    ds_read_b64_tr_b16 a[78:79], v5 offset:38912
    v_cvt_pk_bf16_f32 v51, v42, v43
    v_mfma_f32_16x16x32_bf16 v[248:251], a[120:123], v[52:55], v[248:251]
    ds_read_b64_tr_b16 a[84:85], v6 offset:36864
    v_mfma_f32_16x16x32_bf16 v[248:251], a[124:127], v[56:59], v[248:251]
    s_waitcnt vmcnt(3)
    s_barrier
    v_mfma_f32_16x16x32_bf16 v[28:31], a[0:3], v[76:79], v[16:19]
    ds_read_b64_tr_b16 a[86:87], v6 offset:38912
    v_mfma_f32_16x16x32_bf16 v[28:31], a[4:7], v[80:83], v[28:31]
    ds_read_b64_tr_b16 a[80:81], v6 offset:32768
    v_mfma_f32_16x16x32_bf16 v[28:31], a[8:11], v[84:87], v[28:31]
    ds_read_b64_tr_b16 a[82:83], v6 offset:34816
    v_mfma_f32_16x16x32_bf16 v[28:31], a[12:15], v[88:91], v[28:31]
    ds_read_b64_tr_b16 a[88:89], v7 offset:32768
    v_mfma_f32_16x16x32_bf16 v[32:35], a[28:31], v[88:91], v[16:19]
    ds_read_b64_tr_b16 a[90:91], v7 offset:34816
    v_mfma_f32_16x16x32_bf16 v[32:35], a[24:27], v[84:87], v[32:35]
    ds_read_b64_tr_b16 a[92:93], v7 offset:36864
    v_mfma_f32_16x16x32_bf16 v[32:35], a[20:23], v[80:83], v[32:35]
    ds_read_b64_tr_b16 a[94:95], v7 offset:38912
    v_mfma_f32_16x16x32_bf16 v[32:35], a[16:19], v[76:79], v[32:35]
    v_exp_f32 v28, v28
    v_mfma_f32_16x16x32_bf16 v[36:39], a[32:35], v[76:79], v[16:19]
    ds_read_b64_tr_b16 a[100:101], v4 offset:45056
    v_exp_f32 v29, v29
    v_mfma_f32_16x16x32_bf16 v[36:39], a[36:39], v[80:83], v[36:39]
    ds_read_b64_tr_b16 a[102:103], v4 offset:47104
    v_cvt_pk_bf16_f32 v52, v28, v29
    v_mfma_f32_16x16x32_bf16 v[36:39], a[40:43], v[84:87], v[36:39]
    ds_read_b64_tr_b16 a[96:97], v4 offset:40960
    v_exp_f32 v30, v30
    v_mfma_f32_16x16x32_bf16 v[36:39], a[44:47], v[88:91], v[36:39]
    ds_read_b64_tr_b16 a[98:99], v4 offset:43008
    v_exp_f32 v31, v31
    v_mfma_f32_16x16x32_bf16 v[40:43], a[60:63], v[88:91], v[16:19]
    ds_read_b64_tr_b16 a[104:105], v5 offset:40960
    v_cvt_pk_bf16_f32 v53, v30, v31
    v_mfma_f32_16x16x32_bf16 v[40:43], a[56:59], v[84:87], v[40:43]
    ds_read_b64_tr_b16 a[106:107], v5 offset:43008
    v_mfma_f32_16x16x32_bf16 v[40:43], a[52:55], v[80:83], v[40:43]
    ds_read_b64_tr_b16 a[108:109], v5 offset:45056
    v_mfma_f32_16x16x32_bf16 v[40:43], a[48:51], v[76:79], v[40:43]
    ds_read_b64_tr_b16 a[110:111], v5 offset:47104
    v_mfma_f32_16x16x32_bf16 a[196:199], a[192:195], v[44:47], a[196:199]
    ds_read_b64_tr_b16 a[116:117], v6 offset:45056
    v_mfma_f32_16x16x32_bf16 a[196:199], a[192:195], v[48:51], a[196:199]
    s_waitcnt lgkmcnt(9)
    ds_read_b64_tr_b16 a[118:119], v6 offset:47104
    v_exp_f32 v32, v32
    v_mfma_f32_16x16x32_bf16 v[124:127], a[68:71], v[48:51], v[124:127]
    ds_read_b64_tr_b16 a[112:113], v6 offset:40960
    v_exp_f32 v33, v33
    v_mfma_f32_16x16x32_bf16 v[124:127], a[64:67], v[44:47], v[124:127]
    ds_read_b64_tr_b16 a[114:115], v6 offset:43008
    v_cvt_pk_bf16_f32 v54, v32, v33
    v_mfma_f32_16x16x32_bf16 v[128:131], a[72:75], v[44:47], v[128:131]
    ds_read_b64_tr_b16 a[120:121], v7 offset:40960
    v_exp_f32 v34, v34
    v_mfma_f32_16x16x32_bf16 v[128:131], a[76:79], v[48:51], v[128:131]
    ds_read_b64_tr_b16 a[122:123], v7 offset:43008
    v_exp_f32 v35, v35
    v_mfma_f32_16x16x32_bf16 v[132:135], a[84:87], v[48:51], v[132:135]
    ds_read_b64_tr_b16 a[124:125], v7 offset:45056
    v_cvt_pk_bf16_f32 v55, v34, v35
    v_mfma_f32_16x16x32_bf16 v[132:135], a[80:83], v[44:47], v[132:135]
    ds_read_b64_tr_b16 a[126:127], v7 offset:47104
    v_exp_f32 v36, v36
    v_mfma_f32_16x16x32_bf16 v[136:139], a[88:91], v[44:47], v[136:139]
    ds_read_b128 a[0:3], v2 offset:49152
    v_exp_f32 v37, v37
    v_mfma_f32_16x16x32_bf16 v[136:139], a[92:95], v[48:51], v[136:139]
    s_waitcnt lgkmcnt(9)
    ds_read_b128 a[4:7], v3 offset:49152
    v_cvt_pk_bf16_f32 v56, v36, v37
    v_mfma_f32_16x16x32_bf16 v[140:143], a[100:103], v[48:51], v[140:143]
    ds_read_b128 a[8:11], v2 offset:57344
    v_exp_f32 v38, v38
    v_mfma_f32_16x16x32_bf16 v[140:143], a[96:99], v[44:47], v[140:143]
    ds_read_b128 a[12:15], v3 offset:57344
    v_exp_f32 v39, v39
    v_mfma_f32_16x16x32_bf16 v[144:147], a[104:107], v[44:47], v[144:147]
    ds_read_b128 a[28:31], v3 offset:59392
    v_cvt_pk_bf16_f32 v57, v38, v39
    v_mfma_f32_16x16x32_bf16 v[144:147], a[108:111], v[48:51], v[144:147]
    s_waitcnt lgkmcnt(9)
    ds_read_b128 a[24:27], v2 offset:59392
    v_mfma_f32_16x16x32_bf16 v[148:151], a[116:119], v[48:51], v[148:151]
    ds_read_b128 a[20:23], v3 offset:51200
    v_mfma_f32_16x16x32_bf16 v[148:151], a[112:115], v[44:47], v[148:151]
    s_waitcnt lgkmcnt(9)
    ds_read_b128 a[16:19], v2 offset:51200
    v_mfma_f32_16x16x32_bf16 v[152:155], a[120:123], v[44:47], v[152:155]
    s_waitcnt lgkmcnt(8)
    ds_read_b128 a[32:35], v2 offset:53248
    v_mfma_f32_16x16x32_bf16 v[152:155], a[124:127], v[48:51], v[152:155]
    s_waitcnt lgkmcnt(8)
    ds_read_b128 a[36:39], v3 offset:53248
    v_mfma_f32_16x16x32_bf16 v[28:31], a[0:3], v[60:63], v[12:15]
    s_waitcnt lgkmcnt(8)
    ds_read_b128 a[40:43], v2 offset:61440
    v_mfma_f32_16x16x32_bf16 v[28:31], a[4:7], v[64:67], v[28:31]
    s_waitcnt lgkmcnt(8)
    ds_read_b128 a[44:47], v3 offset:61440
    v_mfma_f32_16x16x32_bf16 v[28:31], a[8:11], v[68:71], v[28:31]
    s_waitcnt lgkmcnt(8)
    ds_read_b128 a[60:63], v3 offset:63488
    v_mfma_f32_16x16x32_bf16 v[28:31], a[12:15], v[72:75], v[28:31]
    s_waitcnt lgkmcnt(8)
    ds_read_b128 a[56:59], v2 offset:63488
    v_mfma_f32_16x16x32_bf16 v[32:35], a[28:31], v[72:75], v[12:15]
    s_waitcnt lgkmcnt(8)
    ds_read_b128 a[52:55], v3 offset:55296
    v_mfma_f32_16x16x32_bf16 v[32:35], a[24:27], v[68:71], v[32:35]
    s_waitcnt lgkmcnt(8)
    ds_read_b128 a[48:51], v2 offset:55296
    v_exp_f32 v40, v40
    v_mfma_f32_16x16x32_bf16 v[32:35], a[20:23], v[64:67], v[32:35]
    s_waitcnt lgkmcnt(8)
    v_exp_f32 v41, v41
    v_mfma_f32_16x16x32_bf16 v[32:35], a[16:19], v[60:63], v[32:35]
    s_waitcnt lgkmcnt(7)
    v_exp_f32 v42, v42
    v_mfma_f32_16x16x32_bf16 v[36:39], a[32:35], v[60:63], v[12:15]
    s_waitcnt lgkmcnt(6)
    v_exp_f32 v43, v43
    v_mfma_f32_16x16x32_bf16 v[36:39], a[36:39], v[64:67], v[36:39]
    s_waitcnt lgkmcnt(5)
    v_exp_f32 v28, v28
    v_mfma_f32_16x16x32_bf16 v[36:39], a[40:43], v[68:71], v[36:39]
    s_waitcnt lgkmcnt(4)
    v_cvt_pk_bf16_f32 v58, v40, v41
    v_cvt_pk_bf16_f32 v59, v42, v43
    v_mfma_f32_16x16x32_bf16 v[36:39], a[44:47], v[72:75], v[36:39]
    s_waitcnt lgkmcnt(3)
    v_exp_f32 v29, v29
    v_mfma_f32_16x16x32_bf16 v[40:43], a[60:63], v[72:75], v[12:15]
    s_waitcnt lgkmcnt(2)
    v_exp_f32 v30, v30
    v_mfma_f32_16x16x32_bf16 v[40:43], a[56:59], v[68:71], v[40:43]
    s_waitcnt lgkmcnt(1)
    v_exp_f32 v31, v31
    v_mfma_f32_16x16x32_bf16 v[40:43], a[52:55], v[64:67], v[40:43]
    s_waitcnt lgkmcnt(0)
    v_exp_f32 v32, v32
    v_mfma_f32_16x16x32_bf16 v[40:43], a[48:51], v[60:63], v[40:43]
    v_exp_f32 v33, v33
    v_mfma_f32_16x16x32_bf16 a[200:203], a[192:195], v[52:55], a[200:203]
    v_exp_f32 v34, v34
    v_mfma_f32_16x16x32_bf16 a[200:203], a[192:195], v[56:59], a[200:203]
    v_exp_f32 v35, v35
    v_mfma_f32_16x16x32_bf16 v[156:159], a[68:71], v[56:59], v[156:159]
    ds_read_b64_tr_b16 a[68:69], v4 offset:53248
    v_cvt_pk_bf16_f32 v44, v28, v29
    v_mfma_f32_16x16x32_bf16 v[156:159], a[64:67], v[52:55], v[156:159]
    ds_read_b64_tr_b16 a[70:71], v4 offset:55296
    v_cvt_pk_bf16_f32 v45, v30, v31
    v_mfma_f32_16x16x32_bf16 v[160:163], a[72:75], v[52:55], v[160:163]
    v_exp_f32 v36, v36
    v_mfma_f32_16x16x32_bf16 v[160:163], a[76:79], v[56:59], v[160:163]
    ds_read_b64_tr_b16 a[64:65], v4 offset:49152
    v_cvt_pk_bf16_f32 v46, v32, v33
    v_mfma_f32_16x16x32_bf16 v[164:167], a[84:87], v[56:59], v[164:167]
    ds_read_b64_tr_b16 a[66:67], v4 offset:51200
    v_cvt_pk_bf16_f32 v47, v34, v35
    v_mfma_f32_16x16x32_bf16 v[164:167], a[80:83], v[52:55], v[164:167]
    v_exp_f32 v37, v37
    v_mfma_f32_16x16x32_bf16 v[168:171], a[88:91], v[52:55], v[168:171]
    v_exp_f32 v38, v38
    v_mfma_f32_16x16x32_bf16 v[168:171], a[92:95], v[56:59], v[168:171]
    v_exp_f32 v39, v39
    v_mfma_f32_16x16x32_bf16 v[172:175], a[100:103], v[56:59], v[172:175]
    v_exp_f32 v40, v40
    v_mfma_f32_16x16x32_bf16 v[172:175], a[96:99], v[52:55], v[172:175]
    ds_read_b64_tr_b16 a[72:73], v5 offset:49152
    v_cvt_pk_bf16_f32 v48, v36, v37
    v_mfma_f32_16x16x32_bf16 v[176:179], a[104:107], v[52:55], v[176:179]
    ds_read_b64_tr_b16 a[74:75], v5 offset:51200
    v_cvt_pk_bf16_f32 v49, v38, v39
    v_mfma_f32_16x16x32_bf16 v[176:179], a[108:111], v[56:59], v[176:179]
    v_exp_f32 v41, v41
    v_mfma_f32_16x16x32_bf16 v[180:183], a[116:119], v[56:59], v[180:183]
    v_exp_f32 v42, v42
    v_mfma_f32_16x16x32_bf16 v[180:183], a[112:115], v[52:55], v[180:183]
    v_exp_f32 v43, v43
    v_mfma_f32_16x16x32_bf16 v[184:187], a[120:123], v[52:55], v[184:187]
    ds_read_b64_tr_b16 a[76:77], v5 offset:53248
    v_cvt_pk_bf16_f32 v50, v40, v41
    v_mfma_f32_16x16x32_bf16 v[184:187], a[124:127], v[56:59], v[184:187]
    ds_read_b64_tr_b16 a[78:79], v5 offset:55296
    v_cvt_pk_bf16_f32 v51, v42, v43
    v_mfma_f32_16x16x32_bf16 v[28:31], a[0:3], v[76:79], v[16:19]
    ds_read_b64_tr_b16 a[84:85], v6 offset:53248
    v_mfma_f32_16x16x32_bf16 v[28:31], a[4:7], v[80:83], v[28:31]
    ds_read_b64_tr_b16 a[86:87], v6 offset:55296
    v_mfma_f32_16x16x32_bf16 v[28:31], a[8:11], v[84:87], v[28:31]
    ds_read_b64_tr_b16 a[80:81], v6 offset:49152
    v_mfma_f32_16x16x32_bf16 v[28:31], a[12:15], v[88:91], v[28:31]
    ds_read_b64_tr_b16 a[82:83], v6 offset:51200
    v_mfma_f32_16x16x32_bf16 v[32:35], a[28:31], v[88:91], v[16:19]
    ds_read_b64_tr_b16 a[88:89], v7 offset:49152
    v_mfma_f32_16x16x32_bf16 v[32:35], a[24:27], v[84:87], v[32:35]
    ds_read_b64_tr_b16 a[90:91], v7 offset:51200
    v_mfma_f32_16x16x32_bf16 v[32:35], a[20:23], v[80:83], v[32:35]
    ds_read_b64_tr_b16 a[92:93], v7 offset:53248
    v_mfma_f32_16x16x32_bf16 v[32:35], a[16:19], v[76:79], v[32:35]
    ds_read_b64_tr_b16 a[94:95], v7 offset:55296
    v_exp_f32 v28, v28
    v_mfma_f32_16x16x32_bf16 v[36:39], a[32:35], v[76:79], v[16:19]
    ds_read_b64_tr_b16 a[100:101], v4 offset:61440
    v_exp_f32 v29, v29
    v_mfma_f32_16x16x32_bf16 v[36:39], a[36:39], v[80:83], v[36:39]
    ds_read_b64_tr_b16 a[102:103], v4 offset:63488
    v_cvt_pk_bf16_f32 v52, v28, v29
    v_mfma_f32_16x16x32_bf16 v[36:39], a[40:43], v[84:87], v[36:39]
    ds_read_b64_tr_b16 a[96:97], v4 offset:57344
    v_mfma_f32_16x16x32_bf16 v[36:39], a[44:47], v[88:91], v[36:39]
    ds_read_b64_tr_b16 a[98:99], v4 offset:59392
    v_mfma_f32_16x16x32_bf16 v[40:43], a[60:63], v[88:91], v[16:19]
    ds_read_b64_tr_b16 a[104:105], v5 offset:57344
    v_mfma_f32_16x16x32_bf16 v[40:43], a[56:59], v[84:87], v[40:43]
    ds_read_b64_tr_b16 a[106:107], v5 offset:59392
    v_mfma_f32_16x16x32_bf16 v[40:43], a[52:55], v[80:83], v[40:43]
    ds_read_b64_tr_b16 a[108:109], v5 offset:61440
    v_mfma_f32_16x16x32_bf16 v[40:43], a[48:51], v[76:79], v[40:43]
    ds_read_b64_tr_b16 a[110:111], v5 offset:63488
    v_exp_f32 v30, v30
    v_mfma_f32_16x16x32_bf16 a[196:199], a[192:195], v[44:47], a[196:199]
    ds_read_b64_tr_b16 a[116:117], v6 offset:61440
    v_exp_f32 v31, v31
    v_mfma_f32_16x16x32_bf16 a[196:199], a[192:195], v[48:51], a[196:199]
    s_waitcnt lgkmcnt(9)
    ds_read_b64_tr_b16 a[118:119], v6 offset:63488
    v_cvt_pk_bf16_f32 v53, v30, v31
    v_mfma_f32_16x16x32_bf16 v[124:127], a[68:71], v[48:51], v[124:127]
    ds_read_b64_tr_b16 a[112:113], v6 offset:57344
    v_exp_f32 v32, v32
    v_mfma_f32_16x16x32_bf16 v[124:127], a[64:67], v[44:47], v[124:127]
    ds_read_b64_tr_b16 a[114:115], v6 offset:59392
    v_exp_f32 v33, v33
    v_mfma_f32_16x16x32_bf16 v[128:131], a[72:75], v[44:47], v[128:131]
    ds_read_b64_tr_b16 a[120:121], v7 offset:57344
    v_cvt_pk_bf16_f32 v54, v32, v33
    v_mfma_f32_16x16x32_bf16 v[128:131], a[76:79], v[48:51], v[128:131]
    ds_read_b64_tr_b16 a[122:123], v7 offset:59392
    v_exp_f32 v34, v34
    v_mfma_f32_16x16x32_bf16 v[132:135], a[84:87], v[48:51], v[132:135]
    ds_read_b64_tr_b16 a[124:125], v7 offset:61440
    v_exp_f32 v35, v35
    v_mfma_f32_16x16x32_bf16 v[132:135], a[80:83], v[44:47], v[132:135]
    ds_read_b64_tr_b16 a[126:127], v7 offset:63488
    v_cvt_pk_bf16_f32 v55, v34, v35
    v_mfma_f32_16x16x32_bf16 v[136:139], a[88:91], v[44:47], v[136:139]
    v_exp_f32 v36, v36
    v_mfma_f32_16x16x32_bf16 v[136:139], a[92:95], v[48:51], v[136:139]
    s_waitcnt lgkmcnt(8)
    v_exp_f32 v37, v37
    v_mfma_f32_16x16x32_bf16 v[140:143], a[100:103], v[48:51], v[140:143]
    v_exp_f32 v38, v38
    v_mfma_f32_16x16x32_bf16 v[140:143], a[96:99], v[44:47], v[140:143]
L_pad9:
    s_cbranch_vccnz L_touched2
    v_exp_f32 v39, v39
    v_mfma_f32_16x16x32_bf16 v[144:147], a[104:107], v[44:47], v[144:147]
    v_exp_f32 v40, v40
    v_mfma_f32_16x16x32_bf16 v[144:147], a[108:111], v[48:51], v[144:147]
    s_waitcnt lgkmcnt(4)
    v_cvt_pk_bf16_f32 v56, v36, v37
    v_cvt_pk_bf16_f32 v57, v38, v39
    v_mfma_f32_16x16x32_bf16 v[148:151], a[116:119], v[48:51], v[148:151]
    v_exp_f32 v41, v41
    v_mfma_f32_16x16x32_bf16 v[148:151], a[112:115], v[44:47], v[148:151]
    s_waitcnt lgkmcnt(2)
    v_exp_f32 v42, v42
    v_mfma_f32_16x16x32_bf16 v[152:155], a[120:123], v[44:47], v[152:155]
    s_waitcnt lgkmcnt(0)
    v_exp_f32 v43, v43
    v_mfma_f32_16x16x32_bf16 v[152:155], a[124:127], v[48:51], v[152:155]
    v_cvt_pk_bf16_f32 v58, v40, v41
    v_cvt_pk_bf16_f32 v59, v42, v43
    v_accvgpr_read_b32 v8, a196
    v_rcp_f32 v60, v8
    v_cmp_nlt_f32 s[40:41], v8, s30
    v_pk_mul_f32 v[124:125], v[124:125], v[60:61] op_sel_hi:[1,0]
    v_pk_mul_f32 v[126:127], v[126:127], v[60:61] op_sel_hi:[1,0]
    v_pk_mul_f32 v[128:129], v[128:129], v[60:61] op_sel_hi:[1,0]
    v_pk_mul_f32 v[130:131], v[130:131], v[60:61] op_sel_hi:[1,0]
    v_pk_mul_f32 v[132:133], v[132:133], v[60:61] op_sel_hi:[1,0]
    v_pk_mul_f32 v[134:135], v[134:135], v[60:61] op_sel_hi:[1,0]
    v_pk_mul_f32 v[136:137], v[136:137], v[60:61] op_sel_hi:[1,0]
    v_pk_mul_f32 v[138:139], v[138:139], v[60:61] op_sel_hi:[1,0]
    v_pk_mul_f32 v[140:141], v[140:141], v[60:61] op_sel_hi:[1,0]
    v_pk_mul_f32 v[142:143], v[142:143], v[60:61] op_sel_hi:[1,0]
    v_pk_mul_f32 v[144:145], v[144:145], v[60:61] op_sel_hi:[1,0]
    v_pk_mul_f32 v[146:147], v[146:147], v[60:61] op_sel_hi:[1,0]
    v_pk_mul_f32 v[148:149], v[148:149], v[60:61] op_sel_hi:[1,0]
    v_pk_mul_f32 v[150:151], v[150:151], v[60:61] op_sel_hi:[1,0]
    v_pk_mul_f32 v[152:153], v[152:153], v[60:61] op_sel_hi:[1,0]
    v_pk_mul_f32 v[154:155], v[154:155], v[60:61] op_sel_hi:[1,0]
    v_mfma_f32_16x16x32_bf16 v[28:31], a[0:3], v[92:95], v[20:23]
    v_cvt_pk_bf16_f32 v124, v124, v125
    v_cvt_pk_bf16_f32 v125, v126, v127
    v_mfma_f32_16x16x32_bf16 v[28:31], a[4:7], v[96:99], v[28:31]
    ds_write_b64 v252, v[124:125] offset:0
    v_cvt_pk_bf16_f32 v128, v128, v129
    v_cvt_pk_bf16_f32 v129, v130, v131
    v_mfma_f32_16x16x32_bf16 v[28:31], a[8:11], v[100:103], v[28:31]
    v_cvt_pk_bf16_f32 v132, v132, v133
    v_cvt_pk_bf16_f32 v133, v134, v135
    v_mfma_f32_16x16x32_bf16 v[28:31], a[12:15], v[104:107], v[28:31]
    ds_write_b64 v252, v[128:129] offset:32
    v_cvt_pk_bf16_f32 v136, v136, v137
    v_cvt_pk_bf16_f32 v137, v138, v139
    v_mfma_f32_16x16x32_bf16 v[32:35], a[28:31], v[104:107], v[20:23]
    v_cvt_pk_bf16_f32 v140, v140, v141
    v_cvt_pk_bf16_f32 v141, v142, v143
    v_mfma_f32_16x16x32_bf16 v[32:35], a[24:27], v[100:103], v[32:35]
    ds_write_b64 v252, v[132:133] offset:64
    v_cvt_pk_bf16_f32 v144, v144, v145
    v_cvt_pk_bf16_f32 v145, v146, v147
    v_mfma_f32_16x16x32_bf16 v[32:35], a[20:23], v[96:99], v[32:35]
    v_cvt_pk_bf16_f32 v148, v148, v149
    v_cvt_pk_bf16_f32 v149, v150, v151
    v_mfma_f32_16x16x32_bf16 v[32:35], a[16:19], v[92:95], v[32:35]
    ds_write_b64 v252, v[136:137] offset:96
    v_cvt_pk_bf16_f32 v152, v152, v153
    v_cvt_pk_bf16_f32 v153, v154, v155
    v_mfma_f32_16x16x32_bf16 v[36:39], a[32:35], v[92:95], v[20:23]
    v_exp_f32 v28, v28
    v_mfma_f32_16x16x32_bf16 v[36:39], a[36:39], v[96:99], v[36:39]
    ds_write_b64 v252, v[140:141] offset:128
    v_exp_f32 v29, v29
    v_mfma_f32_16x16x32_bf16 v[36:39], a[40:43], v[100:103], v[36:39]
    v_exp_f32 v30, v30
    v_mfma_f32_16x16x32_bf16 v[36:39], a[44:47], v[104:107], v[36:39]
    ds_write_b64 v252, v[144:145] offset:160
    v_cvt_pk_bf16_f32 v44, v28, v29
    v_mfma_f32_16x16x32_bf16 v[40:43], a[60:63], v[104:107], v[20:23]
    v_exp_f32 v31, v31
    v_mfma_f32_16x16x32_bf16 v[40:43], a[56:59], v[100:103], v[40:43]
    ds_write_b64 v252, v[148:149] offset:192
    v_cvt_pk_bf16_f32 v45, v30, v31
    v_mfma_f32_16x16x32_bf16 v[40:43], a[52:55], v[96:99], v[40:43]
    v_exp_f32 v32, v32
    v_mfma_f32_16x16x32_bf16 v[40:43], a[48:51], v[92:95], v[40:43]
    ds_write_b64 v252, v[152:153] offset:224
    v_exp_f32 v33, v33
    v_mfma_f32_16x16x32_bf16 a[200:203], a[192:195], v[52:55], a[200:203]
    v_exp_f32 v34, v34
    v_mfma_f32_16x16x32_bf16 a[200:203], a[192:195], v[56:59], a[200:203]
    ds_read_b128 a[128:131], v253 offset:0
    v_cvt_pk_bf16_f32 v46, v32, v33
    v_mfma_f32_16x16x32_bf16 v[156:159], a[68:71], v[56:59], v[156:159]
    v_exp_f32 v35, v35
    v_mfma_f32_16x16x32_bf16 v[156:159], a[64:67], v[52:55], v[156:159]
    ds_read_b128 a[132:135], v253 offset:1088
    v_cvt_pk_bf16_f32 v47, v34, v35
    v_mfma_f32_16x16x32_bf16 v[160:163], a[72:75], v[52:55], v[160:163]
    s_add_u32 s50, s25, 0
    v_exp_f32 v36, v36
    v_mfma_f32_16x16x32_bf16 v[160:163], a[76:79], v[56:59], v[160:163]
    ds_read_b128 a[136:139], v253 offset:2176
    v_mfma_f32_16x16x32_bf16 v[164:167], a[84:87], v[56:59], v[164:167]
    v_exp_f32 v37, v37
    v_mfma_f32_16x16x32_bf16 v[164:167], a[80:83], v[52:55], v[164:167]
    ds_read_b128 a[140:143], v253 offset:3264
    v_cvt_pk_bf16_f32 v48, v36, v37
    v_mfma_f32_16x16x32_bf16 v[168:171], a[88:91], v[52:55], v[168:171]
    v_exp_f32 v38, v38
    v_mfma_f32_16x16x32_bf16 v[168:171], a[92:95], v[56:59], v[168:171]
    v_exp_f32 v39, v39
    v_mfma_f32_16x16x32_bf16 v[172:175], a[100:103], v[56:59], v[172:175]
    v_exp_f32 v40, v40
    v_mfma_f32_16x16x32_bf16 v[172:175], a[96:99], v[52:55], v[172:175]
    s_waitcnt lgkmcnt(3)
    buffer_store_dwordx4 a[128:131], v254, s[16:19], s50 offen sc1
    v_mfma_f32_16x16x32_bf16 v[176:179], a[104:107], v[52:55], v[176:179]
    v_exp_f32 v41, v41
    v_mfma_f32_16x16x32_bf16 v[176:179], a[108:111], v[56:59], v[176:179]
    v_exp_f32 v42, v42
    v_mfma_f32_16x16x32_bf16 v[180:183], a[116:119], v[56:59], v[180:183]
    v_cvt_pk_bf16_f32 v49, v38, v39
    v_cvt_pk_bf16_f32 v50, v40, v41
    v_mfma_f32_16x16x32_bf16 v[180:183], a[112:115], v[52:55], v[180:183]
    v_exp_f32 v43, v43
    v_mfma_f32_16x16x32_bf16 v[184:187], a[120:123], v[52:55], v[184:187]
    v_cvt_pk_bf16_f32 v51, v42, v43
    v_mfma_f32_16x16x32_bf16 v[184:187], a[124:127], v[56:59], v[184:187]
    s_waitcnt lgkmcnt(2)
    buffer_store_dwordx4 a[132:135], v254, s[16:19], s50 offen offset:1024 sc1
    v_accvgpr_read_b32 v9, a200
    v_rcp_f32 v76, v9
    v_cmp_nlt_f32 s[42:43], v9, s30
    v_pk_mul_f32 v[156:157], v[156:157], v[76:77] op_sel_hi:[1,0]
    v_pk_mul_f32 v[158:159], v[158:159], v[76:77] op_sel_hi:[1,0]
    v_pk_mul_f32 v[160:161], v[160:161], v[76:77] op_sel_hi:[1,0]
    v_pk_mul_f32 v[162:163], v[162:163], v[76:77] op_sel_hi:[1,0]
    v_pk_mul_f32 v[164:165], v[164:165], v[76:77] op_sel_hi:[1,0]
    v_pk_mul_f32 v[166:167], v[166:167], v[76:77] op_sel_hi:[1,0]
    v_pk_mul_f32 v[168:169], v[168:169], v[76:77] op_sel_hi:[1,0]
    v_pk_mul_f32 v[170:171], v[170:171], v[76:77] op_sel_hi:[1,0]
    v_pk_mul_f32 v[172:173], v[172:173], v[76:77] op_sel_hi:[1,0]
    v_pk_mul_f32 v[174:175], v[174:175], v[76:77] op_sel_hi:[1,0]
    v_pk_mul_f32 v[176:177], v[176:177], v[76:77] op_sel_hi:[1,0]
    v_pk_mul_f32 v[178:179], v[178:179], v[76:77] op_sel_hi:[1,0]
    v_pk_mul_f32 v[180:181], v[180:181], v[76:77] op_sel_hi:[1,0]
    v_pk_mul_f32 v[182:183], v[182:183], v[76:77] op_sel_hi:[1,0]
    v_pk_mul_f32 v[184:185], v[184:185], v[76:77] op_sel_hi:[1,0]
    v_pk_mul_f32 v[186:187], v[186:187], v[76:77] op_sel_hi:[1,0]
    v_mfma_f32_16x16x32_bf16 v[28:31], a[0:3], v[108:111], v[24:27]
    v_cvt_pk_bf16_f32 v156, v156, v157
    v_cvt_pk_bf16_f32 v157, v158, v159
    v_mfma_f32_16x16x32_bf16 v[28:31], a[4:7], v[112:115], v[28:31]
    ds_write_b64 v252, v[156:157] offset:0
    v_cvt_pk_bf16_f32 v160, v160, v161
    v_cvt_pk_bf16_f32 v161, v162, v163
    v_mfma_f32_16x16x32_bf16 v[28:31], a[8:11], v[116:119], v[28:31]
    v_cvt_pk_bf16_f32 v164, v164, v165
    v_cvt_pk_bf16_f32 v165, v166, v167
    v_mfma_f32_16x16x32_bf16 v[28:31], a[12:15], v[120:123], v[28:31]
    ds_write_b64 v252, v[160:161] offset:32
    v_cvt_pk_bf16_f32 v168, v168, v169
    v_cvt_pk_bf16_f32 v169, v170, v171
    v_mfma_f32_16x16x32_bf16 v[32:35], a[28:31], v[120:123], v[24:27]
    v_cvt_pk_bf16_f32 v172, v172, v173
    v_cvt_pk_bf16_f32 v173, v174, v175
    v_mfma_f32_16x16x32_bf16 v[32:35], a[24:27], v[116:119], v[32:35]
    ds_write_b64 v252, v[164:165] offset:64
    s_waitcnt lgkmcnt(4)
    buffer_store_dwordx4 a[136:139], v254, s[16:19], s50 offen offset:2048 sc1
    v_cvt_pk_bf16_f32 v176, v176, v177
    v_cvt_pk_bf16_f32 v177, v178, v179
    v_mfma_f32_16x16x32_bf16 v[32:35], a[20:23], v[112:115], v[32:35]
    v_cvt_pk_bf16_f32 v180, v180, v181
    v_cvt_pk_bf16_f32 v181, v182, v183
    v_mfma_f32_16x16x32_bf16 v[32:35], a[16:19], v[108:111], v[32:35]
    ds_write_b64 v252, v[168:169] offset:96
    v_cvt_pk_bf16_f32 v184, v184, v185
    v_cvt_pk_bf16_f32 v185, v186, v187
    v_mfma_f32_16x16x32_bf16 v[36:39], a[32:35], v[108:111], v[24:27]
    v_exp_f32 v28, v28
    v_mfma_f32_16x16x32_bf16 v[36:39], a[36:39], v[112:115], v[36:39]
    ds_write_b64 v252, v[172:173] offset:128
    v_exp_f32 v29, v29
    v_mfma_f32_16x16x32_bf16 v[36:39], a[40:43], v[116:119], v[36:39]
    v_exp_f32 v30, v30
    v_mfma_f32_16x16x32_bf16 v[36:39], a[44:47], v[120:123], v[36:39]
    ds_write_b64 v252, v[176:177] offset:160
    s_waitcnt lgkmcnt(6)
    buffer_store_dwordx4 a[140:143], v254, s[16:19], s50 offen offset:3072 sc1
    v_mfma_f32_16x16x32_bf16 v[40:43], a[60:63], v[120:123], v[24:27]
    v_exp_f32 v31, v31
    v_mfma_f32_16x16x32_bf16 v[40:43], a[56:59], v[116:119], v[40:43]
    ds_write_b64 v252, v[180:181] offset:192
    v_cvt_pk_bf16_f32 v52, v28, v29
    v_mfma_f32_16x16x32_bf16 v[40:43], a[52:55], v[112:115], v[40:43]
    v_exp_f32 v32, v32
    v_mfma_f32_16x16x32_bf16 v[40:43], a[48:51], v[108:111], v[40:43]
    ds_write_b64 v252, v[184:185] offset:224
    v_cvt_pk_bf16_f32 v53, v30, v31
    v_mfma_f32_16x16x32_bf16 a[204:207], a[192:195], v[44:47], a[204:207]
    v_exp_f32 v33, v33
    v_mfma_f32_16x16x32_bf16 a[204:207], a[192:195], v[48:51], a[204:207]
    ds_read_b128 a[144:147], v253 offset:0
    v_cvt_pk_bf16_f32 v54, v32, v33
    v_mfma_f32_16x16x32_bf16 v[188:191], a[68:71], v[48:51], v[188:191]
    v_exp_f32 v34, v34
    v_mfma_f32_16x16x32_bf16 v[188:191], a[64:67], v[44:47], v[188:191]
    ds_read_b128 a[148:151], v253 offset:1088
    v_exp_f32 v35, v35
    v_mfma_f32_16x16x32_bf16 v[192:195], a[72:75], v[44:47], v[192:195]
    s_add_u32 s50, s25, 4096
    v_exp_f32 v36, v36
    v_mfma_f32_16x16x32_bf16 v[192:195], a[76:79], v[48:51], v[192:195]
    ds_read_b128 a[152:155], v253 offset:2176
    v_cvt_pk_bf16_f32 v55, v34, v35
    v_mfma_f32_16x16x32_bf16 v[196:199], a[84:87], v[48:51], v[196:199]
    v_exp_f32 v37, v37
    v_mfma_f32_16x16x32_bf16 v[196:199], a[80:83], v[44:47], v[196:199]
    ds_read_b128 a[156:159], v253 offset:3264
    v_cvt_pk_bf16_f32 v56, v36, v37
    v_mfma_f32_16x16x32_bf16 v[200:203], a[88:91], v[44:47], v[200:203]
    ds_read_b128 a[0:3], v2 offset:32768
    v_exp_f32 v38, v38
    v_mfma_f32_16x16x32_bf16 v[200:203], a[92:95], v[48:51], v[200:203]
    ds_read_b128 a[4:7], v3 offset:32768
    v_exp_f32 v39, v39
    v_mfma_f32_16x16x32_bf16 v[204:207], a[100:103], v[48:51], v[204:207]
    ds_read_b128 a[8:11], v2 offset:40960
    v_cvt_pk_bf16_f32 v57, v38, v39
    v_mfma_f32_16x16x32_bf16 v[204:207], a[96:99], v[44:47], v[204:207]
    ds_read_b128 a[12:15], v3 offset:40960
    s_waitcnt lgkmcnt(7)
    buffer_store_dwordx4 a[144:147], v254, s[16:19], s50 offen sc1
    v_mfma_f32_16x16x32_bf16 v[208:211], a[104:107], v[44:47], v[208:211]
    ds_read_b128 a[28:31], v3 offset:43008
    v_exp_f32 v40, v40
    v_mfma_f32_16x16x32_bf16 v[208:211], a[108:111], v[48:51], v[208:211]
    ds_read_b128 a[24:27], v2 offset:43008
    v_exp_f32 v41, v41
    v_mfma_f32_16x16x32_bf16 v[212:215], a[116:119], v[48:51], v[212:215]
    ds_read_b128 a[20:23], v3 offset:34816
    v_cvt_pk_bf16_f32 v58, v40, v41
    v_mfma_f32_16x16x32_bf16 v[212:215], a[112:115], v[44:47], v[212:215]
    ds_read_b128 a[16:19], v2 offset:34816
    v_mfma_f32_16x16x32_bf16 v[216:219], a[120:123], v[44:47], v[216:219]
    ds_read_b128 a[32:35], v2 offset:36864
    v_mfma_f32_16x16x32_bf16 v[216:219], a[124:127], v[48:51], v[216:219]
    s_waitcnt lgkmcnt(8)
    ds_read_b128 a[36:39], v3 offset:36864
    buffer_store_dwordx4 a[148:151], v254, s[16:19], s50 offen offset:1024 sc1
    v_mfma_f32_16x16x32_bf16 v[28:31], a[0:3], v[92:95], v[20:23]
    s_waitcnt lgkmcnt(8)
    ds_read_b128 a[40:43], v2 offset:45056
    v_mfma_f32_16x16x32_bf16 v[28:31], a[4:7], v[96:99], v[28:31]
    s_waitcnt lgkmcnt(8)
    ds_read_b128 a[44:47], v3 offset:45056
    v_mfma_f32_16x16x32_bf16 v[28:31], a[8:11], v[100:103], v[28:31]
    s_waitcnt lgkmcnt(8)
    ds_read_b128 a[60:63], v3 offset:47104
    v_mfma_f32_16x16x32_bf16 v[28:31], a[12:15], v[104:107], v[28:31]
    s_waitcnt lgkmcnt(8)
    ds_read_b128 a[56:59], v2 offset:47104
    v_mfma_f32_16x16x32_bf16 v[32:35], a[28:31], v[104:107], v[20:23]
    s_waitcnt lgkmcnt(8)
    ds_read_b128 a[52:55], v3 offset:38912
    v_mfma_f32_16x16x32_bf16 v[32:35], a[24:27], v[100:103], v[32:35]
    s_waitcnt lgkmcnt(8)
    ds_read_b128 a[48:51], v2 offset:38912
    buffer_store_dwordx4 a[152:155], v254, s[16:19], s50 offen offset:2048 sc1
    v_mfma_f32_16x16x32_bf16 v[32:35], a[20:23], v[96:99], v[32:35]
    s_waitcnt lgkmcnt(8)
    v_exp_f32 v42, v42
    v_mfma_f32_16x16x32_bf16 v[32:35], a[16:19], v[92:95], v[32:35]
    s_waitcnt lgkmcnt(7)
    v_exp_f32 v43, v43
    v_mfma_f32_16x16x32_bf16 v[36:39], a[32:35], v[92:95], v[20:23]
    s_waitcnt lgkmcnt(6)
    v_exp_f32 v28, v28
    v_mfma_f32_16x16x32_bf16 v[36:39], a[36:39], v[96:99], v[36:39]
    s_waitcnt lgkmcnt(5)
    v_exp_f32 v29, v29
    v_mfma_f32_16x16x32_bf16 v[36:39], a[40:43], v[100:103], v[36:39]
    s_waitcnt lgkmcnt(4)
    v_cvt_pk_bf16_f32 v59, v42, v43
    v_cvt_pk_bf16_f32 v44, v28, v29
    v_mfma_f32_16x16x32_bf16 v[36:39], a[44:47], v[104:107], v[36:39]
    s_waitcnt lgkmcnt(3)
    buffer_store_dwordx4 a[156:159], v254, s[16:19], s50 offen offset:3072 sc1
    v_mfma_f32_16x16x32_bf16 v[40:43], a[60:63], v[104:107], v[20:23]
    s_waitcnt lgkmcnt(2)
    v_exp_f32 v30, v30
    v_mfma_f32_16x16x32_bf16 v[40:43], a[56:59], v[100:103], v[40:43]
    s_waitcnt lgkmcnt(1)
    v_exp_f32 v31, v31
    v_mfma_f32_16x16x32_bf16 v[40:43], a[52:55], v[96:99], v[40:43]
    s_waitcnt lgkmcnt(0)
    v_exp_f32 v32, v32
    v_mfma_f32_16x16x32_bf16 v[40:43], a[48:51], v[92:95], v[40:43]
    v_exp_f32 v33, v33
    v_mfma_f32_16x16x32_bf16 a[208:211], a[192:195], v[52:55], a[208:211]
    v_exp_f32 v34, v34
    v_mfma_f32_16x16x32_bf16 a[208:211], a[192:195], v[56:59], a[208:211]
    v_exp_f32 v35, v35
    v_mfma_f32_16x16x32_bf16 v[220:223], a[68:71], v[56:59], v[220:223]
    ds_read_b64_tr_b16 a[68:69], v4 offset:36864
    v_cvt_pk_bf16_f32 v45, v30, v31
    v_mfma_f32_16x16x32_bf16 v[220:223], a[64:67], v[52:55], v[220:223]
    ds_read_b64_tr_b16 a[70:71], v4 offset:38912
    v_cvt_pk_bf16_f32 v46, v32, v33
    v_mfma_f32_16x16x32_bf16 v[224:227], a[72:75], v[52:55], v[224:227]
    v_exp_f32 v36, v36
    v_mfma_f32_16x16x32_bf16 v[224:227], a[76:79], v[56:59], v[224:227]
    v_exp_f32 v37, v37
    v_mfma_f32_16x16x32_bf16 v[228:231], a[84:87], v[56:59], v[228:231]
    v_exp_f32 v38, v38
    v_mfma_f32_16x16x32_bf16 v[228:231], a[80:83], v[52:55], v[228:231]
    v_exp_f32 v39, v39
    v_mfma_f32_16x16x32_bf16 v[232:235], a[88:91], v[52:55], v[232:235]
    ds_read_b64_tr_b16 a[64:65], v4 offset:32768
    v_cvt_pk_bf16_f32 v47, v34, v35
    v_mfma_f32_16x16x32_bf16 v[232:235], a[92:95], v[56:59], v[232:235]
    ds_read_b64_tr_b16 a[66:67], v4 offset:34816
    v_cvt_pk_bf16_f32 v48, v36, v37
    v_mfma_f32_16x16x32_bf16 v[236:239], a[100:103], v[56:59], v[236:239]
    v_exp_f32 v40, v40
    v_mfma_f32_16x16x32_bf16 v[236:239], a[96:99], v[52:55], v[236:239]
    v_exp_f32 v41, v41
    v_mfma_f32_16x16x32_bf16 v[240:243], a[104:107], v[52:55], v[240:243]
    v_exp_f32 v42, v42
    v_mfma_f32_16x16x32_bf16 v[240:243], a[108:111], v[56:59], v[240:243]
    v_exp_f32 v43, v43
    v_mfma_f32_16x16x32_bf16 v[244:247], a[116:119], v[56:59], v[244:247]
    ds_read_b64_tr_b16 a[72:73], v5 offset:32768
    v_cvt_pk_bf16_f32 v49, v38, v39
    v_mfma_f32_16x16x32_bf16 v[244:247], a[112:115], v[52:55], v[244:247]
    ds_read_b64_tr_b16 a[74:75], v5 offset:34816
    v_cvt_pk_bf16_f32 v50, v40, v41
    v_mfma_f32_16x16x32_bf16 v[248:251], a[120:123], v[52:55], v[248:251]
    ds_read_b64_tr_b16 a[76:77], v5 offset:36864
    v_cvt_pk_bf16_f32 v51, v42, v43
    v_mfma_f32_16x16x32_bf16 v[248:251], a[124:127], v[56:59], v[248:251]
    ds_read_b64_tr_b16 a[78:79], v5 offset:38912
    v_mfma_f32_16x16x32_bf16 v[28:31], a[0:3], v[108:111], v[24:27]
    ds_read_b64_tr_b16 a[84:85], v6 offset:36864
    v_mfma_f32_16x16x32_bf16 v[28:31], a[4:7], v[112:115], v[28:31]
    ds_read_b64_tr_b16 a[86:87], v6 offset:38912
    v_mfma_f32_16x16x32_bf16 v[28:31], a[8:11], v[116:119], v[28:31]
    ds_read_b64_tr_b16 a[80:81], v6 offset:32768
    v_mfma_f32_16x16x32_bf16 v[28:31], a[12:15], v[120:123], v[28:31]
    ds_read_b64_tr_b16 a[82:83], v6 offset:34816
    v_mfma_f32_16x16x32_bf16 v[32:35], a[28:31], v[120:123], v[24:27]
    ds_read_b64_tr_b16 a[88:89], v7 offset:32768
    v_mfma_f32_16x16x32_bf16 v[32:35], a[24:27], v[116:119], v[32:35]
    ds_read_b64_tr_b16 a[90:91], v7 offset:34816
    v_mfma_f32_16x16x32_bf16 v[32:35], a[20:23], v[112:115], v[32:35]
    ds_read_b64_tr_b16 a[92:93], v7 offset:36864
    v_mfma_f32_16x16x32_bf16 v[32:35], a[16:19], v[108:111], v[32:35]
    ds_read_b64_tr_b16 a[94:95], v7 offset:38912
    v_mfma_f32_16x16x32_bf16 v[36:39], a[32:35], v[108:111], v[24:27]
    ds_read_b64_tr_b16 a[100:101], v4 offset:45056
    v_mfma_f32_16x16x32_bf16 v[36:39], a[36:39], v[112:115], v[36:39]
    ds_read_b64_tr_b16 a[102:103], v4 offset:47104
    v_mfma_f32_16x16x32_bf16 v[36:39], a[40:43], v[116:119], v[36:39]
    ds_read_b64_tr_b16 a[96:97], v4 offset:40960
    v_mfma_f32_16x16x32_bf16 v[36:39], a[44:47], v[120:123], v[36:39]
    ds_read_b64_tr_b16 a[98:99], v4 offset:43008
    v_mfma_f32_16x16x32_bf16 v[40:43], a[60:63], v[120:123], v[24:27]
    ds_read_b64_tr_b16 a[104:105], v5 offset:40960
    v_mfma_f32_16x16x32_bf16 v[40:43], a[56:59], v[116:119], v[40:43]
    ds_read_b64_tr_b16 a[106:107], v5 offset:43008
    v_exp_f32 v28, v28
    v_mfma_f32_16x16x32_bf16 v[40:43], a[52:55], v[112:115], v[40:43]
    ds_read_b64_tr_b16 a[108:109], v5 offset:45056
    v_exp_f32 v29, v29
    v_mfma_f32_16x16x32_bf16 v[40:43], a[48:51], v[108:111], v[40:43]
    ds_read_b64_tr_b16 a[110:111], v5 offset:47104
    v_cvt_pk_bf16_f32 v52, v28, v29
    v_mfma_f32_16x16x32_bf16 a[204:207], a[192:195], v[44:47], a[204:207]
    ds_read_b64_tr_b16 a[116:117], v6 offset:45056
    v_exp_f32 v30, v30
    v_mfma_f32_16x16x32_bf16 a[204:207], a[192:195], v[48:51], a[204:207]
    s_waitcnt lgkmcnt(9)
    ds_read_b64_tr_b16 a[118:119], v6 offset:47104
    v_exp_f32 v31, v31
    v_mfma_f32_16x16x32_bf16 v[188:191], a[68:71], v[48:51], v[188:191]
    ds_read_b64_tr_b16 a[112:113], v6 offset:40960
    v_cvt_pk_bf16_f32 v53, v30, v31
    v_mfma_f32_16x16x32_bf16 v[188:191], a[64:67], v[44:47], v[188:191]
    ds_read_b64_tr_b16 a[114:115], v6 offset:43008
    v_exp_f32 v32, v32
    v_mfma_f32_16x16x32_bf16 v[192:195], a[72:75], v[44:47], v[192:195]
    ds_read_b64_tr_b16 a[120:121], v7 offset:40960
    v_exp_f32 v33, v33
    v_mfma_f32_16x16x32_bf16 v[192:195], a[76:79], v[48:51], v[192:195]
    ds_read_b64_tr_b16 a[122:123], v7 offset:43008
    v_cvt_pk_bf16_f32 v54, v32, v33
    v_mfma_f32_16x16x32_bf16 v[196:199], a[84:87], v[48:51], v[196:199]
    ds_read_b64_tr_b16 a[124:125], v7 offset:45056
    v_exp_f32 v34, v34
    v_mfma_f32_16x16x32_bf16 v[196:199], a[80:83], v[44:47], v[196:199]
    ds_read_b64_tr_b16 a[126:127], v7 offset:47104
    v_exp_f32 v35, v35
    v_mfma_f32_16x16x32_bf16 v[200:203], a[88:91], v[44:47], v[200:203]
    v_exp_f32 v36, v36
    v_mfma_f32_16x16x32_bf16 v[200:203], a[92:95], v[48:51], v[200:203]
    s_waitcnt lgkmcnt(8)
    v_exp_f32 v37, v37
    v_mfma_f32_16x16x32_bf16 v[204:207], a[100:103], v[48:51], v[204:207]
    v_exp_f32 v38, v38
    v_mfma_f32_16x16x32_bf16 v[204:207], a[96:99], v[44:47], v[204:207]
    v_cvt_pk_bf16_f32 v55, v34, v35
    v_cvt_pk_bf16_f32 v56, v36, v37
    v_mfma_f32_16x16x32_bf16 v[208:211], a[104:107], v[44:47], v[208:211]
    v_exp_f32 v39, v39
    v_mfma_f32_16x16x32_bf16 v[208:211], a[108:111], v[48:51], v[208:211]
    s_waitcnt lgkmcnt(4)
    v_exp_f32 v40, v40
    v_mfma_f32_16x16x32_bf16 v[212:215], a[116:119], v[48:51], v[212:215]
    v_exp_f32 v41, v41
    v_mfma_f32_16x16x32_bf16 v[212:215], a[112:115], v[44:47], v[212:215]
    s_waitcnt lgkmcnt(2)
    v_exp_f32 v42, v42
    v_mfma_f32_16x16x32_bf16 v[216:219], a[120:123], v[44:47], v[216:219]
    s_waitcnt lgkmcnt(0)
    v_exp_f32 v43, v43
    v_mfma_f32_16x16x32_bf16 v[216:219], a[124:127], v[48:51], v[216:219]
    v_cvt_pk_bf16_f32 v57, v38, v39
    v_cvt_pk_bf16_f32 v58, v40, v41
    v_cvt_pk_bf16_f32 v59, v42, v43
    v_accvgpr_read_b32 v10, a204
    v_rcp_f32 v92, v10
    v_cmp_nlt_f32 s[44:45], v10, s30
    v_pk_mul_f32 v[188:189], v[188:189], v[92:93] op_sel_hi:[1,0]
    v_pk_mul_f32 v[190:191], v[190:191], v[92:93] op_sel_hi:[1,0]
    v_pk_mul_f32 v[192:193], v[192:193], v[92:93] op_sel_hi:[1,0]
    v_pk_mul_f32 v[194:195], v[194:195], v[92:93] op_sel_hi:[1,0]
    v_pk_mul_f32 v[196:197], v[196:197], v[92:93] op_sel_hi:[1,0]
    v_pk_mul_f32 v[198:199], v[198:199], v[92:93] op_sel_hi:[1,0]
    v_pk_mul_f32 v[200:201], v[200:201], v[92:93] op_sel_hi:[1,0]
    v_pk_mul_f32 v[202:203], v[202:203], v[92:93] op_sel_hi:[1,0]
    v_pk_mul_f32 v[204:205], v[204:205], v[92:93] op_sel_hi:[1,0]
    v_pk_mul_f32 v[206:207], v[206:207], v[92:93] op_sel_hi:[1,0]
    v_pk_mul_f32 v[208:209], v[208:209], v[92:93] op_sel_hi:[1,0]
    v_pk_mul_f32 v[210:211], v[210:211], v[92:93] op_sel_hi:[1,0]
    v_pk_mul_f32 v[212:213], v[212:213], v[92:93] op_sel_hi:[1,0]
    v_pk_mul_f32 v[214:215], v[214:215], v[92:93] op_sel_hi:[1,0]
    v_pk_mul_f32 v[216:217], v[216:217], v[92:93] op_sel_hi:[1,0]
    v_pk_mul_f32 v[218:219], v[218:219], v[92:93] op_sel_hi:[1,0]
    v_mfma_f32_16x16x32_bf16 a[208:211], a[192:195], v[52:55], a[208:211]
    v_cvt_pk_bf16_f32 v188, v188, v189
    v_cvt_pk_bf16_f32 v189, v190, v191
    v_mfma_f32_16x16x32_bf16 a[208:211], a[192:195], v[56:59], a[208:211]
    ds_write_b64 v252, v[188:189] offset:0
    v_cvt_pk_bf16_f32 v192, v192, v193
    v_cvt_pk_bf16_f32 v193, v194, v195
    v_mfma_f32_16x16x32_bf16 v[220:223], a[68:71], v[56:59], v[220:223]
    ds_write_b64 v252, v[192:193] offset:32
    v_cvt_pk_bf16_f32 v196, v196, v197
    v_cvt_pk_bf16_f32 v197, v198, v199
    v_mfma_f32_16x16x32_bf16 v[220:223], a[64:67], v[52:55], v[220:223]
    ds_write_b64 v252, v[196:197] offset:64
    v_cvt_pk_bf16_f32 v200, v200, v201
    v_cvt_pk_bf16_f32 v201, v202, v203
    v_mfma_f32_16x16x32_bf16 v[224:227], a[72:75], v[52:55], v[224:227]
    ds_write_b64 v252, v[200:201] offset:96
    v_cvt_pk_bf16_f32 v204, v204, v205
    v_cvt_pk_bf16_f32 v205, v206, v207
    v_mfma_f32_16x16x32_bf16 v[224:227], a[76:79], v[56:59], v[224:227]
    ds_write_b64 v252, v[204:205] offset:128
    v_cvt_pk_bf16_f32 v208, v208, v209
    v_cvt_pk_bf16_f32 v209, v210, v211
    v_mfma_f32_16x16x32_bf16 v[228:231], a[84:87], v[56:59], v[228:231]
    s_add_u32 s49, s25, 8192
    ds_write_b64 v252, v[208:209] offset:160
    v_cvt_pk_bf16_f32 v212, v212, v213
    v_cvt_pk_bf16_f32 v213, v214, v215
    v_mfma_f32_16x16x32_bf16 v[228:231], a[80:83], v[52:55], v[228:231]
    ds_write_b64 v252, v[212:213] offset:192
    v_cvt_pk_bf16_f32 v216, v216, v217
    v_cvt_pk_bf16_f32 v217, v218, v219
    v_mfma_f32_16x16x32_bf16 v[232:235], a[88:91], v[52:55], v[232:235]
    ds_write_b64 v252, v[216:217] offset:224
    v_mfma_f32_16x16x32_bf16 v[232:235], a[92:95], v[56:59], v[232:235]
    ds_read_b128 a[160:163], v253 offset:0
    ds_read_b128 a[164:167], v253 offset:1088
    v_mfma_f32_16x16x32_bf16 v[236:239], a[100:103], v[56:59], v[236:239]
    ds_read_b128 a[168:171], v253 offset:2176
    ds_read_b128 a[172:175], v253 offset:3264
    v_mfma_f32_16x16x32_bf16 v[236:239], a[96:99], v[52:55], v[236:239]
    v_accvgpr_read_b32 v11, a208
    v_mfma_f32_16x16x32_bf16 v[240:243], a[104:107], v[52:55], v[240:243]
    v_rcp_f32 v108, v11
    v_mfma_f32_16x16x32_bf16 v[240:243], a[108:111], v[56:59], v[240:243]
    v_mfma_f32_16x16x32_bf16 v[244:247], a[116:119], v[56:59], v[244:247]
    s_waitcnt lgkmcnt(3)
    buffer_store_dwordx4 a[160:163], v254, s[16:19], s49 offen sc1
    v_cmp_nlt_f32 s[46:47], v11, s30
    v_mfma_f32_16x16x32_bf16 v[244:247], a[112:115], v[52:55], v[244:247]
    s_waitcnt lgkmcnt(2)
    buffer_store_dwordx4 a[164:167], v254, s[16:19], s49 offen offset:1024 sc1
    v_mfma_f32_16x16x32_bf16 v[248:251], a[120:123], v[52:55], v[248:251]
    s_waitcnt lgkmcnt(1)
    buffer_store_dwordx4 a[168:171], v254, s[16:19], s49 offen offset:2048 sc1
    v_mfma_f32_16x16x32_bf16 v[248:251], a[124:127], v[56:59], v[248:251]
    s_waitcnt lgkmcnt(0)
    buffer_store_dwordx4 a[172:175], v254, s[16:19], s49 offen offset:3072 sc1
    v_pk_mul_f32 v[220:221], v[220:221], v[108:109] op_sel_hi:[1,0]
    v_pk_mul_f32 v[222:223], v[222:223], v[108:109] op_sel_hi:[1,0]
    v_pk_mul_f32 v[224:225], v[224:225], v[108:109] op_sel_hi:[1,0]
    v_pk_mul_f32 v[226:227], v[226:227], v[108:109] op_sel_hi:[1,0]
    v_pk_mul_f32 v[228:229], v[228:229], v[108:109] op_sel_hi:[1,0]
    v_pk_mul_f32 v[230:231], v[230:231], v[108:109] op_sel_hi:[1,0]
    v_pk_mul_f32 v[232:233], v[232:233], v[108:109] op_sel_hi:[1,0]
    v_pk_mul_f32 v[234:235], v[234:235], v[108:109] op_sel_hi:[1,0]
    v_pk_mul_f32 v[236:237], v[236:237], v[108:109] op_sel_hi:[1,0]
    v_pk_mul_f32 v[238:239], v[238:239], v[108:109] op_sel_hi:[1,0]
    v_pk_mul_f32 v[240:241], v[240:241], v[108:109] op_sel_hi:[1,0]
    v_pk_mul_f32 v[242:243], v[242:243], v[108:109] op_sel_hi:[1,0]
    v_pk_mul_f32 v[244:245], v[244:245], v[108:109] op_sel_hi:[1,0]
    v_pk_mul_f32 v[246:247], v[246:247], v[108:109] op_sel_hi:[1,0]
    v_pk_mul_f32 v[248:249], v[248:249], v[108:109] op_sel_hi:[1,0]
    v_pk_mul_f32 v[250:251], v[250:251], v[108:109] op_sel_hi:[1,0]
    v_cvt_pk_bf16_f32 v220, v220, v221
    v_cvt_pk_bf16_f32 v221, v222, v223
    v_cvt_pk_bf16_f32 v224, v224, v225
    v_cvt_pk_bf16_f32 v225, v226, v227
    v_cvt_pk_bf16_f32 v228, v228, v229
    v_cvt_pk_bf16_f32 v229, v230, v231
    v_cvt_pk_bf16_f32 v232, v232, v233
    v_cvt_pk_bf16_f32 v233, v234, v235
    v_cvt_pk_bf16_f32 v236, v236, v237
    v_cvt_pk_bf16_f32 v237, v238, v239
    v_cvt_pk_bf16_f32 v240, v240, v241
    v_cvt_pk_bf16_f32 v241, v242, v243
    v_cvt_pk_bf16_f32 v244, v244, v245
    v_cvt_pk_bf16_f32 v245, v246, v247
    v_cvt_pk_bf16_f32 v248, v248, v249
    v_cvt_pk_bf16_f32 v249, v250, v251
    ds_write_b64 v252, v[220:221] offset:0
    ds_write_b64 v252, v[224:225] offset:32
    ds_write_b64 v252, v[228:229] offset:64
    ds_write_b64 v252, v[232:233] offset:96
    ds_write_b64 v252, v[236:237] offset:128
    ds_write_b64 v252, v[240:241] offset:160
    ds_write_b64 v252, v[244:245] offset:192
    ds_write_b64 v252, v[248:249] offset:224
    ds_read_b128 a[176:179], v253 offset:0
    ds_read_b128 a[180:183], v253 offset:1088
    ds_read_b128 a[184:187], v253 offset:2176
    ds_read_b128 a[188:191], v253 offset:3264
    s_add_u32 s51, s25, 12288
    s_or_b64 s[54:55], s[32:33], s[32:33]
    s_or_b64 s[54:55], s[34:35], s[54:55]
    s_or_b64 s[54:55], s[36:37], s[54:55]
    s_or_b64 s[54:55], s[38:39], s[54:55]
    s_or_b64 s[54:55], s[40:41], s[54:55]
    s_or_b64 s[54:55], s[42:43], s[54:55]
    s_or_b64 s[54:55], s[44:45], s[54:55]
    s_or_b64 s[54:55], s[46:47], s[54:55]
    s_waitcnt lgkmcnt(3)
    buffer_store_dwordx4 a[176:179], v254, s[16:19], s51 offen sc1
    s_waitcnt lgkmcnt(2)
    buffer_store_dwordx4 a[180:183], v254, s[16:19], s51 offen offset:1024 sc1
    s_waitcnt lgkmcnt(1)
    buffer_store_dwordx4 a[184:187], v254, s[16:19], s51 offen offset:2048 sc1
    s_waitcnt lgkmcnt(0)
    buffer_store_dwordx4 a[188:191], v254, s[16:19], s51 offen offset:3072 sc1
    s_cmp_lg_u64 s[54:55], 0
    s_cbranch_scc1 L_fb
    s_endpgm
L_fb:
    s_waitcnt vmcnt(0)
    s_mov_b32 s52, 0
    s_cmp_lg_u64 s[32:33], 0
    s_cselect_b32 s53, 1, 0
    s_or_b32 s52, s52, s53
    s_cmp_lg_u64 s[34:35], 0
    s_cselect_b32 s53, 2, 0
    s_or_b32 s52, s52, s53
    s_cmp_lg_u64 s[36:37], 0
    s_cselect_b32 s53, 4, 0
    s_or_b32 s52, s52, s53
    s_cmp_lg_u64 s[38:39], 0
    s_cselect_b32 s53, 8, 0
    s_or_b32 s52, s52, s53
    s_cmp_lg_u64 s[40:41], 0
    s_cselect_b32 s53, 16, 0
    s_or_b32 s52, s52, s53
    s_cmp_lg_u64 s[42:43], 0
    s_cselect_b32 s53, 32, 0
    s_or_b32 s52, s52, s53
    s_cmp_lg_u64 s[44:45], 0
    s_cselect_b32 s53, 64, 0
    s_or_b32 s52, s52, s53
    s_cmp_lg_u64 s[46:47], 0
    s_cselect_b32 s53, 128, 0
    s_or_b32 s52, s52, s53
    v_mbcnt_lo_u32_b32 v3, -1, 0
    v_mbcnt_hi_u32_b32 v3, -1, v3
    v_lshrrev_b32 v4, 4, v3
    v_and_b32 v3, 15, v3
    v_lshlrev_b32 v3, 1, v3
    v_lshl_or_b32 v2, v4, 10, v3
L_fb_next:
    s_ff1_i32_b32 s53, s52
    s_bitset0_b32 s52, s53
    s_cmp_ge_u32 s53, 4
    s_cselect_b32 s54, s25, s24
    s_cselect_b32 s55, s23, s22
    s_and_b32 s53, s53, 3
    s_lshl_b32 s53, s53, 12
    s_add_u32 s54, s54, s53
    buffer_load_dwordx4 v[124:127], v1, s[4:7], s54 offen offset:0
    buffer_load_dwordx4 v[128:131], v1, s[4:7], s54 offen offset:64
    buffer_load_dwordx4 v[132:135], v1, s[4:7], s54 offen offset:128
    buffer_load_dwordx4 v[136:139], v1, s[4:7], s54 offen offset:192
    s_waitcnt vmcnt(0)
    v_lshlrev_b32 v140, 16, v124
    v_lshlrev_b32 v142, 16, v125
    v_lshlrev_b32 v144, 16, v126
    v_lshlrev_b32 v146, 16, v127
    v_and_b32 v141, s31, v124
    v_and_b32 v143, s31, v125
    v_and_b32 v145, s31, v126
    v_and_b32 v147, s31, v127
    v_pk_mul_f32 v[140:141], v[140:141], s[28:29]
    v_pk_mul_f32 v[142:143], v[142:143], s[28:29]
    v_pk_mul_f32 v[144:145], v[144:145], s[28:29]
    v_pk_mul_f32 v[146:147], v[146:147], s[28:29]
    v_cvt_pk_bf16_f32 v60, v140, v141
    v_cvt_pk_bf16_f32 v61, v142, v143
    v_cvt_pk_bf16_f32 v62, v144, v145
    v_cvt_pk_bf16_f32 v63, v146, v147
    v_lshlrev_b32 v140, 16, v128
    v_lshlrev_b32 v142, 16, v129
    v_lshlrev_b32 v144, 16, v130
    v_lshlrev_b32 v146, 16, v131
    v_and_b32 v141, s31, v128
    v_and_b32 v143, s31, v129
    v_and_b32 v145, s31, v130
    v_and_b32 v147, s31, v131
    v_pk_mul_f32 v[140:141], v[140:141], s[28:29]
    v_pk_mul_f32 v[142:143], v[142:143], s[28:29]
    v_pk_mul_f32 v[144:145], v[144:145], s[28:29]
    v_pk_mul_f32 v[146:147], v[146:147], s[28:29]
    v_cvt_pk_bf16_f32 v64, v140, v141
    v_cvt_pk_bf16_f32 v65, v142, v143
    v_cvt_pk_bf16_f32 v66, v144, v145
    v_cvt_pk_bf16_f32 v67, v146, v147
    v_lshlrev_b32 v140, 16, v132
    v_lshlrev_b32 v142, 16, v133
    v_lshlrev_b32 v144, 16, v134
    v_lshlrev_b32 v146, 16, v135
    v_and_b32 v141, s31, v132
    v_and_b32 v143, s31, v133
    v_and_b32 v145, s31, v134
    v_and_b32 v147, s31, v135
    v_pk_mul_f32 v[140:141], v[140:141], s[28:29]
    v_pk_mul_f32 v[142:143], v[142:143], s[28:29]
    v_pk_mul_f32 v[144:145], v[144:145], s[28:29]
    v_pk_mul_f32 v[146:147], v[146:147], s[28:29]
    v_cvt_pk_bf16_f32 v68, v140, v141
    v_cvt_pk_bf16_f32 v69, v142, v143
    v_cvt_pk_bf16_f32 v70, v144, v145
    v_cvt_pk_bf16_f32 v71, v146, v147
    v_lshlrev_b32 v140, 16, v136
    v_lshlrev_b32 v142, 16, v137
    v_lshlrev_b32 v144, 16, v138
    v_lshlrev_b32 v146, 16, v139
    v_and_b32 v141, s31, v136
    v_and_b32 v143, s31, v137
    v_and_b32 v145, s31, v138
    v_and_b32 v147, s31, v139
    v_pk_mul_f32 v[140:141], v[140:141], s[28:29]
    v_pk_mul_f32 v[142:143], v[142:143], s[28:29]
    v_pk_mul_f32 v[144:145], v[144:145], s[28:29]
    v_pk_mul_f32 v[146:147], v[146:147], s[28:29]
    v_cvt_pk_bf16_f32 v72, v140, v141
    v_cvt_pk_bf16_f32 v73, v142, v143
    v_cvt_pk_bf16_f32 v74, v144, v145
    v_cvt_pk_bf16_f32 v75, v146, v147
    v_mov_b32 v8, 0xff800000
    s_mov_b32 s48, s55
    s_mov_b32 s49, 0
L_fb_max:
    buffer_load_dwordx4 v[76:79], v1, s[8:11], s48 offen offset:0
    buffer_load_dwordx4 v[80:83], v1, s[8:11], s48 offen offset:64
    buffer_load_dwordx4 v[84:87], v1, s[8:11], s48 offen offset:128
    buffer_load_dwordx4 v[88:91], v1, s[8:11], s48 offen offset:192
    s_waitcnt vmcnt(0)
    v_mfma_f32_16x16x32_bf16 v[28:31], v[76:79], v[60:63], 0
    v_mfma_f32_16x16x32_bf16 v[28:31], v[80:83], v[64:67], v[28:31]
    v_mfma_f32_16x16x32_bf16 v[28:31], v[84:87], v[68:71], v[28:31]
    v_mfma_f32_16x16x32_bf16 v[28:31], v[88:91], v[72:75], v[28:31]
    s_nop 7
    v_max3_f32 v8, v8, v28, v29
    v_max3_f32 v8, v8, v30, v31
    s_add_u32 s48, s48, 4096
    s_add_u32 s49, s49, 1
    s_cmp_lt_u32 s49, 32
    s_cbranch_scc1 L_fb_max
    v_mov_b32 v9, v8
    s_nop 1
    v_permlane32_swap_b32 v9, v8
    v_max_f32 v8, v9, v8
    v_mov_b32 v9, v8
    s_nop 1
    v_permlane16_swap_b32 v9, v8
    v_max_f32 v8, v9, v8
    v_sub_f32 v12, 0, v8
    v_sub_f32 v13, 0, v8
    v_sub_f32 v14, 0, v8
    v_sub_f32 v15, 0, v8
    v_mov_b32 v10, 0
    v_mov_b32 v124, 0
    v_mov_b32 v125, 0
    v_mov_b32 v126, 0
    v_mov_b32 v127, 0
    v_mov_b32 v128, 0
    v_mov_b32 v129, 0
    v_mov_b32 v130, 0
    v_mov_b32 v131, 0
    v_mov_b32 v132, 0
    v_mov_b32 v133, 0
    v_mov_b32 v134, 0
    v_mov_b32 v135, 0
    v_mov_b32 v136, 0
    v_mov_b32 v137, 0
    v_mov_b32 v138, 0
    v_mov_b32 v139, 0
    v_mov_b32 v140, 0
    v_mov_b32 v141, 0
    v_mov_b32 v142, 0
    v_mov_b32 v143, 0
    v_mov_b32 v144, 0
    v_mov_b32 v145, 0
    v_mov_b32 v146, 0
    v_mov_b32 v147, 0
    v_mov_b32 v148, 0
    v_mov_b32 v149, 0
    v_mov_b32 v150, 0
    v_mov_b32 v151, 0
    v_mov_b32 v152, 0
    v_mov_b32 v153, 0
    v_mov_b32 v154, 0
    v_mov_b32 v155, 0
    s_mov_b32 s48, s55
    s_mov_b32 s49, 0
L_fb_pv:
    s_add_u32 s50, s48, 0
    buffer_load_dwordx4 v[76:79], v1, s[8:11], s50 offen offset:0
    buffer_load_dwordx4 v[80:83], v1, s[8:11], s50 offen offset:64
    buffer_load_dwordx4 v[84:87], v1, s[8:11], s50 offen offset:128
    buffer_load_dwordx4 v[88:91], v1, s[8:11], s50 offen offset:192
    s_waitcnt vmcnt(0)
    v_mfma_f32_16x16x32_bf16 v[28:31], v[76:79], v[60:63], v[12:15]
    v_mfma_f32_16x16x32_bf16 v[28:31], v[80:83], v[64:67], v[28:31]
    v_mfma_f32_16x16x32_bf16 v[28:31], v[84:87], v[68:71], v[28:31]
    v_mfma_f32_16x16x32_bf16 v[28:31], v[88:91], v[72:75], v[28:31]
    s_nop 7
    v_exp_f32 v28, v28
    v_exp_f32 v29, v29
    v_exp_f32 v30, v30
    v_exp_f32 v31, v31
    s_nop 0
    v_add_f32 v10, v28, v10
    v_add_f32 v10, v29, v10
    v_add_f32 v10, v30, v10
    v_add_f32 v10, v31, v10
    v_cvt_pk_bf16_f32 v44, v28, v29
    v_cvt_pk_bf16_f32 v45, v30, v31
    s_add_u32 s50, s48, 4096
    buffer_load_dwordx4 v[76:79], v1, s[8:11], s50 offen offset:0
    buffer_load_dwordx4 v[80:83], v1, s[8:11], s50 offen offset:64
    buffer_load_dwordx4 v[84:87], v1, s[8:11], s50 offen offset:128
    buffer_load_dwordx4 v[88:91], v1, s[8:11], s50 offen offset:192
    s_waitcnt vmcnt(0)
    v_mfma_f32_16x16x32_bf16 v[28:31], v[76:79], v[60:63], v[12:15]
    v_mfma_f32_16x16x32_bf16 v[28:31], v[80:83], v[64:67], v[28:31]
    v_mfma_f32_16x16x32_bf16 v[28:31], v[84:87], v[68:71], v[28:31]
    v_mfma_f32_16x16x32_bf16 v[28:31], v[88:91], v[72:75], v[28:31]
    s_nop 7
    v_exp_f32 v28, v28
    v_exp_f32 v29, v29
    v_exp_f32 v30, v30
    v_exp_f32 v31, v31
    s_nop 0
    v_add_f32 v10, v28, v10
    v_add_f32 v10, v29, v10
    v_add_f32 v10, v30, v10
    v_add_f32 v10, v31, v10
    v_cvt_pk_bf16_f32 v46, v28, v29
    v_cvt_pk_bf16_f32 v47, v30, v31
    s_add_u32 s50, s48, 4096
    buffer_load_ushort v96, v2, s[12:15], s48 offen offset:0
    buffer_load_ushort v97, v2, s[12:15], s48 offen offset:256
    buffer_load_ushort v98, v2, s[12:15], s48 offen offset:512
    buffer_load_ushort v99, v2, s[12:15], s48 offen offset:768
    buffer_load_ushort v100, v2, s[12:15], s50 offen offset:0
    buffer_load_ushort v101, v2, s[12:15], s50 offen offset:256
    buffer_load_ushort v102, v2, s[12:15], s50 offen offset:512
    buffer_load_ushort v103, v2, s[12:15], s50 offen offset:768
    s_waitcnt vmcnt(0)
    v_lshl_or_b32 v92, v97, 16, v96
    v_lshl_or_b32 v93, v99, 16, v98
    v_lshl_or_b32 v94, v101, 16, v100
    v_lshl_or_b32 v95, v103, 16, v102
    s_nop 1
    v_mfma_f32_16x16x32_bf16 v[124:127], v[92:95], v[44:47], v[124:127]
    s_nop 7
    buffer_load_ushort v96, v2, s[12:15], s48 offen offset:32
    buffer_load_ushort v97, v2, s[12:15], s48 offen offset:288
    buffer_load_ushort v98, v2, s[12:15], s48 offen offset:544
    buffer_load_ushort v99, v2, s[12:15], s48 offen offset:800
    buffer_load_ushort v100, v2, s[12:15], s50 offen offset:32
    buffer_load_ushort v101, v2, s[12:15], s50 offen offset:288
    buffer_load_ushort v102, v2, s[12:15], s50 offen offset:544
    buffer_load_ushort v103, v2, s[12:15], s50 offen offset:800
    s_waitcnt vmcnt(0)
    v_lshl_or_b32 v92, v97, 16, v96
    v_lshl_or_b32 v93, v99, 16, v98
    v_lshl_or_b32 v94, v101, 16, v100
    v_lshl_or_b32 v95, v103, 16, v102
    s_nop 1
    v_mfma_f32_16x16x32_bf16 v[128:131], v[92:95], v[44:47], v[128:131]
    s_nop 7
    buffer_load_ushort v96, v2, s[12:15], s48 offen offset:64
    buffer_load_ushort v97, v2, s[12:15], s48 offen offset:320
    buffer_load_ushort v98, v2, s[12:15], s48 offen offset:576
    buffer_load_ushort v99, v2, s[12:15], s48 offen offset:832
    buffer_load_ushort v100, v2, s[12:15], s50 offen offset:64
    buffer_load_ushort v101, v2, s[12:15], s50 offen offset:320
    buffer_load_ushort v102, v2, s[12:15], s50 offen offset:576
    buffer_load_ushort v103, v2, s[12:15], s50 offen offset:832
    s_waitcnt vmcnt(0)
    v_lshl_or_b32 v92, v97, 16, v96
    v_lshl_or_b32 v93, v99, 16, v98
    v_lshl_or_b32 v94, v101, 16, v100
    v_lshl_or_b32 v95, v103, 16, v102
    s_nop 1
    v_mfma_f32_16x16x32_bf16 v[132:135], v[92:95], v[44:47], v[132:135]
    s_nop 7
    buffer_load_ushort v96, v2, s[12:15], s48 offen offset:96
    buffer_load_ushort v97, v2, s[12:15], s48 offen offset:352
    buffer_load_ushort v98, v2, s[12:15], s48 offen offset:608
    buffer_load_ushort v99, v2, s[12:15], s48 offen offset:864
    buffer_load_ushort v100, v2, s[12:15], s50 offen offset:96
    buffer_load_ushort v101, v2, s[12:15], s50 offen offset:352
    buffer_load_ushort v102, v2, s[12:15], s50 offen offset:608
    buffer_load_ushort v103, v2, s[12:15], s50 offen offset:864
    s_waitcnt vmcnt(0)
    v_lshl_or_b32 v92, v97, 16, v96
    v_lshl_or_b32 v93, v99, 16, v98
    v_lshl_or_b32 v94, v101, 16, v100
    v_lshl_or_b32 v95, v103, 16, v102
    s_nop 1
    v_mfma_f32_16x16x32_bf16 v[136:139], v[92:95], v[44:47], v[136:139]
    s_nop 7
    buffer_load_ushort v96, v2, s[12:15], s48 offen offset:128
    buffer_load_ushort v97, v2, s[12:15], s48 offen offset:384
    buffer_load_ushort v98, v2, s[12:15], s48 offen offset:640
    buffer_load_ushort v99, v2, s[12:15], s48 offen offset:896
    buffer_load_ushort v100, v2, s[12:15], s50 offen offset:128
    buffer_load_ushort v101, v2, s[12:15], s50 offen offset:384
    buffer_load_ushort v102, v2, s[12:15], s50 offen offset:640
    buffer_load_ushort v103, v2, s[12:15], s50 offen offset:896
    s_waitcnt vmcnt(0)
    v_lshl_or_b32 v92, v97, 16, v96
    v_lshl_or_b32 v93, v99, 16, v98
    v_lshl_or_b32 v94, v101, 16, v100
    v_lshl_or_b32 v95, v103, 16, v102
    s_nop 1
    v_mfma_f32_16x16x32_bf16 v[140:143], v[92:95], v[44:47], v[140:143]
    s_nop 7
    buffer_load_ushort v96, v2, s[12:15], s48 offen offset:160
    buffer_load_ushort v97, v2, s[12:15], s48 offen offset:416
    buffer_load_ushort v98, v2, s[12:15], s48 offen offset:672
    buffer_load_ushort v99, v2, s[12:15], s48 offen offset:928
    buffer_load_ushort v100, v2, s[12:15], s50 offen offset:160
    buffer_load_ushort v101, v2, s[12:15], s50 offen offset:416
    buffer_load_ushort v102, v2, s[12:15], s50 offen offset:672
    buffer_load_ushort v103, v2, s[12:15], s50 offen offset:928
    s_waitcnt vmcnt(0)
    v_lshl_or_b32 v92, v97, 16, v96
    v_lshl_or_b32 v93, v99, 16, v98
    v_lshl_or_b32 v94, v101, 16, v100
    v_lshl_or_b32 v95, v103, 16, v102
    s_nop 1
    v_mfma_f32_16x16x32_bf16 v[144:147], v[92:95], v[44:47], v[144:147]
    s_nop 7
    buffer_load_ushort v96, v2, s[12:15], s48 offen offset:192
    buffer_load_ushort v97, v2, s[12:15], s48 offen offset:448
    buffer_load_ushort v98, v2, s[12:15], s48 offen offset:704
    buffer_load_ushort v99, v2, s[12:15], s48 offen offset:960
    buffer_load_ushort v100, v2, s[12:15], s50 offen offset:192
    buffer_load_ushort v101, v2, s[12:15], s50 offen offset:448
    buffer_load_ushort v102, v2, s[12:15], s50 offen offset:704
    buffer_load_ushort v103, v2, s[12:15], s50 offen offset:960
    s_waitcnt vmcnt(0)
    v_lshl_or_b32 v92, v97, 16, v96
    v_lshl_or_b32 v93, v99, 16, v98
    v_lshl_or_b32 v94, v101, 16, v100
    v_lshl_or_b32 v95, v103, 16, v102
    s_nop 1
    v_mfma_f32_16x16x32_bf16 v[148:151], v[92:95], v[44:47], v[148:151]
    s_nop 7
    buffer_load_ushort v96, v2, s[12:15], s48 offen offset:224
    buffer_load_ushort v97, v2, s[12:15], s48 offen offset:480
    buffer_load_ushort v98, v2, s[12:15], s48 offen offset:736
    buffer_load_ushort v99, v2, s[12:15], s48 offen offset:992
    buffer_load_ushort v100, v2, s[12:15], s50 offen offset:224
    buffer_load_ushort v101, v2, s[12:15], s50 offen offset:480
    buffer_load_ushort v102, v2, s[12:15], s50 offen offset:736
    buffer_load_ushort v103, v2, s[12:15], s50 offen offset:992
    s_waitcnt vmcnt(0)
    v_lshl_or_b32 v92, v97, 16, v96
    v_lshl_or_b32 v93, v99, 16, v98
    v_lshl_or_b32 v94, v101, 16, v100
    v_lshl_or_b32 v95, v103, 16, v102
    s_nop 1
    v_mfma_f32_16x16x32_bf16 v[152:155], v[92:95], v[44:47], v[152:155]
    s_nop 7
    s_add_u32 s48, s48, 8192
    s_add_u32 s49, s49, 1
    s_cmp_lt_u32 s49, 16
    s_cbranch_scc1 L_fb_pv
    v_mov_b32 v61, v10
    s_nop 1
    v_permlane32_swap_b32 v61, v10
    v_add_f32 v10, v61, v10
    v_mov_b32 v61, v10
    s_nop 1
    v_permlane16_swap_b32 v61, v10
    v_add_f32 v10, v61, v10
    v_rcp_f32 v60, v10
    s_nop 0
    v_pk_mul_f32 v[124:125], v[124:125], v[60:61] op_sel_hi:[1,0]
    v_pk_mul_f32 v[126:127], v[126:127], v[60:61] op_sel_hi:[1,0]
    v_pk_mul_f32 v[128:129], v[128:129], v[60:61] op_sel_hi:[1,0]
    v_pk_mul_f32 v[130:131], v[130:131], v[60:61] op_sel_hi:[1,0]
    v_pk_mul_f32 v[132:133], v[132:133], v[60:61] op_sel_hi:[1,0]
    v_pk_mul_f32 v[134:135], v[134:135], v[60:61] op_sel_hi:[1,0]
    v_pk_mul_f32 v[136:137], v[136:137], v[60:61] op_sel_hi:[1,0]
    v_pk_mul_f32 v[138:139], v[138:139], v[60:61] op_sel_hi:[1,0]
    v_pk_mul_f32 v[140:141], v[140:141], v[60:61] op_sel_hi:[1,0]
    v_pk_mul_f32 v[142:143], v[142:143], v[60:61] op_sel_hi:[1,0]
    v_pk_mul_f32 v[144:145], v[144:145], v[60:61] op_sel_hi:[1,0]
    v_pk_mul_f32 v[146:147], v[146:147], v[60:61] op_sel_hi:[1,0]
    v_pk_mul_f32 v[148:149], v[148:149], v[60:61] op_sel_hi:[1,0]
    v_pk_mul_f32 v[150:151], v[150:151], v[60:61] op_sel_hi:[1,0]
    v_pk_mul_f32 v[152:153], v[152:153], v[60:61] op_sel_hi:[1,0]
    v_pk_mul_f32 v[154:155], v[154:155], v[60:61] op_sel_hi:[1,0]
    v_cvt_pk_bf16_f32 v124, v124, v125
    v_cvt_pk_bf16_f32 v125, v126, v127
    v_cvt_pk_bf16_f32 v126, v128, v129
    v_cvt_pk_bf16_f32 v127, v130, v131
    v_cvt_pk_bf16_f32 v132, v132, v133
    v_permlane16_swap_b32 v124, v126
    v_cvt_pk_bf16_f32 v133, v134, v135
    v_permlane16_swap_b32 v125, v127
    v_cvt_pk_bf16_f32 v134, v136, v137
    buffer_store_dwordx4 v[124:127], v1, s[16:19], s54 offen
    v_cvt_pk_bf16_f32 v135, v138, v139
    v_cvt_pk_bf16_f32 v140, v140, v141
    v_permlane16_swap_b32 v132, v134
    v_cvt_pk_bf16_f32 v141, v142, v143
    v_permlane16_swap_b32 v133, v135
    v_cvt_pk_bf16_f32 v142, v144, v145
    buffer_store_dwordx4 v[132:135], v1, s[16:19], s54 offen offset:64
    v_cvt_pk_bf16_f32 v143, v146, v147
    v_cvt_pk_bf16_f32 v148, v148, v149
    v_permlane16_swap_b32 v140, v142
    v_cvt_pk_bf16_f32 v149, v150, v151
    v_permlane16_swap_b32 v141, v143
    v_cvt_pk_bf16_f32 v150, v152, v153
    buffer_store_dwordx4 v[140:143], v1, s[16:19], s54 offen offset:128
    v_cvt_pk_bf16_f32 v151, v154, v155
    s_nop 1
    v_permlane16_swap_b32 v148, v150
    v_permlane16_swap_b32 v149, v151
    buffer_store_dwordx4 v[148:151], v1, s[16:19], s54 offen offset:192
    s_waitcnt vmcnt(0)
    s_cmp_lg_u32 s52, 0
    s_cbranch_scc1 L_fb_next
L_end:
    s_endpgm
.section .rodata,"a"
.p2align 6
.amdhsa_kernel standalone__mha_softmax__near_ridge_kernel
  .amdhsa_next_free_vgpr 512
  .amdhsa_next_free_sgpr 102
  .amdhsa_accum_offset 256
  .amdhsa_group_segment_fixed_size 0
  .amdhsa_kernarg_size 48
  .amdhsa_user_sgpr_count 2
  .amdhsa_user_sgpr_kernarg_segment_ptr 1
  .amdhsa_system_sgpr_workgroup_id_x 1
.end_amdhsa_kernel
```
